```python
import torch

def _softmax(x, axis=-1):
    return torch.softmax(x, dim=axis)
def _gelu(x):
    return torch.nn.functional.gelu(x, approximate="tanh")
def _silu(x):
    return torch.nn.functional.silu(x)
def _sigmoid(x):
    return torch.sigmoid(x)
def _layernorm(x, axis=-1, eps=1e-5):
    m = x.mean(dim=axis, keepdim=True)
    v = x.var(dim=axis, keepdim=True, unbiased=False)
    return (x - m) / torch.sqrt(v + eps)
def _scatter_add(tgt, idx, src, axis=0):
    return tgt.clone().index_add_(axis, idx, src)
def _segment_sum(src, seg, n):
    out = torch.zeros((n,) + src.shape[1:], dtype=src.dtype)
    return out.index_add_(0, seg, src)
def _pad(x, pw):
    flat = tuple(v for pair in reversed(pw) for v in pair)
    return torch.nn.functional.pad(x, flat)

kernel_name = 'concat_heads__mha_block_cached__gqa_block_cached__near_ridge'

def setup_inputs():

    _w = (lambda a: (lambda t: t.to(torch.bfloat16) if t.is_floating_point() else t)(torch.as_tensor(a)))
    def _A_setup():
        B, Sq, D = 8, 128, 512
        H, Sk, Dh = 32, 1024, 128
        return {
            "x": _w((lambda *s: torch.randn(*s, dtype=torch.bfloat16) * 0.8)(B, Sq, D)),
            "k_cache": _w((lambda *s: torch.randn(*s, dtype=torch.bfloat16) * 0.8)(B, H, Sk, Dh)),
            "v_cache": _w((lambda *s: torch.randn(*s, dtype=torch.bfloat16) * 0.05)(B, H, Sk, Dh)),
            "wq": _w((lambda *s: torch.randn(*s, dtype=torch.bfloat16) * 0.8)(D, H * Dh) * (D ** -0.5)),
            "wo": _w((lambda *s: torch.randn(*s, dtype=torch.bfloat16) * 0.05)(H * Dh, D) * ((H * Dh) ** -0.5)),
        }
    _A_in = _A_setup()

    def _B_setup():
        B, Sq, D = 8, 128, 512
        Hq, Hkv, Sk, Dh = 32, 32, 1024, 128
        assert Hq % Hkv == 0, (Hq, Hkv)
        return {
            "x": _w((lambda *s: torch.randn(*s, dtype=torch.bfloat16) * 0.8)(B, Sq, D)),
            "k_cache": _w((lambda *s: torch.randn(*s, dtype=torch.bfloat16) * 0.8)(B, Hkv, Sk, Dh)),
            "v_cache": _w((lambda *s: torch.randn(*s, dtype=torch.bfloat16) * 0.05)(B, Hkv, Sk, Dh)),
            "wq": _w((lambda *s: torch.randn(*s, dtype=torch.bfloat16) * 0.8)(D, Hq * Dh) * (D ** -0.5)),
            "wo": _w((lambda *s: torch.randn(*s, dtype=torch.bfloat16) * 0.05)(Hq * Dh, D) * ((Hq * Dh) ** -0.5)),
        }
    _B_in = _B_setup()

    return {
        "A_x": _A_in["x"],
        "A_k_cache": _A_in["k_cache"],
        "A_v_cache": _A_in["v_cache"],
        "A_wq": _A_in["wq"],
        "A_wo": _A_in["wo"],
        "B_x": _B_in["x"],
        "B_k_cache": _B_in["k_cache"],
        "B_v_cache": _B_in["v_cache"],
        "B_wq": _B_in["wq"],
        "B_wo": _B_in["wo"],
    }

def reference(A_x, A_k_cache, A_v_cache, A_wq, A_wo, B_x, B_k_cache, B_v_cache, B_wq, B_wo):
    def _A_ref(x, k_cache, v_cache, wq, wo):
        B, Sq, D = x.shape
        H, Dh = 32, 128
        q = (lambda x, *d: x.permute(*d))((x @ wq).reshape(B, Sq, H, Dh), 0, 2, 1, 3)
        scores = torch.einsum("bhqd,bhkd->bhqk", q, k_cache) * (Dh ** -0.5)
        p = _softmax(scores, axis=-1)
        o = torch.einsum("bhqk,bhkd->bhqd", p, v_cache)
        return (lambda x, *d: x.permute(*d))(o, 0, 2, 1, 3).reshape(B, Sq, H * Dh) @ wo

    def _B_ref(x, k_cache, v_cache, wq, wo):
        B, Sq, D = x.shape
        Hq, Dh = 32, 128
        Hkv = k_cache.shape[1]
        rep = Hq // Hkv
        q = (lambda x, *d: x.permute(*d))((x @ wq).reshape(B, Sq, Hq, Dh), 0, 2, 1, 3)
        k = (lambda x, n, axis: torch.repeat_interleave(x, n, dim=axis))(k_cache, rep, axis=1)
        v = (lambda x, n, axis: torch.repeat_interleave(x, n, dim=axis))(v_cache, rep, axis=1)
        scores = torch.einsum("bhqd,bhkd->bhqk", q, k) * (Dh ** -0.5)
        p = _softmax(scores, axis=-1)
        o = torch.einsum("bhqk,bhkd->bhqd", p, v)
        return (lambda x, *d: x.permute(*d))(o, 0, 2, 1, 3).reshape(B, Sq, Hq * Dh) @ wo

    a = _A_ref(A_x, A_k_cache, A_v_cache, A_wq, A_wo)
    b = _B_ref(B_x, B_k_cache, B_v_cache, B_wq, B_wo)
    return torch.concatenate([a, b], axis=-1)
```

```asm
; @launch grid=(256,1,1) block=(512,1,1) lds=163840
.amdgcn_target "amdgcn-amd-amdhsa--gfx950"
.text
.globl concat_heads__mha_block_cached__gqa_block_cached__near_ridge_kernel
.p2align 8
.type concat_heads__mha_block_cached__gqa_block_cached__near_ridge_kernel,@function
concat_heads__mha_block_cached__gqa_block_cached__near_ridge_kernel:
  s_cmp_ge_u32 s2, 256
  s_cbranch_scc1 L_end
  s_load_dwordx16 s[36:51], s[0:1], 0
  s_load_dwordx8 s[72:79], s[0:1], 64
  s_load_dwordx2 s[20:21], s[0:1], 96
  s_and_b32 s3, s2, 7
  s_and_b32 s55, s3, 3
  s_lshr_b32 s52, s3, 2
  s_lshr_b32 s53, s2, 5
  s_lshr_b32 s54, s2, 3
  s_and_b32 s54, s54, 3
  v_lshrrev_b32 v2, 6, v0
  v_and_b32 v1, 63, v0
  v_readfirstlane_b32 s34, v2
  s_mov_b32 s6, 67108864
  s_mov_b32 s7, 0x20000
  s_mov_b32 s10, 67108864
  s_mov_b32 s11, 0x20000
  s_mov_b32 s14, 1048576
  s_mov_b32 s15, 0x20000
  s_mov_b32 s18, 4194304
  s_mov_b32 s19, 0x20000
  s_mov_b32 s22, 287309824
  s_mov_b32 s23, 0x20000
  s_mov_b32 s26, 4194304
  s_mov_b32 s27, 0x20000
  s_mov_b32 s30, 2097152
  s_mov_b32 s31, 0x20000
  s_lshr_b32 s35, s34, 2
  s_and_b32 s34, s34, 3
  s_lshl_b32 s60, s34, 12
  s_lshl_b32 s69, s55, 3
  s_add_u32 s69, s69, s54
  s_lshl_b32 s71, s53, 5
  s_add_u32 s71, s71, s69
  s_lshl_b32 s56, s71, 18
  s_mov_b32 s57, s56
  s_add_u32 s61, s56, 1048576
  s_mov_b32 s67, 0x41700000
  v_lshlrev_b32 v30, 4, v1
  v_lshrrev_b32 v28, 4, v1
  v_and_b32 v29, 15, v1
  v_xor_b32 v29, v29, v28
  s_and_b32 s68, s34, 1
  s_lshl_b32 s68, s68, 3
  v_xor_b32 v29, s68, v29
  v_lshlrev_b32 v29, 4, v29
  s_lshl_b32 s68, s34, 4
  v_add_u32 v28, s68, v28
  v_lshl_add_u32 v24, v28, 10, v29
  v_xor_b32 v25, 0x40, v24
  v_lshrrev_b32 v28, 4, v1
  v_and_b32 v29, 15, v1
  v_lshlrev_b32 v27, 1, v28
  v_xor_b32 v29, v29, v27
  v_lshlrev_b32 v29, 4, v29
  s_lshl_b32 s68, s34, 4
  v_add_u32 v28, s68, v28
  v_lshl_add_u32 v18, v28, 13, v29
  v_xor_b32 v19, 0x80, v18
  s_waitcnt lgkmcnt(0)
  s_cmp_eq_u32 s52, 0
  s_cselect_b32 s12, s36, s46
  s_cselect_b32 s13, s37, s47
  s_cselect_b32 s4, s38, s48
  s_cselect_b32 s5, s39, s49
  s_cselect_b32 s8, s40, s50
  s_cselect_b32 s9, s41, s51
  s_cselect_b32 s16, s42, s72
  s_cselect_b32 s17, s43, s73
  s_cselect_b32 s24, s44, s74
  s_cselect_b32 s25, s45, s75
  s_mov_b32 s28, s76
  s_mov_b32 s29, s77
  s_mov_b32 s36, s78
  s_mov_b32 s37, s79
  s_mov_b32 s38, 256
  s_mov_b32 s39, 0x20000
  s_lshl_b32 s42, s69, 8
  s_lshl_b32 s43, s53, 17
  s_add_u32 s41, s54, s53
  s_and_b32 s41, s41, 3
  s_add_u32 s59, s41, 0
  s_and_b32 s59, s59, 3
  s_lshl_b32 s59, s59, 8
  s_add_u32 s59, s59, s43
  s_lshl_b32 s68, s35, 16
  s_add_u32 s59, s59, s68
  s_cmp_eq_u32 s35, 0
  s_mov_b32 s68, 81920
  s_cselect_b32 s68, s68, 49152
  s_add_u32 m0, s60, s68
  s_nop 0
  buffer_load_dwordx4 v24, s[12:15], s59 offen offset:0 lds
  s_add_u32 s59, s59, 3072
  buffer_load_dwordx4 v24, s[12:15], s59 offen offset:1024 lds
  s_add_u32 s59, s59, 3072
  buffer_load_dwordx4 v25, s[12:15], s59 offen offset:2048 lds
  s_add_u32 s59, s59, 3072
  buffer_load_dwordx4 v25, s[12:15], s59 offen offset:3072 lds
  s_cmp_eq_u32 s35, 0
  s_cbranch_scc0 L_grpB
  s_add_u32 s58, s41, 0
  s_and_b32 s58, s58, 3
  s_lshl_b32 s58, s58, 20
  s_add_u32 s58, s58, s42
  s_add_u32 m0, s60, 114688
  s_mov_b32 s68, s58
  buffer_load_dwordx4 v18, s[16:19], s68 offen offset:0 lds
  s_add_u32 m0, s60, 114688
  s_add_u32 s68, s58, 31744
  buffer_load_dwordx4 v18, s[16:19], s68 offen offset:1024 lds
  s_add_u32 m0, s60, 114688
  s_add_u32 s68, s58, 63488
  buffer_load_dwordx4 v19, s[16:19], s68 offen offset:2048 lds
  s_add_u32 m0, s60, 114688
  s_add_u32 s68, s58, 95232
  buffer_load_dwordx4 v19, s[16:19], s68 offen offset:3072 lds
  s_getpc_b64 s[90:91]
L_pc:
  s_sub_u32 s90, s90, L_pc-concat_heads__mha_block_cached__gqa_block_cached__near_ridge_kernel
  s_subb_u32 s91, s91, 0
  s_lshr_b32 s68, s2, 3
  s_lshl_b32 s68, s68, 2
  s_add_u32 s68, s68, s34
  s_lshl_b32 s68, s68, 2
  v_and_b32 v28, 3, v1
  v_add_lshl_u32 v28, v28, s68, 7
  v_min_u32 v28, L_code_end-concat_heads__mha_block_cached__gqa_block_cached__near_ridge_kernel-4, v28
  global_load_dword v32, v28, s[90:91]
  s_lshl_b32 s68, s52, 3
  s_add_u32 s68, s68, s53
  s_lshl_b32 s47, s68, 7
  s_add_u32 s47, s47, 34603008
  s_load_dwordx2 s[84:85], s[20:21], s47
  s_lshl_b32 s68, s68, 2
  s_add_u32 s68, s68, s55
  s_lshl_b32 s68, s68, 5
  s_add_u32 s68, s68, s34
  s_lshl_b32 s45, s68, 13
  s_lshl_b32 s68, s35, 2
  s_add_u32 s68, s68, s54
  s_lshl_b32 s68, s68, 15
  s_add_u32 s70, s45, s68
  s_lshl_b32 s68, s2, 2
  s_add_u32 s68, s68, s34
  s_mul_i32 s46, s68, 384
  s_add_u32 s46, s46, 33554432
  s_mov_b32 s49, 0x40004000
  s_and_b32 s44, s34, 1
  s_lshl_b32 s44, s44, 13
  s_lshl_b32 s48, s55, 20
  s_lshl_b32 s68, s54, 8
  s_add_u32 s48, s48, s68
  v_lshrrev_b32 v28, 4, v1
  v_and_b32 v29, 15, v1
  v_lshlrev_b32 v27, 1, v28
  v_xor_b32 v29, v29, v27
  v_lshlrev_b32 v29, 4, v29
  s_lshl_b32 s68, s34, 4
  v_add_u32 v28, s68, v28
  v_lshl_add_u32 v16, v28, 8, v29
  v_xor_b32 v17, 0x80, v16
  v_lshrrev_b32 v28, 4, v1
  v_and_b32 v29, 15, v1
  v_xor_b32 v29, v29, v28
  s_and_b32 s68, s34, 1
  s_lshl_b32 s68, s68, 3
  v_xor_b32 v29, s68, v29
  v_lshlrev_b32 v29, 4, v29
  s_lshl_b32 s68, s34, 4
  v_add_u32 v28, s68, v28
  v_lshl_add_u32 v14, v28, 8, v29
  v_xor_b32 v15, 0x40, v14
  v_bfe_u32 v29, v1, 2, 2
  v_and_b32 v28, 3, v1
  v_lshl_or_b32 v28, v29, 3, v28
  v_lshlrev_b32 v28, 8, v28
  v_and_b32 v29, 15, v1
  v_lshrrev_b32 v27, 4, v1
  v_xor_b32 v29, v29, v27
  v_xor_b32 v27, 0, v29
  v_lshl_add_u32 v2, v27, 4, v28
  v_xor_b32 v27, 4, v29
  v_lshl_add_u32 v3, v27, 4, v28
  v_xor_b32 v27, 8, v29
  v_lshl_add_u32 v4, v27, 4, v28
  v_xor_b32 v27, 12, v29
  v_lshl_add_u32 v5, v27, 4, v28
  s_cmp_lt_u32 s34, 2
  s_mov_b32 s69, 0x14000
  s_cselect_b32 s69, s69, 0xc000
  s_add_u32 s69, s69, s44
  v_add_u32 v2, s69, v2
  v_add_u32 v3, s69, v3
  v_add_u32 v4, s69, v4
  v_add_u32 v5, s69, v5
  v_bfe_u32 v28, v1, 2, 3
  v_bfe_u32 v27, v1, 2, 2
  v_lshrrev_b32 v29, 4, v1
  v_lshl_add_u32 v29, v29, 3, v27
  v_lshlrev_b32 v29, 8, v29
  v_and_b32 v27, 3, v1
  v_lshl_add_u32 v29, v27, 3, v29
  v_add_u32 v29, 114688, v29
  v_xor_b32 v27, 0, v28
  v_lshl_add_u32 v6, v27, 5, v29
  v_xor_b32 v27, 1, v28
  v_lshl_add_u32 v7, v27, 5, v29
  v_xor_b32 v27, 2, v28
  v_lshl_add_u32 v8, v27, 5, v29
  v_xor_b32 v27, 3, v28
  v_lshl_add_u32 v9, v27, 5, v29
  v_xor_b32 v27, 4, v28
  v_lshl_add_u32 v10, v27, 5, v29
  v_xor_b32 v27, 5, v28
  v_lshl_add_u32 v11, v27, 5, v29
  v_xor_b32 v27, 6, v28
  v_lshl_add_u32 v12, v27, 5, v29
  v_xor_b32 v27, 7, v28
  v_lshl_add_u32 v13, v27, 5, v29
  v_mov_b64 v[64:65], 0
  v_mov_b64 v[66:67], 0
  v_mov_b64 v[68:69], 0
  v_mov_b64 v[70:71], 0
  v_mov_b64 v[72:73], 0
  v_mov_b64 v[74:75], 0
  v_mov_b64 v[76:77], 0
  v_mov_b64 v[78:79], 0
  v_mov_b64 v[80:81], 0
  v_mov_b64 v[82:83], 0
  v_mov_b64 v[84:85], 0
  v_mov_b64 v[86:87], 0
  v_mov_b64 v[88:89], 0
  v_mov_b64 v[90:91], 0
  v_mov_b64 v[92:93], 0
  v_mov_b64 v[94:95], 0
  v_mov_b64 v[96:97], 0
  v_mov_b64 v[98:99], 0
  v_mov_b64 v[100:101], 0
  v_mov_b64 v[102:103], 0
  v_mov_b64 v[104:105], 0
  v_mov_b64 v[106:107], 0
  v_mov_b64 v[108:109], 0
  v_mov_b64 v[110:111], 0
  v_mov_b64 v[112:113], 0
  v_mov_b64 v[114:115], 0
  v_mov_b64 v[116:117], 0
  v_mov_b64 v[118:119], 0
  v_mov_b64 v[120:121], 0
  v_mov_b64 v[122:123], 0
  v_mov_b64 v[124:125], 0
  v_mov_b64 v[126:127], 0
  s_add_u32 s58, s41, 0
  s_and_b32 s58, s58, 3
  s_lshl_b32 s58, s58, 20
  s_add_u32 s58, s58, s42
  s_add_u32 s58, s58, 524288
  s_add_u32 m0, s60, 131072
  s_mov_b32 s68, s58
  buffer_load_dwordx4 v18, s[16:19], s68 offen offset:0 lds
  s_add_u32 m0, s60, 131072
  s_add_u32 s68, s58, 31744
  buffer_load_dwordx4 v18, s[16:19], s68 offen offset:1024 lds
  s_add_u32 m0, s60, 131072
  s_add_u32 s68, s58, 63488
  buffer_load_dwordx4 v19, s[16:19], s68 offen offset:2048 lds
  s_add_u32 m0, s60, 131072
  s_add_u32 s68, s58, 95232
  buffer_load_dwordx4 v19, s[16:19], s68 offen offset:3072 lds
  s_waitcnt lgkmcnt(0)
  s_mul_i32 s86, s84, 0x9E3779B1
  s_add_u32 s86, s86, 0x7F4A7C15
  s_mul_i32 s87, s85, 0x85EBCA6D
  s_add_u32 s87, s87, 0x27D4EB2F
  s_waitcnt vmcnt(5)
  s_barrier
  ds_read_b128 v[128:131], v2 offset:0
  ds_read_b128 v[132:135], v2 offset:1024
  ds_read_b64_tr_b16 v[224:225], v6 offset:0
  ds_read_b64_tr_b16 v[226:227], v6 offset:1024
  ds_read_b64_tr_b16 v[228:229], v7 offset:0
  ds_read_b64_tr_b16 v[230:231], v7 offset:1024
  s_add_u32 s58, s41, 1
  s_and_b32 s58, s58, 3
  s_lshl_b32 s58, s58, 20
  s_add_u32 s58, s58, s42
  s_add_u32 m0, s60, 0
  s_mov_b32 s68, s58
  buffer_load_dwordx4 v18, s[16:19], s68 offen offset:0 lds
  ds_read_b64_tr_b16 v[232:233], v8 offset:0
  ds_read_b64_tr_b16 v[234:235], v8 offset:1024
  ds_read_b64_tr_b16 v[236:237], v9 offset:0
  ds_read_b64_tr_b16 v[238:239], v9 offset:1024
  s_add_u32 m0, s60, 0
  s_add_u32 s68, s58, 31744
  buffer_load_dwordx4 v18, s[16:19], s68 offen offset:1024 lds
  ds_read_b128 v[136:139], v3 offset:0
  ds_read_b64_tr_b16 v[240:241], v10 offset:0
  s_waitcnt lgkmcnt(8)
  ds_read_b64_tr_b16 v[242:243], v10 offset:1024
  v_mfma_f32_16x16x32_bf16 v[64:67], v[224:227], v[128:131], v[64:67]
  ds_read_b128 v[140:143], v3 offset:1024
  ds_read_b64_tr_b16 v[244:245], v11 offset:0
  v_mfma_f32_16x16x32_bf16 v[68:71], v[224:227], v[132:135], v[68:71]
  s_waitcnt lgkmcnt(9)
  ds_read_b64_tr_b16 v[246:247], v11 offset:1024
  s_add_u32 m0, s60, 0
  s_add_u32 s68, s58, 63488
  buffer_load_dwordx4 v19, s[16:19], s68 offen offset:2048 lds
  v_mfma_f32_16x16x32_bf16 v[72:75], v[228:231], v[128:131], v[72:75]
  ds_read_b128 v[144:147], v4 offset:0
  ds_read_b64_tr_b16 v[248:249], v12 offset:0
  v_mfma_f32_16x16x32_bf16 v[76:79], v[228:231], v[132:135], v[76:79]
  s_waitcnt lgkmcnt(10)
  ds_read_b64_tr_b16 v[250:251], v12 offset:1024
  v_mfma_f32_16x16x32_bf16 v[80:83], v[232:235], v[128:131], v[80:83]
  ds_read_b128 v[148:151], v4 offset:1024
  ds_read_b64_tr_b16 v[252:253], v13 offset:0
  v_mfma_f32_16x16x32_bf16 v[84:87], v[232:235], v[132:135], v[84:87]
  s_waitcnt lgkmcnt(11)
  ds_read_b64_tr_b16 v[254:255], v13 offset:1024
  s_add_u32 m0, s60, 0
  s_add_u32 s68, s58, 95232
  buffer_load_dwordx4 v19, s[16:19], s68 offen offset:3072 lds
  s_mov_b32 s72, 0x4000
  v_mfma_f32_16x16x32_bf16 v[88:91], v[236:239], v[128:131], v[88:91]
  ds_read_b128 v[152:155], v5 offset:0
  ds_read_b64_tr_b16 v[224:225], v6 offset:8192
  v_mfma_f32_16x16x32_bf16 v[92:95], v[236:239], v[132:135], v[92:95]
  s_waitcnt lgkmcnt(11)
  ds_read_b64_tr_b16 v[226:227], v6 offset:9216
  v_mfma_f32_16x16x32_bf16 v[96:99], v[240:243], v[128:131], v[96:99]
  ds_read_b128 v[156:159], v5 offset:1024
  ds_read_b64_tr_b16 v[228:229], v7 offset:8192
  v_mfma_f32_16x16x32_bf16 v[100:103], v[240:243], v[132:135], v[100:103]
  s_waitcnt lgkmcnt(11)
  ds_read_b64_tr_b16 v[230:231], v7 offset:9216
  v_add_u32 v6, s72, v6
  s_add_u32 s58, s41, 1
  s_and_b32 s58, s58, 3
  s_lshl_b32 s58, s58, 20
  s_add_u32 s58, s58, s42
  s_add_u32 s58, s58, 524288
  s_add_u32 m0, s60, 16384
  s_mov_b32 s68, s58
  buffer_load_dwordx4 v18, s[16:19], s68 offen offset:0 lds
  v_mfma_f32_16x16x32_bf16 v[104:107], v[244:247], v[128:131], v[104:107]
  ds_read_b64_tr_b16 v[232:233], v8 offset:8192
  v_add_u32 v7, s72, v7
  v_mfma_f32_16x16x32_bf16 v[108:111], v[244:247], v[132:135], v[108:111]
  s_waitcnt lgkmcnt(10)
  ds_read_b64_tr_b16 v[234:235], v8 offset:9216
  s_add_u32 m0, s60, 16384
  s_add_u32 s68, s58, 31744
  buffer_load_dwordx4 v18, s[16:19], s68 offen offset:1024 lds
  v_mfma_f32_16x16x32_bf16 v[112:115], v[248:251], v[128:131], v[112:115]
  ds_read_b64_tr_b16 v[236:237], v9 offset:8192
  v_add_u32 v8, s72, v8
  v_mfma_f32_16x16x32_bf16 v[116:119], v[248:251], v[132:135], v[116:119]
  s_waitcnt lgkmcnt(9)
  ds_read_b64_tr_b16 v[238:239], v9 offset:9216
  s_cmp_lt_u32 s34, 2
  s_mov_b32 s73, 0x10000
  s_cselect_b32 s73, s73, 0xc000
  v_mfma_f32_16x16x32_bf16 v[120:123], v[252:255], v[128:131], v[120:123]
  ds_read_b64_tr_b16 v[240:241], v10 offset:8192
  v_add_u32 v9, s72, v9
  v_mfma_f32_16x16x32_bf16 v[124:127], v[252:255], v[132:135], v[124:127]
  s_waitcnt lgkmcnt(8)
  ds_read_b64_tr_b16 v[242:243], v10 offset:9216
  s_add_u32 m0, s60, 16384
  s_add_u32 s68, s58, 63488
  buffer_load_dwordx4 v19, s[16:19], s68 offen offset:2048 lds
  v_mfma_f32_16x16x32_bf16 v[64:67], v[224:227], v[136:139], v[64:67]
  ds_read_b64_tr_b16 v[244:245], v11 offset:8192
  v_add_u32 v10, s72, v10
  v_mfma_f32_16x16x32_bf16 v[68:71], v[224:227], v[140:143], v[68:71]
  s_waitcnt lgkmcnt(7)
  ds_read_b64_tr_b16 v[246:247], v11 offset:9216
  v_mfma_f32_16x16x32_bf16 v[72:75], v[228:231], v[136:139], v[72:75]
  ds_read_b64_tr_b16 v[248:249], v12 offset:8192
  v_add_u32 v11, s72, v11
  v_mfma_f32_16x16x32_bf16 v[76:79], v[228:231], v[140:143], v[76:79]
  s_waitcnt lgkmcnt(7)
  ds_read_b64_tr_b16 v[250:251], v12 offset:9216
  s_add_u32 m0, s60, 16384
  s_add_u32 s68, s58, 95232
  buffer_load_dwordx4 v19, s[16:19], s68 offen offset:3072 lds
  v_mfma_f32_16x16x32_bf16 v[80:83], v[232:235], v[136:139], v[80:83]
  ds_read_b64_tr_b16 v[252:253], v13 offset:8192
  v_add_u32 v12, s72, v12
  v_mfma_f32_16x16x32_bf16 v[84:87], v[232:235], v[140:143], v[84:87]
  s_waitcnt lgkmcnt(7)
  ds_read_b64_tr_b16 v[254:255], v13 offset:9216
  v_add_u32 v13, s72, v13
  v_mfma_f32_16x16x32_bf16 v[88:91], v[236:239], v[136:139], v[88:91]
  v_mfma_f32_16x16x32_bf16 v[92:95], v[236:239], v[140:143], v[92:95]
  s_waitcnt lgkmcnt(6)
  v_mfma_f32_16x16x32_bf16 v[96:99], v[240:243], v[136:139], v[96:99]
  v_mfma_f32_16x16x32_bf16 v[100:103], v[240:243], v[140:143], v[100:103]
  s_waitcnt lgkmcnt(4)
  v_mfma_f32_16x16x32_bf16 v[104:107], v[244:247], v[136:139], v[104:107]
  s_waitcnt lgkmcnt(0)
  s_waitcnt vmcnt(8)
  s_barrier
  ds_read_b64_tr_b16 v[224:225], v6 offset:0
  ds_read_b64_tr_b16 v[226:227], v6 offset:1024
  v_mfma_f32_16x16x32_bf16 v[108:111], v[244:247], v[140:143], v[108:111]
  ds_read_b64_tr_b16 v[228:229], v7 offset:0
  ds_read_b64_tr_b16 v[230:231], v7 offset:1024
  s_add_u32 s58, s41, 2
  s_and_b32 s58, s58, 3
  s_lshl_b32 s58, s58, 20
  s_add_u32 s58, s58, s42
  s_add_u32 m0, s60, 81920
  s_mov_b32 s68, s58
  buffer_load_dwordx4 v18, s[16:19], s68 offen offset:0 lds
  v_mfma_f32_16x16x32_bf16 v[112:115], v[248:251], v[136:139], v[112:115]
  ds_read_b64_tr_b16 v[232:233], v8 offset:0
  ds_read_b64_tr_b16 v[234:235], v8 offset:1024
  v_mfma_f32_16x16x32_bf16 v[116:119], v[248:251], v[140:143], v[116:119]
  ds_read_b64_tr_b16 v[236:237], v9 offset:0
  ds_read_b64_tr_b16 v[238:239], v9 offset:1024
  v_mfma_f32_16x16x32_bf16 v[120:123], v[252:255], v[136:139], v[120:123]
  ds_read_b64_tr_b16 v[240:241], v10 offset:0
  v_add_u32 v2, s73, v2
  v_mfma_f32_16x16x32_bf16 v[124:127], v[252:255], v[140:143], v[124:127]
  s_waitcnt lgkmcnt(7)
  ds_read_b64_tr_b16 v[242:243], v10 offset:1024
  v_mfma_f32_16x16x32_bf16 v[64:67], v[224:227], v[144:147], v[64:67]
  ds_read_b64_tr_b16 v[244:245], v11 offset:0
  v_add_u32 v3, s73, v3
  v_mfma_f32_16x16x32_bf16 v[68:71], v[224:227], v[148:151], v[68:71]
  s_waitcnt lgkmcnt(7)
  ds_read_b64_tr_b16 v[246:247], v11 offset:1024
  s_add_u32 m0, s60, 81920
  s_add_u32 s68, s58, 31744
  buffer_load_dwordx4 v18, s[16:19], s68 offen offset:1024 lds
  v_mfma_f32_16x16x32_bf16 v[72:75], v[228:231], v[144:147], v[72:75]
  ds_read_b64_tr_b16 v[248:249], v12 offset:0
  v_add_u32 v4, s73, v4
  v_mfma_f32_16x16x32_bf16 v[76:79], v[228:231], v[148:151], v[76:79]
  s_waitcnt lgkmcnt(7)
  ds_read_b64_tr_b16 v[250:251], v12 offset:1024
  v_mfma_f32_16x16x32_bf16 v[80:83], v[232:235], v[144:147], v[80:83]
  ds_read_b64_tr_b16 v[252:253], v13 offset:0
  v_add_u32 v5, s73, v5
  v_mfma_f32_16x16x32_bf16 v[84:87], v[232:235], v[148:151], v[84:87]
  s_waitcnt lgkmcnt(7)
  ds_read_b64_tr_b16 v[254:255], v13 offset:1024
  s_mov_b32 s72, 0xfffe0000
  v_mfma_f32_16x16x32_bf16 v[88:91], v[236:239], v[144:147], v[88:91]
  ds_read_b64_tr_b16 v[224:225], v6 offset:8192
  v_mfma_f32_16x16x32_bf16 v[92:95], v[236:239], v[148:151], v[92:95]
  s_waitcnt lgkmcnt(7)
  ds_read_b64_tr_b16 v[226:227], v6 offset:9216
  v_mfma_f32_16x16x32_bf16 v[96:99], v[240:243], v[144:147], v[96:99]
  ds_read_b64_tr_b16 v[228:229], v7 offset:8192
  v_add_u32 v6, s72, v6
  v_mfma_f32_16x16x32_bf16 v[100:103], v[240:243], v[148:151], v[100:103]
  s_waitcnt lgkmcnt(7)
  ds_read_b64_tr_b16 v[230:231], v7 offset:9216
  s_add_u32 m0, s60, 81920
  s_add_u32 s68, s58, 63488
  buffer_load_dwordx4 v19, s[16:19], s68 offen offset:2048 lds
  v_mfma_f32_16x16x32_bf16 v[104:107], v[244:247], v[144:147], v[104:107]
  ds_read_b64_tr_b16 v[232:233], v8 offset:8192
  v_add_u32 v7, s72, v7
  v_mfma_f32_16x16x32_bf16 v[108:111], v[244:247], v[148:151], v[108:111]
  s_waitcnt lgkmcnt(7)
  ds_read_b64_tr_b16 v[234:235], v8 offset:9216
  v_mfma_f32_16x16x32_bf16 v[112:115], v[248:251], v[144:147], v[112:115]
  ds_read_b64_tr_b16 v[236:237], v9 offset:8192
  v_add_u32 v8, s72, v8
  v_mfma_f32_16x16x32_bf16 v[116:119], v[248:251], v[148:151], v[116:119]
  s_waitcnt lgkmcnt(7)
  ds_read_b64_tr_b16 v[238:239], v9 offset:9216
  v_mfma_f32_16x16x32_bf16 v[120:123], v[252:255], v[144:147], v[120:123]
  ds_read_b64_tr_b16 v[240:241], v10 offset:8192
  v_add_u32 v9, s72, v9
  v_mfma_f32_16x16x32_bf16 v[124:127], v[252:255], v[148:151], v[124:127]
  s_waitcnt lgkmcnt(7)
  ds_read_b64_tr_b16 v[242:243], v10 offset:9216
  s_add_u32 m0, s60, 81920
  s_add_u32 s68, s58, 95232
  buffer_load_dwordx4 v19, s[16:19], s68 offen offset:3072 lds
  v_mfma_f32_16x16x32_bf16 v[64:67], v[224:227], v[152:155], v[64:67]
  ds_read_b64_tr_b16 v[244:245], v11 offset:8192
  v_add_u32 v10, s72, v10
  v_mfma_f32_16x16x32_bf16 v[68:71], v[224:227], v[156:159], v[68:71]
  s_waitcnt lgkmcnt(7)
  ds_read_b64_tr_b16 v[246:247], v11 offset:9216
  v_mfma_f32_16x16x32_bf16 v[72:75], v[228:231], v[152:155], v[72:75]
  ds_read_b64_tr_b16 v[248:249], v12 offset:8192
  v_add_u32 v11, s72, v11
  v_mfma_f32_16x16x32_bf16 v[76:79], v[228:231], v[156:159], v[76:79]
  s_waitcnt lgkmcnt(7)
  ds_read_b64_tr_b16 v[250:251], v12 offset:9216
  v_mfma_f32_16x16x32_bf16 v[80:83], v[232:235], v[152:155], v[80:83]
  ds_read_b64_tr_b16 v[252:253], v13 offset:8192
  v_add_u32 v12, s72, v12
  v_mfma_f32_16x16x32_bf16 v[84:87], v[232:235], v[156:159], v[84:87]
  s_waitcnt lgkmcnt(7)
  ds_read_b64_tr_b16 v[254:255], v13 offset:9216
  v_add_u32 v13, s72, v13
  v_mfma_f32_16x16x32_bf16 v[88:91], v[236:239], v[152:155], v[88:91]
  v_mfma_f32_16x16x32_bf16 v[92:95], v[236:239], v[156:159], v[92:95]
  s_waitcnt lgkmcnt(6)
  v_mfma_f32_16x16x32_bf16 v[96:99], v[240:243], v[152:155], v[96:99]
  v_mfma_f32_16x16x32_bf16 v[100:103], v[240:243], v[156:159], v[100:103]
  s_waitcnt lgkmcnt(4)
  v_mfma_f32_16x16x32_bf16 v[104:107], v[244:247], v[152:155], v[104:107]
  s_waitcnt lgkmcnt(0)
  s_waitcnt vmcnt(8)
  s_barrier
  ds_read_b128 v[160:163], v2 offset:0
  ds_read_b128 v[164:167], v2 offset:1024
  ds_read_b64_tr_b16 v[224:225], v6 offset:0
  v_mfma_f32_16x16x32_bf16 v[108:111], v[244:247], v[156:159], v[108:111]
  ds_read_b64_tr_b16 v[226:227], v6 offset:1024
  ds_read_b64_tr_b16 v[228:229], v7 offset:0
  ds_read_b64_tr_b16 v[230:231], v7 offset:1024
  s_add_u32 s58, s41, 2
  s_and_b32 s58, s58, 3
  s_lshl_b32 s58, s58, 20
  s_add_u32 s58, s58, s42
  s_add_u32 s58, s58, 524288
  s_add_u32 m0, s60, 49152
  s_mov_b32 s68, s58
  buffer_load_dwordx4 v18, s[16:19], s68 offen offset:0 lds
  v_mfma_f32_16x16x32_bf16 v[112:115], v[248:251], v[152:155], v[112:115]
  ds_read_b64_tr_b16 v[232:233], v8 offset:0
  ds_read_b64_tr_b16 v[234:235], v8 offset:1024
  v_mfma_f32_16x16x32_bf16 v[116:119], v[248:251], v[156:159], v[116:119]
  ds_read_b64_tr_b16 v[236:237], v9 offset:0
  ds_read_b64_tr_b16 v[238:239], v9 offset:1024
  v_mfma_f32_16x16x32_bf16 v[120:123], v[252:255], v[152:155], v[120:123]
  ds_read_b128 v[168:171], v3 offset:0
  ds_read_b64_tr_b16 v[240:241], v10 offset:0
  v_mfma_f32_16x16x32_bf16 v[124:127], v[252:255], v[156:159], v[124:127]
  s_waitcnt lgkmcnt(8)
  ds_read_b64_tr_b16 v[242:243], v10 offset:1024
  v_mfma_f32_16x16x32_bf16 v[64:67], v[224:227], v[160:163], v[64:67]
  ds_read_b128 v[172:175], v3 offset:1024
  ds_read_b64_tr_b16 v[244:245], v11 offset:0
  v_mfma_f32_16x16x32_bf16 v[68:71], v[224:227], v[164:167], v[68:71]
  s_waitcnt lgkmcnt(9)
  ds_read_b64_tr_b16 v[246:247], v11 offset:1024
  s_add_u32 m0, s60, 49152
  s_add_u32 s68, s58, 31744
  buffer_load_dwordx4 v18, s[16:19], s68 offen offset:1024 lds
  v_mfma_f32_16x16x32_bf16 v[72:75], v[228:231], v[160:163], v[72:75]
  ds_read_b128 v[176:179], v4 offset:0
  ds_read_b64_tr_b16 v[248:249], v12 offset:0
  v_mfma_f32_16x16x32_bf16 v[76:79], v[228:231], v[164:167], v[76:79]
  s_waitcnt lgkmcnt(10)
  ds_read_b64_tr_b16 v[250:251], v12 offset:1024
  v_mfma_f32_16x16x32_bf16 v[80:83], v[232:235], v[160:163], v[80:83]
  ds_read_b128 v[180:183], v4 offset:1024
  ds_read_b64_tr_b16 v[252:253], v13 offset:0
  v_mfma_f32_16x16x32_bf16 v[84:87], v[232:235], v[164:167], v[84:87]
  s_waitcnt lgkmcnt(11)
  ds_read_b64_tr_b16 v[254:255], v13 offset:1024
  s_mov_b32 s72, 0x4000
  v_mfma_f32_16x16x32_bf16 v[88:91], v[236:239], v[160:163], v[88:91]
  ds_read_b128 v[184:187], v5 offset:0
  ds_read_b64_tr_b16 v[224:225], v6 offset:8192
  v_mfma_f32_16x16x32_bf16 v[92:95], v[236:239], v[164:167], v[92:95]
  s_waitcnt lgkmcnt(11)
  ds_read_b64_tr_b16 v[226:227], v6 offset:9216
  v_mfma_f32_16x16x32_bf16 v[96:99], v[240:243], v[160:163], v[96:99]
  ds_read_b128 v[188:191], v5 offset:1024
  ds_read_b64_tr_b16 v[228:229], v7 offset:8192
  v_mfma_f32_16x16x32_bf16 v[100:103], v[240:243], v[164:167], v[100:103]
  s_waitcnt lgkmcnt(11)
  ds_read_b64_tr_b16 v[230:231], v7 offset:9216
  v_add_u32 v6, s72, v6
  s_add_u32 m0, s60, 49152
  s_add_u32 s68, s58, 63488
  buffer_load_dwordx4 v19, s[16:19], s68 offen offset:2048 lds
  v_mfma_f32_16x16x32_bf16 v[104:107], v[244:247], v[160:163], v[104:107]
  ds_read_b64_tr_b16 v[232:233], v8 offset:8192
  v_add_u32 v7, s72, v7
  v_mfma_f32_16x16x32_bf16 v[108:111], v[244:247], v[164:167], v[108:111]
  s_waitcnt lgkmcnt(10)
  ds_read_b64_tr_b16 v[234:235], v8 offset:9216
  v_mfma_f32_16x16x32_bf16 v[112:115], v[248:251], v[160:163], v[112:115]
  ds_read_b64_tr_b16 v[236:237], v9 offset:8192
  v_add_u32 v8, s72, v8
  v_mfma_f32_16x16x32_bf16 v[116:119], v[248:251], v[164:167], v[116:119]
  s_waitcnt lgkmcnt(9)
  ds_read_b64_tr_b16 v[238:239], v9 offset:9216
  s_cmp_lt_u32 s34, 2
  s_mov_b32 s73, 0xfffec000
  s_cselect_b32 s73, s73, 0xffff0000
  v_mfma_f32_16x16x32_bf16 v[120:123], v[252:255], v[160:163], v[120:123]
  ds_read_b64_tr_b16 v[240:241], v10 offset:8192
  v_add_u32 v9, s72, v9
  v_mfma_f32_16x16x32_bf16 v[124:127], v[252:255], v[164:167], v[124:127]
  s_waitcnt lgkmcnt(8)
  ds_read_b64_tr_b16 v[242:243], v10 offset:9216
  s_add_u32 m0, s60, 49152
  s_add_u32 s68, s58, 95232
  buffer_load_dwordx4 v19, s[16:19], s68 offen offset:3072 lds
  v_mfma_f32_16x16x32_bf16 v[64:67], v[224:227], v[168:171], v[64:67]
  ds_read_b64_tr_b16 v[244:245], v11 offset:8192
  v_add_u32 v10, s72, v10
  v_mfma_f32_16x16x32_bf16 v[68:71], v[224:227], v[172:175], v[68:71]
  s_waitcnt lgkmcnt(7)
  ds_read_b64_tr_b16 v[246:247], v11 offset:9216
  v_mfma_f32_16x16x32_bf16 v[72:75], v[228:231], v[168:171], v[72:75]
  ds_read_b64_tr_b16 v[248:249], v12 offset:8192
  v_add_u32 v11, s72, v11
  v_mfma_f32_16x16x32_bf16 v[76:79], v[228:231], v[172:175], v[76:79]
  s_waitcnt lgkmcnt(7)
  ds_read_b64_tr_b16 v[250:251], v12 offset:9216
  v_mfma_f32_16x16x32_bf16 v[80:83], v[232:235], v[168:171], v[80:83]
  ds_read_b64_tr_b16 v[252:253], v13 offset:8192
  v_add_u32 v12, s72, v12
  v_mfma_f32_16x16x32_bf16 v[84:87], v[232:235], v[172:175], v[84:87]
  s_waitcnt lgkmcnt(7)
  ds_read_b64_tr_b16 v[254:255], v13 offset:9216
  v_add_u32 v13, s72, v13
  v_mfma_f32_16x16x32_bf16 v[88:91], v[236:239], v[168:171], v[88:91]
  v_mfma_f32_16x16x32_bf16 v[92:95], v[236:239], v[172:175], v[92:95]
  s_waitcnt lgkmcnt(6)
  v_mfma_f32_16x16x32_bf16 v[96:99], v[240:243], v[168:171], v[96:99]
  v_mfma_f32_16x16x32_bf16 v[100:103], v[240:243], v[172:175], v[100:103]
  s_waitcnt lgkmcnt(4)
  v_mfma_f32_16x16x32_bf16 v[104:107], v[244:247], v[168:171], v[104:107]
  s_waitcnt lgkmcnt(0)
  s_waitcnt vmcnt(8)
  s_barrier
  ds_read_b64_tr_b16 v[224:225], v6 offset:0
  ds_read_b64_tr_b16 v[226:227], v6 offset:1024
  v_mfma_f32_16x16x32_bf16 v[108:111], v[244:247], v[172:175], v[108:111]
  ds_read_b64_tr_b16 v[228:229], v7 offset:0
  ds_read_b64_tr_b16 v[230:231], v7 offset:1024
  s_add_u32 s58, s41, 3
  s_and_b32 s58, s58, 3
  s_lshl_b32 s58, s58, 20
  s_add_u32 s58, s58, s42
  s_add_u32 m0, s60, 147456
  s_mov_b32 s68, s58
  buffer_load_dwordx4 v18, s[16:19], s68 offen offset:0 lds
  v_mfma_f32_16x16x32_bf16 v[112:115], v[248:251], v[168:171], v[112:115]
  ds_read_b64_tr_b16 v[232:233], v8 offset:0
  ds_read_b64_tr_b16 v[234:235], v8 offset:1024
  v_mfma_f32_16x16x32_bf16 v[116:119], v[248:251], v[172:175], v[116:119]
  ds_read_b64_tr_b16 v[236:237], v9 offset:0
  ds_read_b64_tr_b16 v[238:239], v9 offset:1024
  v_mfma_f32_16x16x32_bf16 v[120:123], v[252:255], v[168:171], v[120:123]
  ds_read_b64_tr_b16 v[240:241], v10 offset:0
  v_add_u32 v2, s73, v2
  v_mfma_f32_16x16x32_bf16 v[124:127], v[252:255], v[172:175], v[124:127]
  s_waitcnt lgkmcnt(7)
  ds_read_b64_tr_b16 v[242:243], v10 offset:1024
  v_mfma_f32_16x16x32_bf16 v[64:67], v[224:227], v[176:179], v[64:67]
  ds_read_b64_tr_b16 v[244:245], v11 offset:0
  v_add_u32 v3, s73, v3
  v_mfma_f32_16x16x32_bf16 v[68:71], v[224:227], v[180:183], v[68:71]
  s_waitcnt lgkmcnt(7)
  ds_read_b64_tr_b16 v[246:247], v11 offset:1024
  s_add_u32 m0, s60, 147456
  s_add_u32 s68, s58, 31744
  buffer_load_dwordx4 v18, s[16:19], s68 offen offset:1024 lds
  v_mfma_f32_16x16x32_bf16 v[72:75], v[228:231], v[176:179], v[72:75]
  ds_read_b64_tr_b16 v[248:249], v12 offset:0
  v_add_u32 v4, s73, v4
  v_mfma_f32_16x16x32_bf16 v[76:79], v[228:231], v[180:183], v[76:79]
  s_waitcnt lgkmcnt(7)
  ds_read_b64_tr_b16 v[250:251], v12 offset:1024
  v_mfma_f32_16x16x32_bf16 v[80:83], v[232:235], v[176:179], v[80:83]
  ds_read_b64_tr_b16 v[252:253], v13 offset:0
  v_add_u32 v5, s73, v5
  v_mfma_f32_16x16x32_bf16 v[84:87], v[232:235], v[180:183], v[84:87]
  s_waitcnt lgkmcnt(7)
  ds_read_b64_tr_b16 v[254:255], v13 offset:1024
  s_mov_b32 s72, 0x10000
  v_mfma_f32_16x16x32_bf16 v[88:91], v[236:239], v[176:179], v[88:91]
  ds_read_b64_tr_b16 v[224:225], v6 offset:8192
  v_mfma_f32_16x16x32_bf16 v[92:95], v[236:239], v[180:183], v[92:95]
  s_waitcnt lgkmcnt(7)
  ds_read_b64_tr_b16 v[226:227], v6 offset:9216
  v_mfma_f32_16x16x32_bf16 v[96:99], v[240:243], v[176:179], v[96:99]
  ds_read_b64_tr_b16 v[228:229], v7 offset:8192
  v_add_u32 v6, s72, v6
  v_mfma_f32_16x16x32_bf16 v[100:103], v[240:243], v[180:183], v[100:103]
  s_waitcnt lgkmcnt(7)
  ds_read_b64_tr_b16 v[230:231], v7 offset:9216
  s_add_u32 m0, s60, 147456
  s_add_u32 s68, s58, 63488
  buffer_load_dwordx4 v19, s[16:19], s68 offen offset:2048 lds
  v_mfma_f32_16x16x32_bf16 v[104:107], v[244:247], v[176:179], v[104:107]
  ds_read_b64_tr_b16 v[232:233], v8 offset:8192
  v_add_u32 v7, s72, v7
  v_mfma_f32_16x16x32_bf16 v[108:111], v[244:247], v[180:183], v[108:111]
  s_waitcnt lgkmcnt(7)
  ds_read_b64_tr_b16 v[234:235], v8 offset:9216
  v_mfma_f32_16x16x32_bf16 v[112:115], v[248:251], v[176:179], v[112:115]
  ds_read_b64_tr_b16 v[236:237], v9 offset:8192
  v_add_u32 v8, s72, v8
  v_mfma_f32_16x16x32_bf16 v[116:119], v[248:251], v[180:183], v[116:119]
  s_waitcnt lgkmcnt(7)
  ds_read_b64_tr_b16 v[238:239], v9 offset:9216
  v_mfma_f32_16x16x32_bf16 v[120:123], v[252:255], v[176:179], v[120:123]
  ds_read_b64_tr_b16 v[240:241], v10 offset:8192
  v_add_u32 v9, s72, v9
  v_mfma_f32_16x16x32_bf16 v[124:127], v[252:255], v[180:183], v[124:127]
  s_waitcnt lgkmcnt(7)
  ds_read_b64_tr_b16 v[242:243], v10 offset:9216
  s_add_u32 m0, s60, 147456
  s_add_u32 s68, s58, 95232
  buffer_load_dwordx4 v19, s[16:19], s68 offen offset:3072 lds
  v_mfma_f32_16x16x32_bf16 v[64:67], v[224:227], v[184:187], v[64:67]
  ds_read_b64_tr_b16 v[244:245], v11 offset:8192
  v_add_u32 v10, s72, v10
  v_mfma_f32_16x16x32_bf16 v[68:71], v[224:227], v[188:191], v[68:71]
  s_waitcnt lgkmcnt(7)
  ds_read_b64_tr_b16 v[246:247], v11 offset:9216
  v_mfma_f32_16x16x32_bf16 v[72:75], v[228:231], v[184:187], v[72:75]
  ds_read_b64_tr_b16 v[248:249], v12 offset:8192
  v_add_u32 v11, s72, v11
  v_mfma_f32_16x16x32_bf16 v[76:79], v[228:231], v[188:191], v[76:79]
  s_waitcnt lgkmcnt(7)
  ds_read_b64_tr_b16 v[250:251], v12 offset:9216
  v_mfma_f32_16x16x32_bf16 v[80:83], v[232:235], v[184:187], v[80:83]
  ds_read_b64_tr_b16 v[252:253], v13 offset:8192
  v_add_u32 v12, s72, v12
  v_mfma_f32_16x16x32_bf16 v[84:87], v[232:235], v[188:191], v[84:87]
  s_waitcnt lgkmcnt(7)
  ds_read_b64_tr_b16 v[254:255], v13 offset:9216
  v_add_u32 v13, s72, v13
  v_mfma_f32_16x16x32_bf16 v[88:91], v[236:239], v[184:187], v[88:91]
  v_mfma_f32_16x16x32_bf16 v[92:95], v[236:239], v[188:191], v[92:95]
  s_waitcnt lgkmcnt(6)
  v_mfma_f32_16x16x32_bf16 v[96:99], v[240:243], v[184:187], v[96:99]
  v_mfma_f32_16x16x32_bf16 v[100:103], v[240:243], v[188:191], v[100:103]
  s_waitcnt lgkmcnt(4)
  v_mfma_f32_16x16x32_bf16 v[104:107], v[244:247], v[184:187], v[104:107]
  s_waitcnt lgkmcnt(0)
  s_waitcnt vmcnt(8)
  s_barrier
  ds_read_b128 v[192:195], v2 offset:0
  ds_read_b128 v[196:199], v2 offset:1024
  ds_read_b64_tr_b16 v[224:225], v6 offset:0
  v_mfma_f32_16x16x32_bf16 v[108:111], v[244:247], v[188:191], v[108:111]
  ds_read_b64_tr_b16 v[226:227], v6 offset:1024
  ds_read_b64_tr_b16 v[228:229], v7 offset:0
  ds_read_b64_tr_b16 v[230:231], v7 offset:1024
  s_add_u32 s58, s41, 3
  s_and_b32 s58, s58, 3
  s_lshl_b32 s58, s58, 20
  s_add_u32 s58, s58, s42
  s_add_u32 s58, s58, 524288
  s_add_u32 m0, s60, 98304
  s_mov_b32 s68, s58
  buffer_load_dwordx4 v18, s[16:19], s68 offen offset:0 lds
  v_mfma_f32_16x16x32_bf16 v[112:115], v[248:251], v[184:187], v[112:115]
  ds_read_b64_tr_b16 v[232:233], v8 offset:0
  ds_read_b64_tr_b16 v[234:235], v8 offset:1024
  v_mfma_f32_16x16x32_bf16 v[116:119], v[248:251], v[188:191], v[116:119]
  ds_read_b64_tr_b16 v[236:237], v9 offset:0
  ds_read_b64_tr_b16 v[238:239], v9 offset:1024
  v_mfma_f32_16x16x32_bf16 v[120:123], v[252:255], v[184:187], v[120:123]
  ds_read_b128 v[200:203], v3 offset:0
  ds_read_b64_tr_b16 v[240:241], v10 offset:0
  v_mfma_f32_16x16x32_bf16 v[124:127], v[252:255], v[188:191], v[124:127]
  s_waitcnt lgkmcnt(8)
  ds_read_b64_tr_b16 v[242:243], v10 offset:1024
  v_mfma_f32_16x16x32_bf16 v[64:67], v[224:227], v[192:195], v[64:67]
  ds_read_b128 v[204:207], v3 offset:1024
  ds_read_b64_tr_b16 v[244:245], v11 offset:0
  v_mfma_f32_16x16x32_bf16 v[68:71], v[224:227], v[196:199], v[68:71]
  s_waitcnt lgkmcnt(9)
  ds_read_b64_tr_b16 v[246:247], v11 offset:1024
  s_add_u32 m0, s60, 98304
  s_add_u32 s68, s58, 31744
  buffer_load_dwordx4 v18, s[16:19], s68 offen offset:1024 lds
  v_mfma_f32_16x16x32_bf16 v[72:75], v[228:231], v[192:195], v[72:75]
  ds_read_b128 v[208:211], v4 offset:0
  ds_read_b64_tr_b16 v[248:249], v12 offset:0
  v_mfma_f32_16x16x32_bf16 v[76:79], v[228:231], v[196:199], v[76:79]
  s_waitcnt lgkmcnt(10)
  ds_read_b64_tr_b16 v[250:251], v12 offset:1024
  v_mfma_f32_16x16x32_bf16 v[80:83], v[232:235], v[192:195], v[80:83]
  ds_read_b128 v[212:215], v4 offset:1024
  ds_read_b64_tr_b16 v[252:253], v13 offset:0
  v_mfma_f32_16x16x32_bf16 v[84:87], v[232:235], v[196:199], v[84:87]
  s_waitcnt lgkmcnt(11)
  ds_read_b64_tr_b16 v[254:255], v13 offset:1024
  s_mov_b32 s72, 0xffff8000
  v_mfma_f32_16x16x32_bf16 v[88:91], v[236:239], v[192:195], v[88:91]
  ds_read_b128 v[216:219], v5 offset:0
  ds_read_b64_tr_b16 v[224:225], v6 offset:8192
  v_mfma_f32_16x16x32_bf16 v[92:95], v[236:239], v[196:199], v[92:95]
  s_waitcnt lgkmcnt(11)
  ds_read_b64_tr_b16 v[226:227], v6 offset:9216
  v_mfma_f32_16x16x32_bf16 v[96:99], v[240:243], v[192:195], v[96:99]
  ds_read_b128 v[220:223], v5 offset:1024
  ds_read_b64_tr_b16 v[228:229], v7 offset:8192
  v_mfma_f32_16x16x32_bf16 v[100:103], v[240:243], v[196:199], v[100:103]
  s_waitcnt lgkmcnt(11)
  ds_read_b64_tr_b16 v[230:231], v7 offset:9216
  v_add_u32 v6, s72, v6
  s_add_u32 m0, s60, 98304
  s_add_u32 s68, s58, 63488
  buffer_load_dwordx4 v19, s[16:19], s68 offen offset:2048 lds
  v_mfma_f32_16x16x32_bf16 v[104:107], v[244:247], v[192:195], v[104:107]
  ds_read_b64_tr_b16 v[232:233], v8 offset:8192
  v_add_u32 v7, s72, v7
  v_mfma_f32_16x16x32_bf16 v[108:111], v[244:247], v[196:199], v[108:111]
  s_waitcnt lgkmcnt(10)
  ds_read_b64_tr_b16 v[234:235], v8 offset:9216
  v_mfma_f32_16x16x32_bf16 v[112:115], v[248:251], v[192:195], v[112:115]
  ds_read_b64_tr_b16 v[236:237], v9 offset:8192
  v_add_u32 v8, s72, v8
  v_mfma_f32_16x16x32_bf16 v[116:119], v[248:251], v[196:199], v[116:119]
  s_waitcnt lgkmcnt(9)
  ds_read_b64_tr_b16 v[238:239], v9 offset:9216
  s_cmp_lt_u32 s34, 2
  s_mov_b32 s73, 0xc000
  s_cselect_b32 s73, s73, 0x18000
  v_mfma_f32_16x16x32_bf16 v[120:123], v[252:255], v[192:195], v[120:123]
  ds_read_b64_tr_b16 v[240:241], v10 offset:8192
  v_add_u32 v9, s72, v9
  v_mfma_f32_16x16x32_bf16 v[124:127], v[252:255], v[196:199], v[124:127]
  s_waitcnt lgkmcnt(8)
  ds_read_b64_tr_b16 v[242:243], v10 offset:9216
  s_add_u32 m0, s60, 98304
  s_add_u32 s68, s58, 95232
  buffer_load_dwordx4 v19, s[16:19], s68 offen offset:3072 lds
  v_mfma_f32_16x16x32_bf16 v[64:67], v[224:227], v[200:203], v[64:67]
  ds_read_b64_tr_b16 v[244:245], v11 offset:8192
  v_add_u32 v10, s72, v10
  v_mfma_f32_16x16x32_bf16 v[68:71], v[224:227], v[204:207], v[68:71]
  s_waitcnt lgkmcnt(7)
  ds_read_b64_tr_b16 v[246:247], v11 offset:9216
  v_mfma_f32_16x16x32_bf16 v[72:75], v[228:231], v[200:203], v[72:75]
  ds_read_b64_tr_b16 v[248:249], v12 offset:8192
  v_add_u32 v11, s72, v11
  v_mfma_f32_16x16x32_bf16 v[76:79], v[228:231], v[204:207], v[76:79]
  s_waitcnt lgkmcnt(7)
  ds_read_b64_tr_b16 v[250:251], v12 offset:9216
  v_mfma_f32_16x16x32_bf16 v[80:83], v[232:235], v[200:203], v[80:83]
  ds_read_b64_tr_b16 v[252:253], v13 offset:8192
  v_add_u32 v12, s72, v12
  v_mfma_f32_16x16x32_bf16 v[84:87], v[232:235], v[204:207], v[84:87]
  s_waitcnt lgkmcnt(7)
  ds_read_b64_tr_b16 v[254:255], v13 offset:9216
  v_add_u32 v13, s72, v13
  v_mfma_f32_16x16x32_bf16 v[88:91], v[236:239], v[200:203], v[88:91]
  v_mfma_f32_16x16x32_bf16 v[92:95], v[236:239], v[204:207], v[92:95]
  s_waitcnt lgkmcnt(6)
  v_mfma_f32_16x16x32_bf16 v[96:99], v[240:243], v[200:203], v[96:99]
  v_mfma_f32_16x16x32_bf16 v[100:103], v[240:243], v[204:207], v[100:103]
  s_waitcnt lgkmcnt(4)
  v_mfma_f32_16x16x32_bf16 v[104:107], v[244:247], v[200:203], v[104:107]
  s_waitcnt lgkmcnt(0)
  s_waitcnt vmcnt(8)
  s_barrier
  ds_read_b64_tr_b16 v[224:225], v6 offset:0
  ds_read_b64_tr_b16 v[226:227], v6 offset:1024
  v_mfma_f32_16x16x32_bf16 v[108:111], v[244:247], v[204:207], v[108:111]
  ds_read_b64_tr_b16 v[228:229], v7 offset:0
  ds_read_b64_tr_b16 v[230:231], v7 offset:1024
  v_mfma_f32_16x16x32_bf16 v[112:115], v[248:251], v[200:203], v[112:115]
  ds_read_b64_tr_b16 v[232:233], v8 offset:0
  ds_read_b64_tr_b16 v[234:235], v8 offset:1024
  v_mfma_f32_16x16x32_bf16 v[116:119], v[248:251], v[204:207], v[116:119]
  ds_read_b64_tr_b16 v[236:237], v9 offset:0
  ds_read_b64_tr_b16 v[238:239], v9 offset:1024
  v_mfma_f32_16x16x32_bf16 v[120:123], v[252:255], v[200:203], v[120:123]
  ds_read_b64_tr_b16 v[240:241], v10 offset:0
  v_add_u32 v2, s73, v2
  v_mfma_f32_16x16x32_bf16 v[124:127], v[252:255], v[204:207], v[124:127]
  s_waitcnt lgkmcnt(7)
  ds_read_b64_tr_b16 v[242:243], v10 offset:1024
  v_mfma_f32_16x16x32_bf16 v[64:67], v[224:227], v[208:211], v[64:67]
  ds_read_b64_tr_b16 v[244:245], v11 offset:0
  v_add_u32 v3, s73, v3
  v_mfma_f32_16x16x32_bf16 v[68:71], v[224:227], v[212:215], v[68:71]
  s_waitcnt lgkmcnt(7)
  ds_read_b64_tr_b16 v[246:247], v11 offset:1024
  v_mfma_f32_16x16x32_bf16 v[72:75], v[228:231], v[208:211], v[72:75]
  ds_read_b64_tr_b16 v[248:249], v12 offset:0
  v_add_u32 v4, s73, v4
  v_mfma_f32_16x16x32_bf16 v[76:79], v[228:231], v[212:215], v[76:79]
  s_waitcnt lgkmcnt(7)
  ds_read_b64_tr_b16 v[250:251], v12 offset:1024
  v_mfma_f32_16x16x32_bf16 v[80:83], v[232:235], v[208:211], v[80:83]
  ds_read_b64_tr_b16 v[252:253], v13 offset:0
  v_add_u32 v5, s73, v5
  v_mfma_f32_16x16x32_bf16 v[84:87], v[232:235], v[212:215], v[84:87]
  s_waitcnt lgkmcnt(7)
  ds_read_b64_tr_b16 v[254:255], v13 offset:1024
  s_mov_b32 s72, 0x18000
  v_mfma_f32_16x16x32_bf16 v[88:91], v[236:239], v[208:211], v[88:91]
  ds_read_b64_tr_b16 v[224:225], v6 offset:8192
  v_mfma_f32_16x16x32_bf16 v[92:95], v[236:239], v[212:215], v[92:95]
  s_waitcnt lgkmcnt(7)
  ds_read_b64_tr_b16 v[226:227], v6 offset:9216
  v_mfma_f32_16x16x32_bf16 v[96:99], v[240:243], v[208:211], v[96:99]
  ds_read_b64_tr_b16 v[228:229], v7 offset:8192
  v_add_u32 v6, s72, v6
  v_mfma_f32_16x16x32_bf16 v[100:103], v[240:243], v[212:215], v[100:103]
  s_waitcnt lgkmcnt(7)
  ds_read_b64_tr_b16 v[230:231], v7 offset:9216
  v_mfma_f32_16x16x32_bf16 v[104:107], v[244:247], v[208:211], v[104:107]
  ds_read_b64_tr_b16 v[232:233], v8 offset:8192
  v_add_u32 v7, s72, v7
  v_mfma_f32_16x16x32_bf16 v[108:111], v[244:247], v[212:215], v[108:111]
  s_waitcnt lgkmcnt(7)
  ds_read_b64_tr_b16 v[234:235], v8 offset:9216
  v_mfma_f32_16x16x32_bf16 v[112:115], v[248:251], v[208:211], v[112:115]
  ds_read_b64_tr_b16 v[236:237], v9 offset:8192
  v_add_u32 v8, s72, v8
  v_mfma_f32_16x16x32_bf16 v[116:119], v[248:251], v[212:215], v[116:119]
  s_waitcnt lgkmcnt(7)
  ds_read_b64_tr_b16 v[238:239], v9 offset:9216
  v_mfma_f32_16x16x32_bf16 v[120:123], v[252:255], v[208:211], v[120:123]
  ds_read_b64_tr_b16 v[240:241], v10 offset:8192
  v_add_u32 v9, s72, v9
  v_mfma_f32_16x16x32_bf16 v[124:127], v[252:255], v[212:215], v[124:127]
  s_waitcnt lgkmcnt(7)
  ds_read_b64_tr_b16 v[242:243], v10 offset:9216
  v_mfma_f32_16x16x32_bf16 v[64:67], v[224:227], v[216:219], v[64:67]
  ds_read_b64_tr_b16 v[244:245], v11 offset:8192
  v_add_u32 v10, s72, v10
  v_mfma_f32_16x16x32_bf16 v[68:71], v[224:227], v[220:223], v[68:71]
  s_waitcnt lgkmcnt(7)
  ds_read_b64_tr_b16 v[246:247], v11 offset:9216
  v_mfma_f32_16x16x32_bf16 v[72:75], v[228:231], v[216:219], v[72:75]
  ds_read_b64_tr_b16 v[248:249], v12 offset:8192
  v_add_u32 v11, s72, v11
  v_mfma_f32_16x16x32_bf16 v[76:79], v[228:231], v[220:223], v[76:79]
  s_waitcnt lgkmcnt(7)
  ds_read_b64_tr_b16 v[250:251], v12 offset:9216
  v_mfma_f32_16x16x32_bf16 v[80:83], v[232:235], v[216:219], v[80:83]
  ds_read_b64_tr_b16 v[252:253], v13 offset:8192
  v_add_u32 v12, s72, v12
  v_mfma_f32_16x16x32_bf16 v[84:87], v[232:235], v[220:223], v[84:87]
  s_waitcnt lgkmcnt(7)
  ds_read_b64_tr_b16 v[254:255], v13 offset:9216
  v_add_u32 v13, s72, v13
  v_mfma_f32_16x16x32_bf16 v[88:91], v[236:239], v[216:219], v[88:91]
  v_mfma_f32_16x16x32_bf16 v[92:95], v[236:239], v[220:223], v[92:95]
  s_waitcnt lgkmcnt(6)
  v_mfma_f32_16x16x32_bf16 v[96:99], v[240:243], v[216:219], v[96:99]
  v_mfma_f32_16x16x32_bf16 v[100:103], v[240:243], v[220:223], v[100:103]
  s_waitcnt lgkmcnt(4)
  v_mfma_f32_16x16x32_bf16 v[104:107], v[244:247], v[216:219], v[104:107]
  s_waitcnt lgkmcnt(0)
  s_waitcnt vmcnt(4)
  s_barrier
  ds_read_b128 v[32:35], v2 offset:0
  ds_read_b128 v[36:39], v2 offset:1024
  ds_read_b64_tr_b16 v[224:225], v6 offset:0
  v_mfma_f32_16x16x32_bf16 v[108:111], v[244:247], v[220:223], v[108:111]
  ds_read_b64_tr_b16 v[226:227], v6 offset:1024
  ds_read_b64_tr_b16 v[228:229], v7 offset:0
  ds_read_b64_tr_b16 v[230:231], v7 offset:1024
  v_mfma_f32_16x16x32_bf16 v[112:115], v[248:251], v[216:219], v[112:115]
  ds_read_b64_tr_b16 v[232:233], v8 offset:0
  ds_read_b64_tr_b16 v[234:235], v8 offset:1024
  v_mfma_f32_16x16x32_bf16 v[116:119], v[248:251], v[220:223], v[116:119]
  ds_read_b64_tr_b16 v[236:237], v9 offset:0
  ds_read_b64_tr_b16 v[238:239], v9 offset:1024
  v_mfma_f32_16x16x32_bf16 v[120:123], v[252:255], v[216:219], v[120:123]
  ds_read_b128 v[40:43], v3 offset:0
  ds_read_b64_tr_b16 v[240:241], v10 offset:0
  v_mfma_f32_16x16x32_bf16 v[124:127], v[252:255], v[220:223], v[124:127]
  s_waitcnt lgkmcnt(8)
  ds_read_b64_tr_b16 v[242:243], v10 offset:1024
  v_mfma_f32_16x16x32_bf16 v[64:67], v[224:227], v[32:35], v[64:67]
  ds_read_b128 v[44:47], v3 offset:1024
  ds_read_b64_tr_b16 v[244:245], v11 offset:0
  v_mfma_f32_16x16x32_bf16 v[68:71], v[224:227], v[36:39], v[68:71]
  s_waitcnt lgkmcnt(9)
  ds_read_b64_tr_b16 v[246:247], v11 offset:1024
  v_mfma_f32_16x16x32_bf16 v[72:75], v[228:231], v[32:35], v[72:75]
  ds_read_b128 v[48:51], v4 offset:0
  ds_read_b64_tr_b16 v[248:249], v12 offset:0
  v_mfma_f32_16x16x32_bf16 v[76:79], v[228:231], v[36:39], v[76:79]
  s_waitcnt lgkmcnt(10)
  ds_read_b64_tr_b16 v[250:251], v12 offset:1024
  v_mfma_f32_16x16x32_bf16 v[80:83], v[232:235], v[32:35], v[80:83]
  ds_read_b128 v[52:55], v4 offset:1024
  ds_read_b64_tr_b16 v[252:253], v13 offset:0
  v_mfma_f32_16x16x32_bf16 v[84:87], v[232:235], v[36:39], v[84:87]
  s_waitcnt lgkmcnt(11)
  ds_read_b64_tr_b16 v[254:255], v13 offset:1024
  s_mov_b32 s72, 0xffff4000
  v_mfma_f32_16x16x32_bf16 v[88:91], v[236:239], v[32:35], v[88:91]
  ds_read_b128 v[56:59], v5 offset:0
  ds_read_b64_tr_b16 v[224:225], v6 offset:8192
  v_mfma_f32_16x16x32_bf16 v[92:95], v[236:239], v[36:39], v[92:95]
  s_waitcnt lgkmcnt(11)
  ds_read_b64_tr_b16 v[226:227], v6 offset:9216
  v_mfma_f32_16x16x32_bf16 v[96:99], v[240:243], v[32:35], v[96:99]
  ds_read_b128 v[60:63], v5 offset:1024
  ds_read_b64_tr_b16 v[228:229], v7 offset:8192
  v_mfma_f32_16x16x32_bf16 v[100:103], v[240:243], v[36:39], v[100:103]
  s_waitcnt lgkmcnt(11)
  ds_read_b64_tr_b16 v[230:231], v7 offset:9216
  v_add_u32 v6, s72, v6
  v_mfma_f32_16x16x32_bf16 v[104:107], v[244:247], v[32:35], v[104:107]
  ds_read_b64_tr_b16 v[232:233], v8 offset:8192
  v_add_u32 v7, s72, v7
  v_mfma_f32_16x16x32_bf16 v[108:111], v[244:247], v[36:39], v[108:111]
  s_waitcnt lgkmcnt(10)
  ds_read_b64_tr_b16 v[234:235], v8 offset:9216
  v_mfma_f32_16x16x32_bf16 v[112:115], v[248:251], v[32:35], v[112:115]
  ds_read_b64_tr_b16 v[236:237], v9 offset:8192
  v_add_u32 v8, s72, v8
  v_mfma_f32_16x16x32_bf16 v[116:119], v[248:251], v[36:39], v[116:119]
  s_waitcnt lgkmcnt(9)
  ds_read_b64_tr_b16 v[238:239], v9 offset:9216
  s_cmp_lt_u32 s34, 2
  s_mov_b32 s73, 0xfffe4000
  s_cselect_b32 s73, s73, 0xfffe0000
  s_sub_u32 s73, s73, s44
  v_mfma_f32_16x16x32_bf16 v[120:123], v[252:255], v[32:35], v[120:123]
  ds_read_b64_tr_b16 v[240:241], v10 offset:8192
  v_add_u32 v9, s72, v9
  v_mfma_f32_16x16x32_bf16 v[124:127], v[252:255], v[36:39], v[124:127]
  s_waitcnt lgkmcnt(8)
  ds_read_b64_tr_b16 v[242:243], v10 offset:9216
  v_mfma_f32_16x16x32_bf16 v[64:67], v[224:227], v[40:43], v[64:67]
  ds_read_b64_tr_b16 v[244:245], v11 offset:8192
  v_add_u32 v10, s72, v10
  v_mfma_f32_16x16x32_bf16 v[68:71], v[224:227], v[44:47], v[68:71]
  s_waitcnt lgkmcnt(7)
  ds_read_b64_tr_b16 v[246:247], v11 offset:9216
  v_mfma_f32_16x16x32_bf16 v[72:75], v[228:231], v[40:43], v[72:75]
  ds_read_b64_tr_b16 v[248:249], v12 offset:8192
  v_add_u32 v11, s72, v11
  v_mfma_f32_16x16x32_bf16 v[76:79], v[228:231], v[44:47], v[76:79]
  s_waitcnt lgkmcnt(7)
  ds_read_b64_tr_b16 v[250:251], v12 offset:9216
  v_mfma_f32_16x16x32_bf16 v[80:83], v[232:235], v[40:43], v[80:83]
  ds_read_b64_tr_b16 v[252:253], v13 offset:8192
  v_add_u32 v12, s72, v12
  v_mfma_f32_16x16x32_bf16 v[84:87], v[232:235], v[44:47], v[84:87]
  s_waitcnt lgkmcnt(7)
  ds_read_b64_tr_b16 v[254:255], v13 offset:9216
  v_add_u32 v13, s72, v13
  v_mfma_f32_16x16x32_bf16 v[88:91], v[236:239], v[40:43], v[88:91]
  v_mfma_f32_16x16x32_bf16 v[92:95], v[236:239], v[44:47], v[92:95]
  s_waitcnt lgkmcnt(6)
  v_mfma_f32_16x16x32_bf16 v[96:99], v[240:243], v[40:43], v[96:99]
  v_mfma_f32_16x16x32_bf16 v[100:103], v[240:243], v[44:47], v[100:103]
  s_waitcnt lgkmcnt(4)
  v_mfma_f32_16x16x32_bf16 v[104:107], v[244:247], v[40:43], v[104:107]
  s_waitcnt lgkmcnt(0)
  s_waitcnt vmcnt(0)
  s_barrier
  ds_read_b64_tr_b16 v[224:225], v6 offset:0
  ds_read_b64_tr_b16 v[226:227], v6 offset:1024
  v_mfma_f32_16x16x32_bf16 v[108:111], v[244:247], v[44:47], v[108:111]
  ds_read_b64_tr_b16 v[228:229], v7 offset:0
  ds_read_b64_tr_b16 v[230:231], v7 offset:1024
  v_mfma_f32_16x16x32_bf16 v[112:115], v[248:251], v[40:43], v[112:115]
  ds_read_b64_tr_b16 v[232:233], v8 offset:0
  ds_read_b64_tr_b16 v[234:235], v8 offset:1024
  v_mfma_f32_16x16x32_bf16 v[116:119], v[248:251], v[44:47], v[116:119]
  ds_read_b64_tr_b16 v[236:237], v9 offset:0
  ds_read_b64_tr_b16 v[238:239], v9 offset:1024
  v_mfma_f32_16x16x32_bf16 v[120:123], v[252:255], v[40:43], v[120:123]
  ds_read_b64_tr_b16 v[240:241], v10 offset:0
  v_add_u32 v2, s73, v2
  v_mfma_f32_16x16x32_bf16 v[124:127], v[252:255], v[44:47], v[124:127]
  s_waitcnt lgkmcnt(7)
  ds_read_b64_tr_b16 v[242:243], v10 offset:1024
  v_mfma_f32_16x16x32_bf16 v[64:67], v[224:227], v[48:51], v[64:67]
  ds_read_b64_tr_b16 v[244:245], v11 offset:0
  v_add_u32 v3, s73, v3
  v_mfma_f32_16x16x32_bf16 v[68:71], v[224:227], v[52:55], v[68:71]
  s_waitcnt lgkmcnt(7)
  ds_read_b64_tr_b16 v[246:247], v11 offset:1024
  v_mfma_f32_16x16x32_bf16 v[72:75], v[228:231], v[48:51], v[72:75]
  ds_read_b64_tr_b16 v[248:249], v12 offset:0
  v_add_u32 v4, s73, v4
  v_mfma_f32_16x16x32_bf16 v[76:79], v[228:231], v[52:55], v[76:79]
  s_waitcnt lgkmcnt(7)
  ds_read_b64_tr_b16 v[250:251], v12 offset:1024
  v_mfma_f32_16x16x32_bf16 v[80:83], v[232:235], v[48:51], v[80:83]
  ds_read_b64_tr_b16 v[252:253], v13 offset:0
  v_add_u32 v5, s73, v5
  v_mfma_f32_16x16x32_bf16 v[84:87], v[232:235], v[52:55], v[84:87]
  s_waitcnt lgkmcnt(7)
  ds_read_b64_tr_b16 v[254:255], v13 offset:1024
  s_mov_b32 s72, 0xffff8000
  v_mfma_f32_16x16x32_bf16 v[88:91], v[236:239], v[48:51], v[88:91]
  ds_read_b64_tr_b16 v[224:225], v6 offset:8192
  v_mfma_f32_16x16x32_bf16 v[92:95], v[236:239], v[52:55], v[92:95]
  s_waitcnt lgkmcnt(7)
  ds_read_b64_tr_b16 v[226:227], v6 offset:9216
  v_mfma_f32_16x16x32_bf16 v[96:99], v[240:243], v[48:51], v[96:99]
  ds_read_b64_tr_b16 v[228:229], v7 offset:8192
  v_add_u32 v6, s72, v6
  v_mfma_f32_16x16x32_bf16 v[100:103], v[240:243], v[52:55], v[100:103]
  s_waitcnt lgkmcnt(7)
  ds_read_b64_tr_b16 v[230:231], v7 offset:9216
  v_mfma_f32_16x16x32_bf16 v[104:107], v[244:247], v[48:51], v[104:107]
  ds_read_b64_tr_b16 v[232:233], v8 offset:8192
  v_add_u32 v7, s72, v7
  v_mfma_f32_16x16x32_bf16 v[108:111], v[244:247], v[52:55], v[108:111]
  s_waitcnt lgkmcnt(7)
  ds_read_b64_tr_b16 v[234:235], v8 offset:9216
  v_mfma_f32_16x16x32_bf16 v[112:115], v[248:251], v[48:51], v[112:115]
  ds_read_b64_tr_b16 v[236:237], v9 offset:8192
  v_add_u32 v8, s72, v8
  v_mfma_f32_16x16x32_bf16 v[116:119], v[248:251], v[52:55], v[116:119]
  s_waitcnt lgkmcnt(7)
  ds_read_b64_tr_b16 v[238:239], v9 offset:9216
  v_mfma_f32_16x16x32_bf16 v[120:123], v[252:255], v[48:51], v[120:123]
  ds_read_b64_tr_b16 v[240:241], v10 offset:8192
  v_add_u32 v9, s72, v9
  v_mfma_f32_16x16x32_bf16 v[124:127], v[252:255], v[52:55], v[124:127]
  s_waitcnt lgkmcnt(7)
  ds_read_b64_tr_b16 v[242:243], v10 offset:9216
  v_mfma_f32_16x16x32_bf16 v[64:67], v[224:227], v[56:59], v[64:67]
  ds_read_b64_tr_b16 v[244:245], v11 offset:8192
  v_add_u32 v10, s72, v10
  v_mfma_f32_16x16x32_bf16 v[68:71], v[224:227], v[60:63], v[68:71]
  s_waitcnt lgkmcnt(7)
  ds_read_b64_tr_b16 v[246:247], v11 offset:9216
  v_mfma_f32_16x16x32_bf16 v[72:75], v[228:231], v[56:59], v[72:75]
  ds_read_b64_tr_b16 v[248:249], v12 offset:8192
  v_add_u32 v11, s72, v11
  v_mfma_f32_16x16x32_bf16 v[76:79], v[228:231], v[60:63], v[76:79]
  s_waitcnt lgkmcnt(7)
  ds_read_b64_tr_b16 v[250:251], v12 offset:9216
  v_mfma_f32_16x16x32_bf16 v[80:83], v[232:235], v[56:59], v[80:83]
  ds_read_b64_tr_b16 v[252:253], v13 offset:8192
  v_add_u32 v12, s72, v12
  v_mfma_f32_16x16x32_bf16 v[84:87], v[232:235], v[60:63], v[84:87]
  s_waitcnt lgkmcnt(7)
  ds_read_b64_tr_b16 v[254:255], v13 offset:9216
  v_add_u32 v13, s72, v13
  v_mfma_f32_16x16x32_bf16 v[88:91], v[236:239], v[56:59], v[88:91]
  v_mfma_f32_16x16x32_bf16 v[92:95], v[236:239], v[60:63], v[92:95]
  s_waitcnt lgkmcnt(6)
  v_mfma_f32_16x16x32_bf16 v[96:99], v[240:243], v[56:59], v[96:99]
  v_mfma_f32_16x16x32_bf16 v[100:103], v[240:243], v[60:63], v[100:103]
  s_waitcnt lgkmcnt(4)
  v_mfma_f32_16x16x32_bf16 v[104:107], v[244:247], v[56:59], v[104:107]
  s_waitcnt lgkmcnt(0)
  s_barrier
  v_mfma_f32_16x16x32_bf16 v[108:111], v[244:247], v[60:63], v[108:111]
  v_mfma_f32_16x16x32_bf16 v[112:115], v[248:251], v[56:59], v[112:115]
  v_mfma_f32_16x16x32_bf16 v[116:119], v[248:251], v[60:63], v[116:119]
  v_mfma_f32_16x16x32_bf16 v[120:123], v[252:255], v[56:59], v[120:123]
  v_mfma_f32_16x16x32_bf16 v[124:127], v[252:255], v[60:63], v[124:127]
  s_mov_b32 s90, 0x3e0293ee
  s_mov_b32 s91, 0x3e0293ee
  s_nop 3
  v_mul_f32 v64, s90, v64
  v_mul_f32 v65, s90, v65
  v_mul_f32 v66, s90, v66
  v_mul_f32 v67, s90, v67
  v_cvt_pk_bf16_f32 v32, v64, v65
  v_cvt_pk_bf16_f32 v33, v66, v67
  v_mul_f32 v72, s90, v72
  v_mul_f32 v73, s90, v73
  v_mul_f32 v74, s90, v74
  v_mul_f32 v75, s90, v75
  v_cvt_pk_bf16_f32 v34, v72, v73
  v_cvt_pk_bf16_f32 v35, v74, v75
  v_mul_f32 v68, s90, v68
  v_mul_f32 v69, s90, v69
  v_mul_f32 v70, s90, v70
  v_mul_f32 v71, s90, v71
  v_cvt_pk_bf16_f32 v36, v68, v69
  v_cvt_pk_bf16_f32 v37, v70, v71
  v_mul_f32 v76, s90, v76
  v_mul_f32 v77, s90, v77
  v_mul_f32 v78, s90, v78
  v_mul_f32 v79, s90, v79
  v_cvt_pk_bf16_f32 v38, v76, v77
  v_cvt_pk_bf16_f32 v39, v78, v79
  v_mul_f32 v80, s90, v80
  v_mul_f32 v81, s90, v81
  v_mul_f32 v82, s90, v82
  v_mul_f32 v83, s90, v83
  v_cvt_pk_bf16_f32 v40, v80, v81
  v_cvt_pk_bf16_f32 v41, v82, v83
  v_mul_f32 v88, s90, v88
  v_mul_f32 v89, s90, v89
  v_mul_f32 v90, s90, v90
  v_mul_f32 v91, s90, v91
  v_cvt_pk_bf16_f32 v42, v88, v89
  v_cvt_pk_bf16_f32 v43, v90, v91
  v_mul_f32 v84, s90, v84
  v_mul_f32 v85, s90, v85
  v_mul_f32 v86, s90, v86
  v_mul_f32 v87, s90, v87
  v_cvt_pk_bf16_f32 v44, v84, v85
  v_cvt_pk_bf16_f32 v45, v86, v87
  v_mul_f32 v92, s90, v92
  v_mul_f32 v93, s90, v93
  v_mul_f32 v94, s90, v94
  v_mul_f32 v95, s90, v95
  v_cvt_pk_bf16_f32 v46, v92, v93
  v_cvt_pk_bf16_f32 v47, v94, v95
  v_mul_f32 v96, s90, v96
  v_mul_f32 v97, s90, v97
  v_mul_f32 v98, s90, v98
  v_mul_f32 v99, s90, v99
  v_cvt_pk_bf16_f32 v48, v96, v97
  v_cvt_pk_bf16_f32 v49, v98, v99
  v_mul_f32 v104, s90, v104
  v_mul_f32 v105, s90, v105
  v_mul_f32 v106, s90, v106
  v_mul_f32 v107, s90, v107
  v_cvt_pk_bf16_f32 v50, v104, v105
  v_cvt_pk_bf16_f32 v51, v106, v107
  v_mul_f32 v100, s90, v100
  v_mul_f32 v101, s90, v101
  v_mul_f32 v102, s90, v102
  v_mul_f32 v103, s90, v103
  v_cvt_pk_bf16_f32 v52, v100, v101
  v_cvt_pk_bf16_f32 v53, v102, v103
  v_mul_f32 v108, s90, v108
  v_mul_f32 v109, s90, v109
  v_mul_f32 v110, s90, v110
  v_mul_f32 v111, s90, v111
  v_cvt_pk_bf16_f32 v54, v108, v109
  v_cvt_pk_bf16_f32 v55, v110, v111
  v_mul_f32 v112, s90, v112
  v_mul_f32 v113, s90, v113
  v_mul_f32 v114, s90, v114
  v_mul_f32 v115, s90, v115
  v_cvt_pk_bf16_f32 v56, v112, v113
  v_cvt_pk_bf16_f32 v57, v114, v115
  v_mul_f32 v120, s90, v120
  v_mul_f32 v121, s90, v121
  v_mul_f32 v122, s90, v122
  v_mul_f32 v123, s90, v123
  v_cvt_pk_bf16_f32 v58, v120, v121
  v_cvt_pk_bf16_f32 v59, v122, v123
  v_mul_f32 v116, s90, v116
  v_mul_f32 v117, s90, v117
  v_mul_f32 v118, s90, v118
  v_mul_f32 v119, s90, v119
  v_cvt_pk_bf16_f32 v60, v116, v117
  v_cvt_pk_bf16_f32 v61, v118, v119
  v_mul_f32 v124, s90, v124
  v_mul_f32 v125, s90, v125
  v_mul_f32 v126, s90, v126
  v_mul_f32 v127, s90, v127
  v_cvt_pk_bf16_f32 v62, v124, v125
  v_cvt_pk_bf16_f32 v63, v126, v127
  v_permlane32_swap_b32 v32, v34
  v_permlane32_swap_b32 v33, v35
  v_permlane32_swap_b32 v36, v38
  v_permlane32_swap_b32 v37, v39
  v_permlane32_swap_b32 v40, v42
  v_permlane32_swap_b32 v41, v43
  v_permlane32_swap_b32 v44, v46
  v_permlane32_swap_b32 v45, v47
  v_permlane32_swap_b32 v48, v50
  v_permlane32_swap_b32 v49, v51
  v_permlane32_swap_b32 v52, v54
  v_permlane32_swap_b32 v53, v55
  v_permlane32_swap_b32 v56, v58
  v_permlane32_swap_b32 v57, v59
  v_permlane32_swap_b32 v60, v62
  v_permlane32_swap_b32 v61, v63
  v_permlane16_swap_b32 v32, v34
  v_permlane16_swap_b32 v33, v35
  v_permlane16_swap_b32 v36, v38
  v_permlane16_swap_b32 v37, v39
  v_permlane16_swap_b32 v40, v42
  v_permlane16_swap_b32 v41, v43
  v_permlane16_swap_b32 v44, v46
  v_permlane16_swap_b32 v45, v47
  v_permlane16_swap_b32 v48, v50
  v_permlane16_swap_b32 v49, v51
  v_permlane16_swap_b32 v52, v54
  v_permlane16_swap_b32 v53, v55
  v_permlane16_swap_b32 v56, v58
  v_permlane16_swap_b32 v57, v59
  v_permlane16_swap_b32 v60, v62
  v_permlane16_swap_b32 v61, v63
L_att_entry:
  ds_read_b128 v[192:195], v2 offset:0
  ds_read_b128 v[196:199], v3 offset:0
  ds_read_b128 v[200:203], v4 offset:0
  ds_read_b128 v[204:207], v5 offset:0
  ds_read_b128 v[208:211], v2 offset:1024
  ds_read_b128 v[212:215], v3 offset:1024
  ds_read_b128 v[216:219], v4 offset:1024
  ds_read_b128 v[220:223], v5 offset:1024
  v_mov_b64 v[64:65], 0
  v_mov_b64 v[66:67], 0
  v_mov_b64 v[68:69], 0
  v_mov_b64 v[70:71], 0
  v_mov_b64 v[72:73], 0
  v_mov_b64 v[74:75], 0
  v_mov_b64 v[76:77], 0
  v_mov_b64 v[78:79], 0
  v_mov_b64 v[80:81], 0
  v_mov_b64 v[82:83], 0
  v_mov_b64 v[84:85], 0
  v_mov_b64 v[86:87], 0
  v_mov_b64 v[88:89], 0
  v_mov_b64 v[90:91], 0
  v_mov_b64 v[92:93], 0
  v_mov_b64 v[94:95], 0
  v_mov_b64 v[96:97], 0
  v_mov_b64 v[98:99], 0
  v_mov_b64 v[100:101], 0
  v_mov_b64 v[102:103], 0
  v_mov_b64 v[104:105], 0
  v_mov_b64 v[106:107], 0
  v_mov_b64 v[108:109], 0
  v_mov_b64 v[110:111], 0
  v_mov_b64 v[112:113], 0
  v_mov_b64 v[114:115], 0
  v_mov_b64 v[116:117], 0
  v_mov_b64 v[118:119], 0
  v_mov_b64 v[120:121], 0
  v_mov_b64 v[122:123], 0
  v_mov_b64 v[124:125], 0
  v_mov_b64 v[126:127], 0
  v_mov_b64 v[136:137], 0
  v_mov_b64 v[138:139], 0
  v_mov_b64 v[140:141], 0
  v_mov_b64 v[142:143], 0
  v_mov_b64 v[184:185], 0
  v_mov_b64 v[186:187], 0
  v_mov_b64 v[188:189], 0
  v_mov_b64 v[190:191], 0
  v_mov_b64 v[240:241], 0
  v_mov_b64 v[242:243], 0
  v_mov_b64 v[244:245], 0
  v_mov_b64 v[246:247], 0
  v_mov_b64 v[248:249], 0
  v_mov_b64 v[250:251], 0
  v_mov_b64 v[252:253], 0
  v_mov_b64 v[254:255], 0
  v_mov_b32 v20, 0x3f803f80
  v_mov_b32 v21, 0x3f803f80
  v_mov_b32 v22, 0x3f803f80
  v_mov_b32 v23, 0x3f803f80
  s_waitcnt lgkmcnt(4)
  v_mfma_f32_16x16x32_bf16 v[144:147], v[192:195], v[32:35], 0
  v_mfma_f32_16x16x32_bf16 v[148:151], v[192:195], v[36:39], 0
  v_mfma_f32_16x16x32_bf16 v[144:147], v[196:199], v[40:43], v[144:147]
  v_mfma_f32_16x16x32_bf16 v[148:151], v[196:199], v[44:47], v[148:151]
  v_mfma_f32_16x16x32_bf16 v[144:147], v[200:203], v[48:51], v[144:147]
  v_mfma_f32_16x16x32_bf16 v[148:151], v[200:203], v[52:55], v[148:151]
  v_mfma_f32_16x16x32_bf16 v[144:147], v[204:207], v[56:59], v[144:147]
  v_mfma_f32_16x16x32_bf16 v[148:151], v[204:207], v[60:63], v[148:151]
  s_waitcnt lgkmcnt(0)
  v_mfma_f32_16x16x32_bf16 v[152:155], v[208:211], v[32:35], 0
  v_mfma_f32_16x16x32_bf16 v[156:159], v[208:211], v[36:39], 0
  v_mfma_f32_16x16x32_bf16 v[152:155], v[212:215], v[40:43], v[152:155]
  v_mfma_f32_16x16x32_bf16 v[156:159], v[212:215], v[44:47], v[156:159]
  v_mfma_f32_16x16x32_bf16 v[152:155], v[216:219], v[48:51], v[152:155]
  v_mfma_f32_16x16x32_bf16 v[156:159], v[216:219], v[52:55], v[156:159]
  v_mfma_f32_16x16x32_bf16 v[152:155], v[220:223], v[56:59], v[152:155]
  v_mfma_f32_16x16x32_bf16 v[156:159], v[220:223], v[60:63], v[156:159]
  ds_read_b128 v[192:195], v2 offset:8192
  ds_read_b128 v[196:199], v3 offset:8192
  ds_read_b128 v[200:203], v4 offset:8192
  ds_read_b128 v[204:207], v5 offset:8192
  s_mov_b32 s62, 0
  s_nop 3
  v_max3_f32 v24, v144, v145, v146
  v_max3_f32 v24, v24, v147, v152
  v_max3_f32 v24, v24, v153, v154
  v_max_f32 v24, v24, v155
  v_max3_f32 v25, v148, v149, v150
  v_max3_f32 v25, v25, v151, v156
  v_max3_f32 v25, v25, v157, v158
  v_max_f32 v25, v25, v159
  v_mov_b32 v26, v24
  v_mov_b32 v27, v25
  s_nop 1
  v_permlane32_swap_b32 v24, v26
  v_permlane32_swap_b32 v25, v27
  v_max_f32 v24, v24, v26
  v_max_f32 v25, v25, v27
  v_mov_b32 v26, v24
  v_mov_b32 v27, v25
  s_nop 1
  v_permlane16_swap_b32 v24, v26
  v_permlane16_swap_b32 v25, v27
  v_max_f32 v24, v24, v26
  v_max_f32 v25, v25, v27
  v_add_f32 v24, s67, v24
  v_add_f32 v25, s67, v25
  v_sub_f32 v128, 0, v24
  v_sub_f32 v129, 0, v24
  v_sub_f32 v130, 0, v24
  v_sub_f32 v131, 0, v24
  v_sub_f32 v132, 0, v25
  v_sub_f32 v133, 0, v25
  v_sub_f32 v134, 0, v25
  v_sub_f32 v135, 0, v25
  v_sub_f32 v144, v144, v24
  v_sub_f32 v145, v145, v24
  v_sub_f32 v146, v146, v24
  v_sub_f32 v147, v147, v24
  v_sub_f32 v148, v148, v25
  v_sub_f32 v149, v149, v25
  v_sub_f32 v150, v150, v25
  v_sub_f32 v151, v151, v25
  v_sub_f32 v152, v152, v24
  v_sub_f32 v153, v153, v24
  v_sub_f32 v154, v154, v24
  v_sub_f32 v155, v155, v24
  v_sub_f32 v156, v156, v25
  v_sub_f32 v157, v157, v25
  v_sub_f32 v158, v158, v25
  v_sub_f32 v159, v159, v25
  s_waitcnt lgkmcnt(3)
  v_mfma_f32_16x16x32_bf16 v[160:163], v[192:195], v[32:35], v[128:131]
  v_exp_f32 v24, v144
  v_mfma_f32_16x16x32_bf16 v[164:167], v[192:195], v[36:39], v[132:135]
  s_waitcnt lgkmcnt(2)
  v_exp_f32 v25, v145
  ds_read_b128 v[208:211], v2 offset:9216
  v_cvt_pk_bf16_f32 v176, v24, v25
  v_mfma_f32_16x16x32_bf16 v[160:163], v[196:199], v[40:43], v[160:163]
  v_exp_f32 v24, v146
  v_mfma_f32_16x16x32_bf16 v[164:167], v[196:199], v[44:47], v[164:167]
  s_waitcnt lgkmcnt(2)
  v_exp_f32 v25, v147
  ds_read_b128 v[212:215], v3 offset:9216
  v_cvt_pk_bf16_f32 v177, v24, v25
  v_mfma_f32_16x16x32_bf16 v[160:163], v[200:203], v[48:51], v[160:163]
  v_exp_f32 v24, v148
  v_mfma_f32_16x16x32_bf16 v[164:167], v[200:203], v[52:55], v[164:167]
  s_waitcnt lgkmcnt(2)
  v_exp_f32 v25, v149
  ds_read_b128 v[216:219], v4 offset:9216
  v_cvt_pk_bf16_f32 v180, v24, v25
  v_mfma_f32_16x16x32_bf16 v[160:163], v[204:207], v[56:59], v[160:163]
  v_exp_f32 v24, v150
  v_mfma_f32_16x16x32_bf16 v[164:167], v[204:207], v[60:63], v[164:167]
  s_waitcnt lgkmcnt(2)
  v_exp_f32 v25, v151
  ds_read_b128 v[220:223], v5 offset:9216
  v_cvt_pk_bf16_f32 v181, v24, v25
.p2align 3
L_att_loop:
  v_mfma_f32_16x16x32_bf16 v[168:171], v[208:211], v[32:35], v[128:131]
  v_exp_f32 v24, v152
  v_mfma_f32_16x16x32_bf16 v[172:175], v[208:211], v[36:39], v[132:135]
  s_waitcnt lgkmcnt(0)
  s_waitcnt vmcnt(8)
  s_barrier
  ds_read_b64_tr_b16 v[224:225], v6 offset:0
  ds_read_b64_tr_b16 v[226:227], v6 offset:1024
  v_mfma_f32_16x16x32_bf16 v[96:99], v[240:243], v[184:187], v[96:99]
  v_exp_f32 v25, v153
  v_mfma_f32_16x16x32_bf16 v[100:103], v[240:243], v[188:191], v[100:103]
  ds_read_b128 v[192:195], v2 offset:16384
  v_cvt_pk_bf16_f32 v178, v24, v25
  v_mfma_f32_16x16x32_bf16 v[168:171], v[212:215], v[40:43], v[168:171]
  v_exp_f32 v24, v154
  v_mfma_f32_16x16x32_bf16 v[172:175], v[212:215], v[44:47], v[172:175]
  ds_read_b64_tr_b16 v[228:229], v7 offset:0
  ds_read_b64_tr_b16 v[230:231], v7 offset:1024
  v_mfma_f32_16x16x32_bf16 v[104:107], v[244:247], v[184:187], v[104:107]
  v_exp_f32 v25, v155
  v_mfma_f32_16x16x32_bf16 v[108:111], v[244:247], v[188:191], v[108:111]
  ds_read_b128 v[196:199], v3 offset:16384
  v_cvt_pk_bf16_f32 v179, v24, v25
  v_mfma_f32_16x16x32_bf16 v[140:143], v[20:23], v[188:191], v[140:143]
  v_or3_b32 v28, v176, v177, v180
  v_or3_b32 v28, v28, v181, v178
  v_mfma_f32_16x16x32_bf16 v[168:171], v[216:219], v[48:51], v[168:171]
  v_exp_f32 v24, v156
  v_mfma_f32_16x16x32_bf16 v[172:175], v[216:219], v[52:55], v[172:175]
  ds_read_b64_tr_b16 v[232:233], v8 offset:0
  ds_read_b64_tr_b16 v[234:235], v8 offset:1024
  v_mfma_f32_16x16x32_bf16 v[112:115], v[248:251], v[184:187], v[112:115]
  v_exp_f32 v25, v157
  v_mfma_f32_16x16x32_bf16 v[116:119], v[248:251], v[188:191], v[116:119]
  ds_read_b128 v[200:203], v4 offset:16384
  v_cvt_pk_bf16_f32 v182, v24, v25
  v_mfma_f32_16x16x32_bf16 v[168:171], v[220:223], v[56:59], v[168:171]
  v_exp_f32 v24, v158
  v_mfma_f32_16x16x32_bf16 v[172:175], v[220:223], v[60:63], v[172:175]
  s_waitcnt lgkmcnt(6)
  v_exp_f32 v25, v159
  v_mfma_f32_16x16x32_bf16 v[120:123], v[252:255], v[184:187], v[120:123]
  ds_read_b128 v[204:207], v5 offset:16384
  v_or3_b32 v28, v28, v179, v182
  v_mfma_f32_16x16x32_bf16 v[124:127], v[252:255], v[188:191], v[124:127]
  v_cvt_pk_bf16_f32 v183, v24, v25
  v_bitop3_b32 v28, v28, v183, s49 bitop3:0xa8
  v_cmp_ne_u32 vcc, 0, v28
  v_mfma_f32_16x16x32_bf16 v[136:139], v[20:23], v[184:187], v[136:139]
  ds_read_b64_tr_b16 v[236:237], v9 offset:0
  ds_read_b64_tr_b16 v[238:239], v9 offset:1024
  s_cbranch_vccnz L_sta0
L_oka0:
  v_mfma_f32_16x16x32_bf16 v[144:147], v[192:195], v[32:35], v[128:131]
  v_exp_f32 v24, v160
  v_mfma_f32_16x16x32_bf16 v[148:151], v[192:195], v[36:39], v[132:135]
  ds_read_b64_tr_b16 v[240:241], v10 offset:0
  ds_read_b64_tr_b16 v[242:243], v10 offset:1024
  v_mfma_f32_16x16x32_bf16 v[64:67], v[224:227], v[176:179], v[64:67]
  s_waitcnt lgkmcnt(8)
  v_exp_f32 v25, v161
  v_mfma_f32_16x16x32_bf16 v[68:71], v[224:227], v[180:183], v[68:71]
  ds_read_b128 v[208:211], v2 offset:17408
  v_cvt_pk_bf16_f32 v184, v24, v25
  v_mfma_f32_16x16x32_bf16 v[144:147], v[196:199], v[40:43], v[144:147]
  v_exp_f32 v24, v162
  v_mfma_f32_16x16x32_bf16 v[148:151], v[196:199], v[44:47], v[148:151]
  ds_read_b64_tr_b16 v[244:245], v11 offset:0
  ds_read_b64_tr_b16 v[246:247], v11 offset:1024
  v_mfma_f32_16x16x32_bf16 v[72:75], v[228:231], v[176:179], v[72:75]
  s_waitcnt lgkmcnt(8)
  v_exp_f32 v25, v163
  v_mfma_f32_16x16x32_bf16 v[76:79], v[228:231], v[180:183], v[76:79]
  ds_read_b128 v[212:215], v3 offset:17408
  v_cvt_pk_bf16_f32 v185, v24, v25
  v_mfma_f32_16x16x32_bf16 v[144:147], v[200:203], v[48:51], v[144:147]
  v_exp_f32 v24, v164
  v_mfma_f32_16x16x32_bf16 v[148:151], v[200:203], v[52:55], v[148:151]
  ds_read_b64_tr_b16 v[248:249], v12 offset:0
  ds_read_b64_tr_b16 v[250:251], v12 offset:1024
  v_mfma_f32_16x16x32_bf16 v[80:83], v[232:235], v[176:179], v[80:83]
  s_waitcnt lgkmcnt(8)
  v_exp_f32 v25, v165
  v_mfma_f32_16x16x32_bf16 v[84:87], v[232:235], v[180:183], v[84:87]
  ds_read_b128 v[216:219], v4 offset:17408
  v_cvt_pk_bf16_f32 v188, v24, v25
  v_mfma_f32_16x16x32_bf16 v[144:147], v[204:207], v[56:59], v[144:147]
  v_exp_f32 v24, v166
  v_mfma_f32_16x16x32_bf16 v[148:151], v[204:207], v[60:63], v[148:151]
  ds_read_b64_tr_b16 v[252:253], v13 offset:0
  ds_read_b64_tr_b16 v[254:255], v13 offset:1024
  v_mfma_f32_16x16x32_bf16 v[88:91], v[236:239], v[176:179], v[88:91]
  s_waitcnt lgkmcnt(8)
  v_exp_f32 v25, v167
  v_mfma_f32_16x16x32_bf16 v[92:95], v[236:239], v[180:183], v[92:95]
  ds_read_b128 v[220:223], v5 offset:17408
  v_cvt_pk_bf16_f32 v189, v24, v25
  v_mfma_f32_16x16x32_bf16 v[152:155], v[208:211], v[32:35], v[128:131]
  v_exp_f32 v24, v168
  v_mfma_f32_16x16x32_bf16 v[156:159], v[208:211], v[36:39], v[132:135]
  ds_read_b64_tr_b16 v[224:225], v6 offset:8192
  ds_read_b64_tr_b16 v[226:227], v6 offset:9216
  v_mfma_f32_16x16x32_bf16 v[96:99], v[240:243], v[176:179], v[96:99]
  s_waitcnt lgkmcnt(8)
  v_exp_f32 v25, v169
  v_mfma_f32_16x16x32_bf16 v[100:103], v[240:243], v[180:183], v[100:103]
  ds_read_b128 v[192:195], v2 offset:24576
  v_cvt_pk_bf16_f32 v186, v24, v25
  v_mfma_f32_16x16x32_bf16 v[152:155], v[212:215], v[40:43], v[152:155]
  v_exp_f32 v24, v170
  v_mfma_f32_16x16x32_bf16 v[156:159], v[212:215], v[44:47], v[156:159]
  ds_read_b64_tr_b16 v[228:229], v7 offset:8192
  ds_read_b64_tr_b16 v[230:231], v7 offset:9216
  v_mfma_f32_16x16x32_bf16 v[104:107], v[244:247], v[176:179], v[104:107]
  s_waitcnt lgkmcnt(8)
  v_exp_f32 v25, v171
  v_mfma_f32_16x16x32_bf16 v[108:111], v[244:247], v[180:183], v[108:111]
  ds_read_b128 v[196:199], v3 offset:24576
  v_cvt_pk_bf16_f32 v187, v24, v25
  v_mfma_f32_16x16x32_bf16 v[140:143], v[20:23], v[180:183], v[140:143]
  v_or3_b32 v28, v184, v185, v188
  v_or3_b32 v28, v28, v189, v186
  v_mfma_f32_16x16x32_bf16 v[152:155], v[216:219], v[48:51], v[152:155]
  v_exp_f32 v24, v172
  v_mfma_f32_16x16x32_bf16 v[156:159], v[216:219], v[52:55], v[156:159]
  ds_read_b64_tr_b16 v[232:233], v8 offset:8192
  ds_read_b64_tr_b16 v[234:235], v8 offset:9216
  v_mfma_f32_16x16x32_bf16 v[112:115], v[248:251], v[176:179], v[112:115]
  s_waitcnt lgkmcnt(8)
  v_exp_f32 v25, v173
  v_mfma_f32_16x16x32_bf16 v[116:119], v[248:251], v[180:183], v[116:119]
  ds_read_b128 v[200:203], v4 offset:24576
  v_cvt_pk_bf16_f32 v190, v24, v25
  v_mfma_f32_16x16x32_bf16 v[152:155], v[220:223], v[56:59], v[152:155]
  v_exp_f32 v24, v174
  v_mfma_f32_16x16x32_bf16 v[156:159], v[220:223], v[60:63], v[156:159]
  s_waitcnt lgkmcnt(6)
  v_exp_f32 v25, v175
  v_mfma_f32_16x16x32_bf16 v[120:123], v[252:255], v[176:179], v[120:123]
  ds_read_b128 v[204:207], v5 offset:24576
  v_or3_b32 v28, v28, v187, v190
  v_mfma_f32_16x16x32_bf16 v[124:127], v[252:255], v[180:183], v[124:127]
  v_cvt_pk_bf16_f32 v191, v24, v25
  v_bitop3_b32 v28, v28, v191, s49 bitop3:0xa8
  v_cmp_ne_u32 vcc, 0, v28
  v_mfma_f32_16x16x32_bf16 v[136:139], v[20:23], v[176:179], v[136:139]
  ds_read_b64_tr_b16 v[236:237], v9 offset:8192
  ds_read_b64_tr_b16 v[238:239], v9 offset:9216
  s_cbranch_vccnz L_stb0
L_okb0:
  v_mfma_f32_16x16x32_bf16 v[160:163], v[192:195], v[32:35], v[128:131]
  v_exp_f32 v24, v144
  v_mfma_f32_16x16x32_bf16 v[164:167], v[192:195], v[36:39], v[132:135]
  ds_read_b64_tr_b16 v[240:241], v10 offset:8192
  ds_read_b64_tr_b16 v[242:243], v10 offset:9216
  v_mfma_f32_16x16x32_bf16 v[64:67], v[224:227], v[184:187], v[64:67]
  s_waitcnt lgkmcnt(8)
  v_exp_f32 v25, v145
  v_mfma_f32_16x16x32_bf16 v[68:71], v[224:227], v[188:191], v[68:71]
  ds_read_b128 v[208:211], v2 offset:25600
  v_cvt_pk_bf16_f32 v176, v24, v25
  v_mfma_f32_16x16x32_bf16 v[160:163], v[196:199], v[40:43], v[160:163]
  v_exp_f32 v24, v146
  v_mfma_f32_16x16x32_bf16 v[164:167], v[196:199], v[44:47], v[164:167]
  ds_read_b64_tr_b16 v[244:245], v11 offset:8192
  ds_read_b64_tr_b16 v[246:247], v11 offset:9216
  v_mfma_f32_16x16x32_bf16 v[72:75], v[228:231], v[184:187], v[72:75]
  s_waitcnt lgkmcnt(8)
  v_exp_f32 v25, v147
  v_mfma_f32_16x16x32_bf16 v[76:79], v[228:231], v[188:191], v[76:79]
  ds_read_b128 v[212:215], v3 offset:25600
  v_cvt_pk_bf16_f32 v177, v24, v25
  v_mfma_f32_16x16x32_bf16 v[160:163], v[200:203], v[48:51], v[160:163]
  v_exp_f32 v24, v148
  v_mfma_f32_16x16x32_bf16 v[164:167], v[200:203], v[52:55], v[164:167]
  ds_read_b64_tr_b16 v[248:249], v12 offset:8192
  ds_read_b64_tr_b16 v[250:251], v12 offset:9216
  v_mfma_f32_16x16x32_bf16 v[80:83], v[232:235], v[184:187], v[80:83]
  s_waitcnt lgkmcnt(8)
  v_exp_f32 v25, v149
  v_mfma_f32_16x16x32_bf16 v[84:87], v[232:235], v[188:191], v[84:87]
  ds_read_b128 v[216:219], v4 offset:25600
  v_cvt_pk_bf16_f32 v180, v24, v25
  v_mfma_f32_16x16x32_bf16 v[160:163], v[204:207], v[56:59], v[160:163]
  v_exp_f32 v24, v150
  v_mfma_f32_16x16x32_bf16 v[164:167], v[204:207], v[60:63], v[164:167]
  ds_read_b64_tr_b16 v[252:253], v13 offset:8192
  ds_read_b64_tr_b16 v[254:255], v13 offset:9216
  v_mfma_f32_16x16x32_bf16 v[88:91], v[236:239], v[184:187], v[88:91]
  s_waitcnt lgkmcnt(8)
  v_exp_f32 v25, v151
  v_mfma_f32_16x16x32_bf16 v[92:95], v[236:239], v[188:191], v[92:95]
  ds_read_b128 v[220:223], v5 offset:25600
  v_cvt_pk_bf16_f32 v181, v24, v25
  v_mfma_f32_16x16x32_bf16 v[168:171], v[208:211], v[32:35], v[128:131]
  v_exp_f32 v24, v152
  v_mfma_f32_16x16x32_bf16 v[172:175], v[208:211], v[36:39], v[132:135]
  s_waitcnt lgkmcnt(0)
  s_waitcnt vmcnt(0)
  s_barrier
  ds_read_b64_tr_b16 v[224:225], v6 offset:16384
  ds_read_b64_tr_b16 v[226:227], v6 offset:17408
  v_mfma_f32_16x16x32_bf16 v[96:99], v[240:243], v[184:187], v[96:99]
  v_exp_f32 v25, v153
  v_mfma_f32_16x16x32_bf16 v[100:103], v[240:243], v[188:191], v[100:103]
  ds_read_b128 v[192:195], v2 offset:32768
  v_cvt_pk_bf16_f32 v178, v24, v25
  v_mfma_f32_16x16x32_bf16 v[168:171], v[212:215], v[40:43], v[168:171]
  v_exp_f32 v24, v154
  v_mfma_f32_16x16x32_bf16 v[172:175], v[212:215], v[44:47], v[172:175]
  ds_read_b64_tr_b16 v[228:229], v7 offset:16384
  ds_read_b64_tr_b16 v[230:231], v7 offset:17408
  v_mfma_f32_16x16x32_bf16 v[104:107], v[244:247], v[184:187], v[104:107]
  v_exp_f32 v25, v155
  v_mfma_f32_16x16x32_bf16 v[108:111], v[244:247], v[188:191], v[108:111]
  ds_read_b128 v[196:199], v3 offset:32768
  v_cvt_pk_bf16_f32 v179, v24, v25
  v_mfma_f32_16x16x32_bf16 v[140:143], v[20:23], v[188:191], v[140:143]
  v_or3_b32 v28, v176, v177, v180
  v_or3_b32 v28, v28, v181, v178
  v_mfma_f32_16x16x32_bf16 v[168:171], v[216:219], v[48:51], v[168:171]
  v_exp_f32 v24, v156
  v_mfma_f32_16x16x32_bf16 v[172:175], v[216:219], v[52:55], v[172:175]
  ds_read_b64_tr_b16 v[232:233], v8 offset:16384
  ds_read_b64_tr_b16 v[234:235], v8 offset:17408
  v_mfma_f32_16x16x32_bf16 v[112:115], v[248:251], v[184:187], v[112:115]
  v_exp_f32 v25, v157
  v_mfma_f32_16x16x32_bf16 v[116:119], v[248:251], v[188:191], v[116:119]
  ds_read_b128 v[200:203], v4 offset:32768
  v_cvt_pk_bf16_f32 v182, v24, v25
  v_mfma_f32_16x16x32_bf16 v[168:171], v[220:223], v[56:59], v[168:171]
  v_exp_f32 v24, v158
  v_mfma_f32_16x16x32_bf16 v[172:175], v[220:223], v[60:63], v[172:175]
  s_waitcnt lgkmcnt(6)
  v_exp_f32 v25, v159
  v_mfma_f32_16x16x32_bf16 v[120:123], v[252:255], v[184:187], v[120:123]
  ds_read_b128 v[204:207], v5 offset:32768
  v_or3_b32 v28, v28, v179, v182
  v_mfma_f32_16x16x32_bf16 v[124:127], v[252:255], v[188:191], v[124:127]
  v_cvt_pk_bf16_f32 v183, v24, v25
  v_bitop3_b32 v28, v28, v183, s49 bitop3:0xa8
  v_cmp_ne_u32 vcc, 0, v28
  v_mfma_f32_16x16x32_bf16 v[136:139], v[20:23], v[184:187], v[136:139]
  ds_read_b64_tr_b16 v[236:237], v9 offset:16384
  ds_read_b64_tr_b16 v[238:239], v9 offset:17408
  s_cbranch_vccnz L_sta1
L_oka1:
  v_mfma_f32_16x16x32_bf16 v[144:147], v[192:195], v[32:35], v[128:131]
  v_exp_f32 v24, v160
  v_mfma_f32_16x16x32_bf16 v[148:151], v[192:195], v[36:39], v[132:135]
  ds_read_b64_tr_b16 v[240:241], v10 offset:16384
  ds_read_b64_tr_b16 v[242:243], v10 offset:17408
  v_mfma_f32_16x16x32_bf16 v[64:67], v[224:227], v[176:179], v[64:67]
  s_waitcnt lgkmcnt(8)
  v_exp_f32 v25, v161
  v_mfma_f32_16x16x32_bf16 v[68:71], v[224:227], v[180:183], v[68:71]
  ds_read_b128 v[208:211], v2 offset:33792
  v_cvt_pk_bf16_f32 v184, v24, v25
  v_mfma_f32_16x16x32_bf16 v[144:147], v[196:199], v[40:43], v[144:147]
  v_exp_f32 v24, v162
  v_mfma_f32_16x16x32_bf16 v[148:151], v[196:199], v[44:47], v[148:151]
  ds_read_b64_tr_b16 v[244:245], v11 offset:16384
  ds_read_b64_tr_b16 v[246:247], v11 offset:17408
  v_mfma_f32_16x16x32_bf16 v[72:75], v[228:231], v[176:179], v[72:75]
  s_waitcnt lgkmcnt(8)
  v_exp_f32 v25, v163
  v_mfma_f32_16x16x32_bf16 v[76:79], v[228:231], v[180:183], v[76:79]
  ds_read_b128 v[212:215], v3 offset:33792
  v_cvt_pk_bf16_f32 v185, v24, v25
  v_mfma_f32_16x16x32_bf16 v[144:147], v[200:203], v[48:51], v[144:147]
  v_exp_f32 v24, v164
  v_mfma_f32_16x16x32_bf16 v[148:151], v[200:203], v[52:55], v[148:151]
  ds_read_b64_tr_b16 v[248:249], v12 offset:16384
  ds_read_b64_tr_b16 v[250:251], v12 offset:17408
  v_mfma_f32_16x16x32_bf16 v[80:83], v[232:235], v[176:179], v[80:83]
  s_waitcnt lgkmcnt(8)
  v_exp_f32 v25, v165
  v_mfma_f32_16x16x32_bf16 v[84:87], v[232:235], v[180:183], v[84:87]
  ds_read_b128 v[216:219], v4 offset:33792
  v_cvt_pk_bf16_f32 v188, v24, v25
  v_mfma_f32_16x16x32_bf16 v[144:147], v[204:207], v[56:59], v[144:147]
  v_exp_f32 v24, v166
  v_mfma_f32_16x16x32_bf16 v[148:151], v[204:207], v[60:63], v[148:151]
  ds_read_b64_tr_b16 v[252:253], v13 offset:16384
  ds_read_b64_tr_b16 v[254:255], v13 offset:17408
  v_mfma_f32_16x16x32_bf16 v[88:91], v[236:239], v[176:179], v[88:91]
  s_waitcnt lgkmcnt(8)
  v_exp_f32 v25, v167
  v_mfma_f32_16x16x32_bf16 v[92:95], v[236:239], v[180:183], v[92:95]
  ds_read_b128 v[220:223], v5 offset:33792
  v_cvt_pk_bf16_f32 v189, v24, v25
  v_mfma_f32_16x16x32_bf16 v[152:155], v[208:211], v[32:35], v[128:131]
  v_exp_f32 v24, v168
  v_mfma_f32_16x16x32_bf16 v[156:159], v[208:211], v[36:39], v[132:135]
  ds_read_b64_tr_b16 v[224:225], v6 offset:24576
  ds_read_b64_tr_b16 v[226:227], v6 offset:25600
  v_mfma_f32_16x16x32_bf16 v[96:99], v[240:243], v[176:179], v[96:99]
  s_waitcnt lgkmcnt(8)
  v_exp_f32 v25, v169
  v_mfma_f32_16x16x32_bf16 v[100:103], v[240:243], v[180:183], v[100:103]
  ds_read_b128 v[192:195], v2 offset:40960
  v_cvt_pk_bf16_f32 v186, v24, v25
  v_mfma_f32_16x16x32_bf16 v[152:155], v[212:215], v[40:43], v[152:155]
  v_exp_f32 v24, v170
  v_mfma_f32_16x16x32_bf16 v[156:159], v[212:215], v[44:47], v[156:159]
  ds_read_b64_tr_b16 v[228:229], v7 offset:24576
  ds_read_b64_tr_b16 v[230:231], v7 offset:25600
  v_mfma_f32_16x16x32_bf16 v[104:107], v[244:247], v[176:179], v[104:107]
  s_waitcnt lgkmcnt(8)
  v_exp_f32 v25, v171
  v_mfma_f32_16x16x32_bf16 v[108:111], v[244:247], v[180:183], v[108:111]
  ds_read_b128 v[196:199], v3 offset:40960
  v_cvt_pk_bf16_f32 v187, v24, v25
  v_mfma_f32_16x16x32_bf16 v[140:143], v[20:23], v[180:183], v[140:143]
  v_or3_b32 v28, v184, v185, v188
  v_or3_b32 v28, v28, v189, v186
  v_mfma_f32_16x16x32_bf16 v[152:155], v[216:219], v[48:51], v[152:155]
  v_exp_f32 v24, v172
  v_mfma_f32_16x16x32_bf16 v[156:159], v[216:219], v[52:55], v[156:159]
  ds_read_b64_tr_b16 v[232:233], v8 offset:24576
  ds_read_b64_tr_b16 v[234:235], v8 offset:25600
  v_mfma_f32_16x16x32_bf16 v[112:115], v[248:251], v[176:179], v[112:115]
  s_waitcnt lgkmcnt(8)
  v_exp_f32 v25, v173
  v_mfma_f32_16x16x32_bf16 v[116:119], v[248:251], v[180:183], v[116:119]
  ds_read_b128 v[200:203], v4 offset:40960
  v_cvt_pk_bf16_f32 v190, v24, v25
  v_mfma_f32_16x16x32_bf16 v[152:155], v[220:223], v[56:59], v[152:155]
  v_exp_f32 v24, v174
  v_mfma_f32_16x16x32_bf16 v[156:159], v[220:223], v[60:63], v[156:159]
  s_waitcnt lgkmcnt(6)
  v_exp_f32 v25, v175
  v_mfma_f32_16x16x32_bf16 v[120:123], v[252:255], v[176:179], v[120:123]
  ds_read_b128 v[204:207], v5 offset:40960
  v_or3_b32 v28, v28, v187, v190
  v_mfma_f32_16x16x32_bf16 v[124:127], v[252:255], v[180:183], v[124:127]
  v_cvt_pk_bf16_f32 v191, v24, v25
  v_bitop3_b32 v28, v28, v191, s49 bitop3:0xa8
  v_cmp_ne_u32 vcc, 0, v28
  v_mfma_f32_16x16x32_bf16 v[136:139], v[20:23], v[176:179], v[136:139]
  ds_read_b64_tr_b16 v[236:237], v9 offset:24576
  ds_read_b64_tr_b16 v[238:239], v9 offset:25600
  s_cbranch_vccnz L_stb1
L_okb1:
  v_mfma_f32_16x16x32_bf16 v[160:163], v[192:195], v[32:35], v[128:131]
  v_exp_f32 v24, v144
  v_mfma_f32_16x16x32_bf16 v[164:167], v[192:195], v[36:39], v[132:135]
  ds_read_b64_tr_b16 v[240:241], v10 offset:24576
  ds_read_b64_tr_b16 v[242:243], v10 offset:25600
  v_mfma_f32_16x16x32_bf16 v[64:67], v[224:227], v[184:187], v[64:67]
  s_waitcnt lgkmcnt(8)
  v_exp_f32 v25, v145
  v_mfma_f32_16x16x32_bf16 v[68:71], v[224:227], v[188:191], v[68:71]
  ds_read_b128 v[208:211], v2 offset:41984
  v_cvt_pk_bf16_f32 v176, v24, v25
  v_mfma_f32_16x16x32_bf16 v[160:163], v[196:199], v[40:43], v[160:163]
  v_exp_f32 v24, v146
  v_mfma_f32_16x16x32_bf16 v[164:167], v[196:199], v[44:47], v[164:167]
  ds_read_b64_tr_b16 v[244:245], v11 offset:24576
  ds_read_b64_tr_b16 v[246:247], v11 offset:25600
  v_mfma_f32_16x16x32_bf16 v[72:75], v[228:231], v[184:187], v[72:75]
  s_waitcnt lgkmcnt(8)
  v_exp_f32 v25, v147
  v_mfma_f32_16x16x32_bf16 v[76:79], v[228:231], v[188:191], v[76:79]
  ds_read_b128 v[212:215], v3 offset:41984
  v_cvt_pk_bf16_f32 v177, v24, v25
  v_mfma_f32_16x16x32_bf16 v[160:163], v[200:203], v[48:51], v[160:163]
  v_exp_f32 v24, v148
  v_mfma_f32_16x16x32_bf16 v[164:167], v[200:203], v[52:55], v[164:167]
  ds_read_b64_tr_b16 v[248:249], v12 offset:24576
  ds_read_b64_tr_b16 v[250:251], v12 offset:25600
  v_mfma_f32_16x16x32_bf16 v[80:83], v[232:235], v[184:187], v[80:83]
  s_waitcnt lgkmcnt(8)
  v_exp_f32 v25, v149
  v_mfma_f32_16x16x32_bf16 v[84:87], v[232:235], v[188:191], v[84:87]
  ds_read_b128 v[216:219], v4 offset:41984
  v_cvt_pk_bf16_f32 v180, v24, v25
  v_mfma_f32_16x16x32_bf16 v[160:163], v[204:207], v[56:59], v[160:163]
  v_exp_f32 v24, v150
  v_mfma_f32_16x16x32_bf16 v[164:167], v[204:207], v[60:63], v[164:167]
  ds_read_b64_tr_b16 v[252:253], v13 offset:24576
  ds_read_b64_tr_b16 v[254:255], v13 offset:25600
  v_mfma_f32_16x16x32_bf16 v[88:91], v[236:239], v[184:187], v[88:91]
  s_waitcnt lgkmcnt(8)
  v_exp_f32 v25, v151
  v_mfma_f32_16x16x32_bf16 v[92:95], v[236:239], v[188:191], v[92:95]
  ds_read_b128 v[220:223], v5 offset:41984
  v_cvt_pk_bf16_f32 v181, v24, v25
  v_mfma_f32_16x16x32_bf16 v[168:171], v[208:211], v[32:35], v[128:131]
  v_exp_f32 v24, v152
  v_mfma_f32_16x16x32_bf16 v[172:175], v[208:211], v[36:39], v[132:135]
  s_waitcnt lgkmcnt(0)
  s_barrier
  ds_read_b64_tr_b16 v[224:225], v6 offset:32768
  ds_read_b64_tr_b16 v[226:227], v6 offset:33792
  v_mfma_f32_16x16x32_bf16 v[96:99], v[240:243], v[184:187], v[96:99]
  v_exp_f32 v25, v153
  v_mfma_f32_16x16x32_bf16 v[100:103], v[240:243], v[188:191], v[100:103]
  ds_read_b128 v[192:195], v2 offset:0
  v_cvt_pk_bf16_f32 v178, v24, v25
  v_mfma_f32_16x16x32_bf16 v[168:171], v[212:215], v[40:43], v[168:171]
  v_exp_f32 v24, v154
  v_mfma_f32_16x16x32_bf16 v[172:175], v[212:215], v[44:47], v[172:175]
  ds_read_b64_tr_b16 v[228:229], v7 offset:32768
  ds_read_b64_tr_b16 v[230:231], v7 offset:33792
  v_mfma_f32_16x16x32_bf16 v[104:107], v[244:247], v[184:187], v[104:107]
  v_exp_f32 v25, v155
  v_mfma_f32_16x16x32_bf16 v[108:111], v[244:247], v[188:191], v[108:111]
  ds_read_b128 v[196:199], v3 offset:0
  v_cvt_pk_bf16_f32 v179, v24, v25
  v_mfma_f32_16x16x32_bf16 v[140:143], v[20:23], v[188:191], v[140:143]
  v_or3_b32 v28, v176, v177, v180
  v_or3_b32 v28, v28, v181, v178
  v_mfma_f32_16x16x32_bf16 v[168:171], v[216:219], v[48:51], v[168:171]
  v_exp_f32 v24, v156
  v_mfma_f32_16x16x32_bf16 v[172:175], v[216:219], v[52:55], v[172:175]
  ds_read_b64_tr_b16 v[232:233], v8 offset:32768
  ds_read_b64_tr_b16 v[234:235], v8 offset:33792
  v_mfma_f32_16x16x32_bf16 v[112:115], v[248:251], v[184:187], v[112:115]
  v_exp_f32 v25, v157
  v_mfma_f32_16x16x32_bf16 v[116:119], v[248:251], v[188:191], v[116:119]
  ds_read_b128 v[200:203], v4 offset:0
  v_cvt_pk_bf16_f32 v182, v24, v25
  v_mfma_f32_16x16x32_bf16 v[168:171], v[220:223], v[56:59], v[168:171]
  v_exp_f32 v24, v158
  v_mfma_f32_16x16x32_bf16 v[172:175], v[220:223], v[60:63], v[172:175]
  s_waitcnt lgkmcnt(6)
  v_exp_f32 v25, v159
  v_mfma_f32_16x16x32_bf16 v[120:123], v[252:255], v[184:187], v[120:123]
  ds_read_b128 v[204:207], v5 offset:0
  v_or3_b32 v28, v28, v179, v182
  v_mfma_f32_16x16x32_bf16 v[124:127], v[252:255], v[188:191], v[124:127]
  v_cvt_pk_bf16_f32 v183, v24, v25
  v_bitop3_b32 v28, v28, v183, s49 bitop3:0xa8
  v_cmp_ne_u32 vcc, 0, v28
  v_mfma_f32_16x16x32_bf16 v[136:139], v[20:23], v[184:187], v[136:139]
  ds_read_b64_tr_b16 v[236:237], v9 offset:32768
  ds_read_b64_tr_b16 v[238:239], v9 offset:33792
  s_cbranch_vccnz L_sta2
L_oka2:
  v_mfma_f32_16x16x32_bf16 v[144:147], v[192:195], v[32:35], v[128:131]
  v_exp_f32 v24, v160
  v_mfma_f32_16x16x32_bf16 v[148:151], v[192:195], v[36:39], v[132:135]
  ds_read_b64_tr_b16 v[240:241], v10 offset:32768
  ds_read_b64_tr_b16 v[242:243], v10 offset:33792
  v_mfma_f32_16x16x32_bf16 v[64:67], v[224:227], v[176:179], v[64:67]
  s_waitcnt lgkmcnt(8)
  v_exp_f32 v25, v161
  v_mfma_f32_16x16x32_bf16 v[68:71], v[224:227], v[180:183], v[68:71]
  ds_read_b128 v[208:211], v2 offset:1024
  v_cvt_pk_bf16_f32 v184, v24, v25
  v_mfma_f32_16x16x32_bf16 v[144:147], v[196:199], v[40:43], v[144:147]
  v_exp_f32 v24, v162
  v_mfma_f32_16x16x32_bf16 v[148:151], v[196:199], v[44:47], v[148:151]
  ds_read_b64_tr_b16 v[244:245], v11 offset:32768
  ds_read_b64_tr_b16 v[246:247], v11 offset:33792
  v_mfma_f32_16x16x32_bf16 v[72:75], v[228:231], v[176:179], v[72:75]
  s_waitcnt lgkmcnt(8)
  v_exp_f32 v25, v163
  v_mfma_f32_16x16x32_bf16 v[76:79], v[228:231], v[180:183], v[76:79]
  ds_read_b128 v[212:215], v3 offset:1024
  v_cvt_pk_bf16_f32 v185, v24, v25
  v_mfma_f32_16x16x32_bf16 v[144:147], v[200:203], v[48:51], v[144:147]
  v_exp_f32 v24, v164
  v_mfma_f32_16x16x32_bf16 v[148:151], v[200:203], v[52:55], v[148:151]
  ds_read_b64_tr_b16 v[248:249], v12 offset:32768
  ds_read_b64_tr_b16 v[250:251], v12 offset:33792
  v_mfma_f32_16x16x32_bf16 v[80:83], v[232:235], v[176:179], v[80:83]
  s_waitcnt lgkmcnt(8)
  v_exp_f32 v25, v165
  v_mfma_f32_16x16x32_bf16 v[84:87], v[232:235], v[180:183], v[84:87]
  ds_read_b128 v[216:219], v4 offset:1024
  v_cvt_pk_bf16_f32 v188, v24, v25
  v_mfma_f32_16x16x32_bf16 v[144:147], v[204:207], v[56:59], v[144:147]
  v_exp_f32 v24, v166
  v_mfma_f32_16x16x32_bf16 v[148:151], v[204:207], v[60:63], v[148:151]
  ds_read_b64_tr_b16 v[252:253], v13 offset:32768
  ds_read_b64_tr_b16 v[254:255], v13 offset:33792
  v_mfma_f32_16x16x32_bf16 v[88:91], v[236:239], v[176:179], v[88:91]
  s_waitcnt lgkmcnt(8)
  v_exp_f32 v25, v167
  v_mfma_f32_16x16x32_bf16 v[92:95], v[236:239], v[180:183], v[92:95]
  ds_read_b128 v[220:223], v5 offset:1024
  v_cvt_pk_bf16_f32 v189, v24, v25
  v_mfma_f32_16x16x32_bf16 v[152:155], v[208:211], v[32:35], v[128:131]
  v_exp_f32 v24, v168
  v_mfma_f32_16x16x32_bf16 v[156:159], v[208:211], v[36:39], v[132:135]
  ds_read_b64_tr_b16 v[224:225], v6 offset:40960
  ds_read_b64_tr_b16 v[226:227], v6 offset:41984
  v_mfma_f32_16x16x32_bf16 v[96:99], v[240:243], v[176:179], v[96:99]
  s_waitcnt lgkmcnt(8)
  v_exp_f32 v25, v169
  v_mfma_f32_16x16x32_bf16 v[100:103], v[240:243], v[180:183], v[100:103]
  ds_read_b128 v[192:195], v2 offset:8192
  v_cvt_pk_bf16_f32 v186, v24, v25
  v_mfma_f32_16x16x32_bf16 v[152:155], v[212:215], v[40:43], v[152:155]
  v_exp_f32 v24, v170
  v_mfma_f32_16x16x32_bf16 v[156:159], v[212:215], v[44:47], v[156:159]
  ds_read_b64_tr_b16 v[228:229], v7 offset:40960
  ds_read_b64_tr_b16 v[230:231], v7 offset:41984
  v_mfma_f32_16x16x32_bf16 v[104:107], v[244:247], v[176:179], v[104:107]
  s_waitcnt lgkmcnt(8)
  v_exp_f32 v25, v171
  v_mfma_f32_16x16x32_bf16 v[108:111], v[244:247], v[180:183], v[108:111]
  ds_read_b128 v[196:199], v3 offset:8192
  v_cvt_pk_bf16_f32 v187, v24, v25
  v_mfma_f32_16x16x32_bf16 v[140:143], v[20:23], v[180:183], v[140:143]
  v_or3_b32 v28, v184, v185, v188
  v_or3_b32 v28, v28, v189, v186
  v_mfma_f32_16x16x32_bf16 v[152:155], v[216:219], v[48:51], v[152:155]
  v_exp_f32 v24, v172
  v_mfma_f32_16x16x32_bf16 v[156:159], v[216:219], v[52:55], v[156:159]
  ds_read_b64_tr_b16 v[232:233], v8 offset:40960
  ds_read_b64_tr_b16 v[234:235], v8 offset:41984
  v_mfma_f32_16x16x32_bf16 v[112:115], v[248:251], v[176:179], v[112:115]
  s_waitcnt lgkmcnt(8)
  v_exp_f32 v25, v173
  v_mfma_f32_16x16x32_bf16 v[116:119], v[248:251], v[180:183], v[116:119]
  ds_read_b128 v[200:203], v4 offset:8192
  v_cvt_pk_bf16_f32 v190, v24, v25
  v_mfma_f32_16x16x32_bf16 v[152:155], v[220:223], v[56:59], v[152:155]
  v_exp_f32 v24, v174
  v_mfma_f32_16x16x32_bf16 v[156:159], v[220:223], v[60:63], v[156:159]
  s_waitcnt lgkmcnt(6)
  v_exp_f32 v25, v175
  v_mfma_f32_16x16x32_bf16 v[120:123], v[252:255], v[176:179], v[120:123]
  ds_read_b128 v[204:207], v5 offset:8192
  v_or3_b32 v28, v28, v187, v190
  v_mfma_f32_16x16x32_bf16 v[124:127], v[252:255], v[180:183], v[124:127]
  v_cvt_pk_bf16_f32 v191, v24, v25
  v_bitop3_b32 v28, v28, v191, s49 bitop3:0xa8
  v_cmp_ne_u32 vcc, 0, v28
  v_mfma_f32_16x16x32_bf16 v[136:139], v[20:23], v[176:179], v[136:139]
  ds_read_b64_tr_b16 v[236:237], v9 offset:40960
  ds_read_b64_tr_b16 v[238:239], v9 offset:41984
  s_cbranch_vccnz L_stb2
L_okb2:
  v_mfma_f32_16x16x32_bf16 v[160:163], v[192:195], v[32:35], v[128:131]
  v_exp_f32 v24, v144
  v_mfma_f32_16x16x32_bf16 v[164:167], v[192:195], v[36:39], v[132:135]
  ds_read_b64_tr_b16 v[240:241], v10 offset:40960
  ds_read_b64_tr_b16 v[242:243], v10 offset:41984
  v_mfma_f32_16x16x32_bf16 v[64:67], v[224:227], v[184:187], v[64:67]
  s_waitcnt lgkmcnt(8)
  v_exp_f32 v25, v145
  v_mfma_f32_16x16x32_bf16 v[68:71], v[224:227], v[188:191], v[68:71]
  ds_read_b128 v[208:211], v2 offset:9216
  v_cvt_pk_bf16_f32 v176, v24, v25
  v_mfma_f32_16x16x32_bf16 v[160:163], v[196:199], v[40:43], v[160:163]
  v_exp_f32 v24, v146
  v_mfma_f32_16x16x32_bf16 v[164:167], v[196:199], v[44:47], v[164:167]
  ds_read_b64_tr_b16 v[244:245], v11 offset:40960
  ds_read_b64_tr_b16 v[246:247], v11 offset:41984
  v_mfma_f32_16x16x32_bf16 v[72:75], v[228:231], v[184:187], v[72:75]
  s_waitcnt lgkmcnt(8)
  v_exp_f32 v25, v147
  v_mfma_f32_16x16x32_bf16 v[76:79], v[228:231], v[188:191], v[76:79]
  ds_read_b128 v[212:215], v3 offset:9216
  v_cvt_pk_bf16_f32 v177, v24, v25
  v_mfma_f32_16x16x32_bf16 v[160:163], v[200:203], v[48:51], v[160:163]
  v_exp_f32 v24, v148
  v_mfma_f32_16x16x32_bf16 v[164:167], v[200:203], v[52:55], v[164:167]
  ds_read_b64_tr_b16 v[248:249], v12 offset:40960
  ds_read_b64_tr_b16 v[250:251], v12 offset:41984
  v_mfma_f32_16x16x32_bf16 v[80:83], v[232:235], v[184:187], v[80:83]
  s_waitcnt lgkmcnt(8)
  v_exp_f32 v25, v149
  v_mfma_f32_16x16x32_bf16 v[84:87], v[232:235], v[188:191], v[84:87]
  ds_read_b128 v[216:219], v4 offset:9216
  v_cvt_pk_bf16_f32 v180, v24, v25
  v_mfma_f32_16x16x32_bf16 v[160:163], v[204:207], v[56:59], v[160:163]
  v_exp_f32 v24, v150
  v_mfma_f32_16x16x32_bf16 v[164:167], v[204:207], v[60:63], v[164:167]
  ds_read_b64_tr_b16 v[252:253], v13 offset:40960
  ds_read_b64_tr_b16 v[254:255], v13 offset:41984
  v_mfma_f32_16x16x32_bf16 v[88:91], v[236:239], v[184:187], v[88:91]
  s_waitcnt lgkmcnt(8)
  v_exp_f32 v25, v151
  v_mfma_f32_16x16x32_bf16 v[92:95], v[236:239], v[188:191], v[92:95]
  ds_read_b128 v[220:223], v5 offset:9216
  v_cvt_pk_bf16_f32 v181, v24, v25
  s_add_u32 s62, s62, 1
  s_cmp_lt_u32 s62, 5
  s_cbranch_scc1 L_att_loop
  v_mfma_f32_16x16x32_bf16 v[168:171], v[208:211], v[32:35], v[128:131]
  v_exp_f32 v24, v152
  v_mfma_f32_16x16x32_bf16 v[172:175], v[208:211], v[36:39], v[132:135]
  s_waitcnt lgkmcnt(0)
  s_barrier
  ds_read_b64_tr_b16 v[224:225], v6 offset:0
  ds_read_b64_tr_b16 v[226:227], v6 offset:1024
  v_mfma_f32_16x16x32_bf16 v[96:99], v[240:243], v[184:187], v[96:99]
  v_exp_f32 v25, v153
  v_mfma_f32_16x16x32_bf16 v[100:103], v[240:243], v[188:191], v[100:103]
  v_cvt_pk_bf16_f32 v178, v24, v25
  v_mfma_f32_16x16x32_bf16 v[168:171], v[212:215], v[40:43], v[168:171]
  v_exp_f32 v24, v154
  v_mfma_f32_16x16x32_bf16 v[172:175], v[212:215], v[44:47], v[172:175]
  ds_read_b64_tr_b16 v[228:229], v7 offset:0
  ds_read_b64_tr_b16 v[230:231], v7 offset:1024
  v_mfma_f32_16x16x32_bf16 v[104:107], v[244:247], v[184:187], v[104:107]
  v_exp_f32 v25, v155
  v_mfma_f32_16x16x32_bf16 v[108:111], v[244:247], v[188:191], v[108:111]
  v_cvt_pk_bf16_f32 v179, v24, v25
  v_mfma_f32_16x16x32_bf16 v[140:143], v[20:23], v[188:191], v[140:143]
  v_or3_b32 v28, v176, v177, v180
  v_or3_b32 v28, v28, v181, v178
  v_mfma_f32_16x16x32_bf16 v[168:171], v[216:219], v[48:51], v[168:171]
  v_exp_f32 v24, v156
  v_mfma_f32_16x16x32_bf16 v[172:175], v[216:219], v[52:55], v[172:175]
  ds_read_b64_tr_b16 v[232:233], v8 offset:0
  ds_read_b64_tr_b16 v[234:235], v8 offset:1024
  v_mfma_f32_16x16x32_bf16 v[112:115], v[248:251], v[184:187], v[112:115]
  v_exp_f32 v25, v157
  v_mfma_f32_16x16x32_bf16 v[116:119], v[248:251], v[188:191], v[116:119]
  v_cvt_pk_bf16_f32 v182, v24, v25
  v_mfma_f32_16x16x32_bf16 v[168:171], v[220:223], v[56:59], v[168:171]
  v_exp_f32 v24, v158
  v_mfma_f32_16x16x32_bf16 v[172:175], v[220:223], v[60:63], v[172:175]
  s_waitcnt lgkmcnt(4)
  v_exp_f32 v25, v159
  v_mfma_f32_16x16x32_bf16 v[120:123], v[252:255], v[184:187], v[120:123]
  v_or3_b32 v28, v28, v179, v182
  v_mfma_f32_16x16x32_bf16 v[124:127], v[252:255], v[188:191], v[124:127]
  v_cvt_pk_bf16_f32 v183, v24, v25
  v_bitop3_b32 v28, v28, v183, s49 bitop3:0xa8
  v_cmp_ne_u32 vcc, 0, v28
  v_mfma_f32_16x16x32_bf16 v[136:139], v[20:23], v[184:187], v[136:139]
  ds_read_b64_tr_b16 v[236:237], v9 offset:0
  ds_read_b64_tr_b16 v[238:239], v9 offset:1024
  s_cbranch_vccnz L_ste0
L_oke0:
  v_exp_f32 v24, v160
  ds_read_b64_tr_b16 v[240:241], v10 offset:0
  ds_read_b64_tr_b16 v[242:243], v10 offset:1024
  v_mfma_f32_16x16x32_bf16 v[64:67], v[224:227], v[176:179], v[64:67]
  s_waitcnt lgkmcnt(6)
  v_exp_f32 v25, v161
  v_mfma_f32_16x16x32_bf16 v[68:71], v[224:227], v[180:183], v[68:71]
  v_cvt_pk_bf16_f32 v184, v24, v25
  v_exp_f32 v24, v162
  ds_read_b64_tr_b16 v[244:245], v11 offset:0
  ds_read_b64_tr_b16 v[246:247], v11 offset:1024
  v_mfma_f32_16x16x32_bf16 v[72:75], v[228:231], v[176:179], v[72:75]
  s_waitcnt lgkmcnt(6)
  v_exp_f32 v25, v163
  v_mfma_f32_16x16x32_bf16 v[76:79], v[228:231], v[180:183], v[76:79]
  v_cvt_pk_bf16_f32 v185, v24, v25
  v_exp_f32 v24, v164
  ds_read_b64_tr_b16 v[248:249], v12 offset:0
  ds_read_b64_tr_b16 v[250:251], v12 offset:1024
  v_mfma_f32_16x16x32_bf16 v[80:83], v[232:235], v[176:179], v[80:83]
  s_waitcnt lgkmcnt(6)
  v_exp_f32 v25, v165
  v_mfma_f32_16x16x32_bf16 v[84:87], v[232:235], v[180:183], v[84:87]
  v_cvt_pk_bf16_f32 v188, v24, v25
  v_exp_f32 v24, v166
  ds_read_b64_tr_b16 v[252:253], v13 offset:0
  ds_read_b64_tr_b16 v[254:255], v13 offset:1024
  v_mfma_f32_16x16x32_bf16 v[88:91], v[236:239], v[176:179], v[88:91]
  s_waitcnt lgkmcnt(6)
  v_exp_f32 v25, v167
  v_mfma_f32_16x16x32_bf16 v[92:95], v[236:239], v[180:183], v[92:95]
  v_cvt_pk_bf16_f32 v189, v24, v25
  v_exp_f32 v24, v168
  ds_read_b64_tr_b16 v[224:225], v6 offset:8192
  ds_read_b64_tr_b16 v[226:227], v6 offset:9216
  v_mfma_f32_16x16x32_bf16 v[96:99], v[240:243], v[176:179], v[96:99]
  s_waitcnt lgkmcnt(6)
  v_exp_f32 v25, v169
  v_mfma_f32_16x16x32_bf16 v[100:103], v[240:243], v[180:183], v[100:103]
  v_cvt_pk_bf16_f32 v186, v24, v25
  v_exp_f32 v24, v170
  ds_read_b64_tr_b16 v[228:229], v7 offset:8192
  ds_read_b64_tr_b16 v[230:231], v7 offset:9216
  v_mfma_f32_16x16x32_bf16 v[104:107], v[244:247], v[176:179], v[104:107]
  s_waitcnt lgkmcnt(6)
  v_exp_f32 v25, v171
  v_mfma_f32_16x16x32_bf16 v[108:111], v[244:247], v[180:183], v[108:111]
  v_cvt_pk_bf16_f32 v187, v24, v25
  v_mfma_f32_16x16x32_bf16 v[140:143], v[20:23], v[180:183], v[140:143]
  v_or3_b32 v28, v184, v185, v188
  v_or3_b32 v28, v28, v189, v186
  v_exp_f32 v24, v172
  ds_read_b64_tr_b16 v[232:233], v8 offset:8192
  ds_read_b64_tr_b16 v[234:235], v8 offset:9216
  v_mfma_f32_16x16x32_bf16 v[112:115], v[248:251], v[176:179], v[112:115]
  s_waitcnt lgkmcnt(6)
  v_exp_f32 v25, v173
  v_mfma_f32_16x16x32_bf16 v[116:119], v[248:251], v[180:183], v[116:119]
  v_cvt_pk_bf16_f32 v190, v24, v25
  v_exp_f32 v24, v174
  s_waitcnt lgkmcnt(4)
  v_exp_f32 v25, v175
  v_mfma_f32_16x16x32_bf16 v[120:123], v[252:255], v[176:179], v[120:123]
  v_or3_b32 v28, v28, v187, v190
  v_mfma_f32_16x16x32_bf16 v[124:127], v[252:255], v[180:183], v[124:127]
  v_cvt_pk_bf16_f32 v191, v24, v25
  v_bitop3_b32 v28, v28, v191, s49 bitop3:0xa8
  v_cmp_ne_u32 vcc, 0, v28
  v_mfma_f32_16x16x32_bf16 v[136:139], v[20:23], v[176:179], v[136:139]
  ds_read_b64_tr_b16 v[236:237], v9 offset:8192
  ds_read_b64_tr_b16 v[238:239], v9 offset:9216
  s_cbranch_vccnz L_ste1
L_oke1:
  ds_read_b64_tr_b16 v[240:241], v10 offset:8192
  ds_read_b64_tr_b16 v[242:243], v10 offset:9216
  v_mfma_f32_16x16x32_bf16 v[64:67], v[224:227], v[184:187], v[64:67]
  s_waitcnt lgkmcnt(6)
  v_mfma_f32_16x16x32_bf16 v[68:71], v[224:227], v[188:191], v[68:71]
  ds_read_b64_tr_b16 v[244:245], v11 offset:8192
  ds_read_b64_tr_b16 v[246:247], v11 offset:9216
  v_mfma_f32_16x16x32_bf16 v[72:75], v[228:231], v[184:187], v[72:75]
  s_waitcnt lgkmcnt(6)
  v_mfma_f32_16x16x32_bf16 v[76:79], v[228:231], v[188:191], v[76:79]
  ds_read_b64_tr_b16 v[248:249], v12 offset:8192
  ds_read_b64_tr_b16 v[250:251], v12 offset:9216
  v_mfma_f32_16x16x32_bf16 v[80:83], v[232:235], v[184:187], v[80:83]
  s_waitcnt lgkmcnt(6)
  v_mfma_f32_16x16x32_bf16 v[84:87], v[232:235], v[188:191], v[84:87]
  ds_read_b64_tr_b16 v[252:253], v13 offset:8192
  ds_read_b64_tr_b16 v[254:255], v13 offset:9216
  v_mfma_f32_16x16x32_bf16 v[88:91], v[236:239], v[184:187], v[88:91]
  s_waitcnt lgkmcnt(6)
  v_mfma_f32_16x16x32_bf16 v[92:95], v[236:239], v[188:191], v[92:95]
  v_mfma_f32_16x16x32_bf16 v[96:99], v[240:243], v[184:187], v[96:99]
  s_waitcnt lgkmcnt(4)
  v_mfma_f32_16x16x32_bf16 v[100:103], v[240:243], v[188:191], v[100:103]
  v_mfma_f32_16x16x32_bf16 v[104:107], v[244:247], v[184:187], v[104:107]
  s_waitcnt lgkmcnt(2)
  v_mfma_f32_16x16x32_bf16 v[108:111], v[244:247], v[188:191], v[108:111]
  v_mfma_f32_16x16x32_bf16 v[140:143], v[20:23], v[188:191], v[140:143]
  v_mfma_f32_16x16x32_bf16 v[112:115], v[248:251], v[184:187], v[112:115]
  s_waitcnt lgkmcnt(0)
  v_mfma_f32_16x16x32_bf16 v[116:119], v[248:251], v[188:191], v[116:119]
  v_mfma_f32_16x16x32_bf16 v[120:123], v[252:255], v[184:187], v[120:123]
  v_mfma_f32_16x16x32_bf16 v[124:127], v[252:255], v[188:191], v[124:127]
  v_mfma_f32_16x16x32_bf16 v[136:139], v[20:23], v[184:187], v[136:139]
  s_cmp_eq_u32 s35, 0
  s_cbranch_scc0 L_B_fin
  s_add_u32 s56, s61, 49152
  s_add_u32 s57, s61, 32768
  s_nop 7
  v_rcp_f32 v24, v136
  v_rcp_f32 v25, v138
  v_rcp_f32 v26, v140
  v_rcp_f32 v27, v142
  s_nop 0
  v_mul_f32 v64, v24, v64
  v_mul_f32 v65, v24, v65
  v_mul_f32 v66, v24, v66
  v_mul_f32 v67, v24, v67
  v_cvt_pk_bf16_f32 v128, v64, v65
  v_cvt_pk_bf16_f32 v129, v66, v67
  v_mul_f32 v72, v24, v72
  v_mul_f32 v73, v24, v73
  v_mul_f32 v74, v24, v74
  v_mul_f32 v75, v24, v75
  v_cvt_pk_bf16_f32 v130, v72, v73
  v_cvt_pk_bf16_f32 v131, v74, v75
  v_mul_f32 v68, v26, v68
  v_mul_f32 v69, v26, v69
  v_mul_f32 v70, v26, v70
  v_mul_f32 v71, v26, v71
  v_cvt_pk_bf16_f32 v132, v68, v69
  v_cvt_pk_bf16_f32 v133, v70, v71
  v_mul_f32 v76, v26, v76
  v_mul_f32 v77, v26, v77
  v_mul_f32 v78, v26, v78
  v_mul_f32 v79, v26, v79
  v_cvt_pk_bf16_f32 v134, v76, v77
  v_cvt_pk_bf16_f32 v135, v78, v79
  v_mul_f32 v80, v24, v80
  v_mul_f32 v81, v24, v81
  v_mul_f32 v82, v24, v82
  v_mul_f32 v83, v24, v83
  v_cvt_pk_bf16_f32 v136, v80, v81
  v_cvt_pk_bf16_f32 v137, v82, v83
  v_mul_f32 v88, v24, v88
  v_mul_f32 v89, v24, v89
  v_mul_f32 v90, v24, v90
  v_mul_f32 v91, v24, v91
  v_cvt_pk_bf16_f32 v138, v88, v89
  v_cvt_pk_bf16_f32 v139, v90, v91
  v_mul_f32 v84, v26, v84
  v_mul_f32 v85, v26, v85
  v_mul_f32 v86, v26, v86
  v_mul_f32 v87, v26, v87
  v_cvt_pk_bf16_f32 v140, v84, v85
  v_cvt_pk_bf16_f32 v141, v86, v87
  v_mul_f32 v92, v26, v92
  v_mul_f32 v93, v26, v93
  v_mul_f32 v94, v26, v94
  v_mul_f32 v95, v26, v95
  v_cvt_pk_bf16_f32 v142, v92, v93
  v_cvt_pk_bf16_f32 v143, v94, v95
  v_mul_f32 v96, v24, v96
  v_mul_f32 v97, v24, v97
  v_mul_f32 v98, v24, v98
  v_mul_f32 v99, v24, v99
  v_cvt_pk_bf16_f32 v144, v96, v97
  v_cvt_pk_bf16_f32 v145, v98, v99
  v_mul_f32 v104, v24, v104
  v_mul_f32 v105, v24, v105
  v_mul_f32 v106, v24, v106
  v_mul_f32 v107, v24, v107
  v_cvt_pk_bf16_f32 v146, v104, v105
  v_cvt_pk_bf16_f32 v147, v106, v107
  v_mul_f32 v100, v26, v100
  v_mul_f32 v101, v26, v101
  v_mul_f32 v102, v26, v102
  v_mul_f32 v103, v26, v103
  v_cvt_pk_bf16_f32 v148, v100, v101
  v_cvt_pk_bf16_f32 v149, v102, v103
  v_mul_f32 v108, v26, v108
  v_mul_f32 v109, v26, v109
  v_mul_f32 v110, v26, v110
  v_mul_f32 v111, v26, v111
  v_cvt_pk_bf16_f32 v150, v108, v109
  v_cvt_pk_bf16_f32 v151, v110, v111
  v_mul_f32 v112, v24, v112
  v_mul_f32 v113, v24, v113
  v_mul_f32 v114, v24, v114
  v_mul_f32 v115, v24, v115
  v_cvt_pk_bf16_f32 v152, v112, v113
  v_cvt_pk_bf16_f32 v153, v114, v115
  v_mul_f32 v120, v24, v120
  v_mul_f32 v121, v24, v121
  v_mul_f32 v122, v24, v122
  v_mul_f32 v123, v24, v123
  v_cvt_pk_bf16_f32 v154, v120, v121
  v_cvt_pk_bf16_f32 v155, v122, v123
  v_mul_f32 v116, v26, v116
  v_mul_f32 v117, v26, v117
  v_mul_f32 v118, v26, v118
  v_mul_f32 v119, v26, v119
  v_cvt_pk_bf16_f32 v156, v116, v117
  v_cvt_pk_bf16_f32 v157, v118, v119
  v_mul_f32 v124, v26, v124
  v_mul_f32 v125, v26, v125
  v_mul_f32 v126, v26, v126
  v_mul_f32 v127, v26, v127
  v_cvt_pk_bf16_f32 v158, v124, v125
  v_cvt_pk_bf16_f32 v159, v126, v127
  v_permlane32_swap_b32 v128, v130
  v_permlane32_swap_b32 v129, v131
  v_permlane32_swap_b32 v132, v134
  v_permlane32_swap_b32 v133, v135
  v_permlane32_swap_b32 v136, v138
  v_permlane32_swap_b32 v137, v139
  v_permlane32_swap_b32 v140, v142
  v_permlane32_swap_b32 v141, v143
  v_permlane32_swap_b32 v144, v146
  v_permlane32_swap_b32 v145, v147
  v_permlane32_swap_b32 v148, v150
  v_permlane32_swap_b32 v149, v151
  v_permlane32_swap_b32 v152, v154
  v_permlane32_swap_b32 v153, v155
  v_permlane32_swap_b32 v156, v158
  v_permlane32_swap_b32 v157, v159
  v_permlane16_swap_b32 v128, v130
  v_permlane16_swap_b32 v129, v131
  v_permlane16_swap_b32 v132, v134
  v_permlane16_swap_b32 v133, v135
  v_permlane16_swap_b32 v136, v138
  v_permlane16_swap_b32 v137, v139
  v_permlane16_swap_b32 v140, v142
  v_permlane16_swap_b32 v141, v143
  v_permlane16_swap_b32 v144, v146
  v_permlane16_swap_b32 v145, v147
  v_permlane16_swap_b32 v148, v150
  v_permlane16_swap_b32 v149, v151
  v_permlane16_swap_b32 v152, v154
  v_permlane16_swap_b32 v153, v155
  v_permlane16_swap_b32 v156, v158
  v_permlane16_swap_b32 v157, v159
  v_lshrrev_b32 v28, 4, v1
  v_and_b32 v29, 15, v1
  v_lshlrev_b32 v27, 1, v28
  v_xor_b32 v29, v29, v27
  v_lshlrev_b32 v29, 4, v29
  s_lshl_b32 s68, s34, 4
  v_add_u32 v28, s68, v28
  v_lshl_add_u32 v18, v28, 10, v29
  v_xor_b32 v19, 0x80, v18
  v_mov_b64 v[64:65], 0
  v_mov_b64 v[66:67], 0
  v_mov_b64 v[68:69], 0
  v_mov_b64 v[70:71], 0
  v_mov_b64 v[72:73], 0
  v_mov_b64 v[74:75], 0
  v_mov_b64 v[76:77], 0
  v_mov_b64 v[78:79], 0
  v_mov_b64 v[80:81], 0
  v_mov_b64 v[82:83], 0
  v_mov_b64 v[84:85], 0
  v_mov_b64 v[86:87], 0
  v_mov_b64 v[88:89], 0
  v_mov_b64 v[90:91], 0
  v_mov_b64 v[92:93], 0
  v_mov_b64 v[94:95], 0
  v_mov_b64 v[96:97], 0
  v_mov_b64 v[98:99], 0
  v_mov_b64 v[100:101], 0
  v_mov_b64 v[102:103], 0
  v_mov_b64 v[104:105], 0
  v_mov_b64 v[106:107], 0
  v_mov_b64 v[108:109], 0
  v_mov_b64 v[110:111], 0
  v_mov_b64 v[112:113], 0
  v_mov_b64 v[114:115], 0
  v_mov_b64 v[116:117], 0
  v_mov_b64 v[118:119], 0
  v_mov_b64 v[120:121], 0
  v_mov_b64 v[122:123], 0
  v_mov_b64 v[124:125], 0
  v_mov_b64 v[126:127], 0
  s_lshl_b32 s69, s55, 1
  v_bfe_u32 v28, v1, 2, 3
  v_bfe_u32 v27, v1, 2, 2
  v_lshrrev_b32 v29, 4, v1
  v_lshl_add_u32 v29, v29, 3, v27
  v_lshlrev_b32 v29, 8, v29
  v_and_b32 v27, 3, v1
  v_lshl_add_u32 v29, v27, 3, v29
  v_add_u32 v29, 131072, v29
  v_xor_b32 v28, s69, v28
  v_xor_b32 v27, 0, v28
  v_lshl_add_u32 v6, v27, 5, v29
  v_xor_b32 v27, 1, v28
  v_lshl_add_u32 v7, v27, 5, v29
  v_xor_b32 v27, 2, v28
  v_lshl_add_u32 v8, v27, 5, v29
  v_xor_b32 v27, 3, v28
  v_lshl_add_u32 v9, v27, 5, v29
  v_xor_b32 v27, 4, v28
  v_lshl_add_u32 v10, v27, 5, v29
  v_xor_b32 v27, 5, v28
  v_lshl_add_u32 v11, v27, 5, v29
  v_xor_b32 v27, 6, v28
  v_lshl_add_u32 v12, v27, 5, v29
  v_xor_b32 v27, 7, v28
  v_lshl_add_u32 v13, v27, 5, v29
  s_add_u32 s69, s54, 1
  v_add_u32 v20, s69, v1
  v_and_b32 v20, 3, v20
  v_lshlrev_b32 v20, 5, v20
  s_and_b32 s69, s2, 0xe7
  s_lshl_b32 s69, s69, 2
  s_add_u32 s69, s69, s34
  v_add_u32 v20, s69, v20
  v_mul_u32_u24 v20, 384, v20
  v_add_u32 v20, 33554432, v20
  s_cmp_lt_u32 s34, 2
  s_mov_b32 s69, 114688
  s_cselect_b32 s69, s69, 16384
  s_add_u32 s69, s69, s44
  v_add_u32 v26, s69, v30
  s_barrier
  s_add_u32 s58, s54, 0
  s_and_b32 s58, s58, 3
  s_lshl_b32 s58, s58, 17
  s_add_u32 s58, s58, s48
  s_add_u32 m0, s60, 131072
  s_mov_b32 s68, s58
  buffer_load_dwordx4 v18, s[24:27], s68 offen offset:0 lds
  s_add_u32 m0, s60, 131072
  s_add_u32 s68, s58, 3072
  buffer_load_dwordx4 v18, s[24:27], s68 offen offset:1024 lds
  s_add_u32 m0, s60, 16384
  s_nop 0
  buffer_load_dwordx4 v14, s[4:7], s56 offen offset:0 nt lds
  buffer_load_dwordx4 v14, s[4:7], s56 offen offset:1024 nt lds
  buffer_load_dwordx4 v15, s[4:7], s56 offen offset:2048 nt lds
  buffer_load_dwordx4 v15, s[4:7], s56 offen offset:3072 nt lds
  s_add_u32 s56, s56, 16384
  s_add_u32 m0, s60, 114688
  s_nop 0
  buffer_load_dwordx4 v16, s[8:11], s57 offen offset:0 nt lds
  buffer_load_dwordx4 v16, s[8:11], s57 offen offset:1024 nt lds
  buffer_load_dwordx4 v17, s[8:11], s57 offen offset:2048 nt lds
  buffer_load_dwordx4 v17, s[8:11], s57 offen offset:3072 nt lds
  s_add_u32 s57, s57, 16384
  s_barrier
  s_add_u32 m0, s60, 131072
  s_add_u32 s68, s58, 6144
  buffer_load_dwordx4 v19, s[24:27], s68 offen offset:2048 lds
  s_add_u32 m0, s60, 131072
  s_add_u32 s68, s58, 9216
  buffer_load_dwordx4 v19, s[24:27], s68 offen offset:3072 lds
  s_add_u32 m0, s60, 32768
  s_nop 0
  buffer_load_dwordx4 v14, s[4:7], s56 offen offset:0 nt lds
  buffer_load_dwordx4 v14, s[4:7], s56 offen offset:1024 nt lds
  buffer_load_dwordx4 v15, s[4:7], s56 offen offset:2048 nt lds
  buffer_load_dwordx4 v15, s[4:7], s56 offen offset:3072 nt lds
  s_add_u32 s56, s56, 16384
  s_add_u32 m0, s60, 81920
  s_nop 0
  buffer_load_dwordx4 v16, s[8:11], s57 offen offset:0 nt lds
  buffer_load_dwordx4 v16, s[8:11], s57 offen offset:1024 nt lds
  buffer_load_dwordx4 v17, s[8:11], s57 offen offset:2048 nt lds
  buffer_load_dwordx4 v17, s[8:11], s57 offen offset:3072 nt lds
  s_add_u32 s57, s57, 16384
  s_waitcnt vmcnt(8)
  s_barrier
  s_add_u32 s58, s54, 0
  s_and_b32 s58, s58, 3
  s_lshl_b32 s58, s58, 17
  s_add_u32 s58, s58, s48
  s_add_u32 s58, s58, 65536
  s_add_u32 m0, s60, 147456
  s_mov_b32 s68, s58
  buffer_load_dwordx4 v18, s[24:27], s68 offen offset:0 lds
  ds_read_b64_tr_b16 v[224:225], v6 offset:0
  ds_read_b64_tr_b16 v[226:227], v6 offset:1024
  s_add_u32 m0, s60, 147456
  s_add_u32 s68, s58, 3072
  buffer_load_dwordx4 v18, s[24:27], s68 offen offset:1024 lds
  s_add_u32 m0, s60, 49152
  s_nop 0
  buffer_load_dwordx4 v14, s[4:7], s56 offen offset:0 nt lds
  ds_read_b64_tr_b16 v[228:229], v7 offset:0
  ds_read_b64_tr_b16 v[230:231], v7 offset:1024
  buffer_load_dwordx4 v14, s[4:7], s56 offen offset:1024 nt lds
  buffer_load_dwordx4 v15, s[4:7], s56 offen offset:2048 nt lds
  buffer_load_dwordx4 v15, s[4:7], s56 offen offset:3072 nt lds
  s_add_u32 s56, s56, 16384
  ds_read_b64_tr_b16 v[232:233], v8 offset:0
  ds_read_b64_tr_b16 v[234:235], v8 offset:1024
  s_add_u32 m0, s60, 98304
  s_nop 0
  buffer_load_dwordx4 v16, s[8:11], s57 offen offset:0 nt lds
  buffer_load_dwordx4 v16, s[8:11], s57 offen offset:1024 nt lds
  ds_read_b64_tr_b16 v[236:237], v9 offset:0
  ds_read_b64_tr_b16 v[238:239], v9 offset:1024
  buffer_load_dwordx4 v17, s[8:11], s57 offen offset:2048 nt lds
  buffer_load_dwordx4 v17, s[8:11], s57 offen offset:3072 nt lds
  s_add_u32 s57, s57, 16384
  s_waitcnt vmcnt(10)
  s_barrier
  s_add_u32 m0, s60, 147456
  s_add_u32 s68, s58, 6144
  buffer_load_dwordx4 v19, s[24:27], s68 offen offset:2048 lds
  ds_read_b64_tr_b16 v[240:241], v10 offset:0
  s_waitcnt lgkmcnt(7)
  ds_read_b64_tr_b16 v[242:243], v10 offset:1024
  s_add_u32 m0, s60, 147456
  s_add_u32 s68, s58, 9216
  buffer_load_dwordx4 v19, s[24:27], s68 offen offset:3072 lds
  v_mfma_f32_16x16x32_bf16 v[64:67], v[224:227], v[128:131], v[64:67]
  ds_read_b64_tr_b16 v[244:245], v11 offset:0
  v_mfma_f32_16x16x32_bf16 v[68:71], v[224:227], v[132:135], v[68:71]
  s_waitcnt lgkmcnt(7)
  ds_read_b64_tr_b16 v[246:247], v11 offset:1024
  s_add_u32 m0, s60, 16384
  s_nop 0
  buffer_load_dwordx4 v14, s[4:7], s56 offen offset:0 nt lds
  buffer_load_dwordx4 v14, s[4:7], s56 offen offset:1024 nt lds
  v_mfma_f32_16x16x32_bf16 v[72:75], v[228:231], v[128:131], v[72:75]
  ds_read_b64_tr_b16 v[248:249], v12 offset:0
  v_mfma_f32_16x16x32_bf16 v[76:79], v[228:231], v[132:135], v[76:79]
  s_waitcnt lgkmcnt(7)
  ds_read_b64_tr_b16 v[250:251], v12 offset:1024
  buffer_load_dwordx4 v15, s[4:7], s56 offen offset:2048 nt lds
  buffer_load_dwordx4 v15, s[4:7], s56 offen offset:3072 nt lds
  s_add_u32 s56, s56, 16384
  v_mfma_f32_16x16x32_bf16 v[80:83], v[232:235], v[128:131], v[80:83]
  ds_read_b64_tr_b16 v[252:253], v13 offset:0
  v_mfma_f32_16x16x32_bf16 v[84:87], v[232:235], v[132:135], v[84:87]
  s_waitcnt lgkmcnt(7)
  ds_read_b64_tr_b16 v[254:255], v13 offset:1024
  s_add_u32 m0, s60, 114688
  s_nop 0
  buffer_load_dwordx4 v16, s[8:11], s57 offen offset:0 nt lds
  s_mov_b32 s72, 0x4000
  v_mfma_f32_16x16x32_bf16 v[88:91], v[236:239], v[128:131], v[88:91]
  ds_read_b64_tr_b16 v[224:225], v6 offset:8192
  v_mfma_f32_16x16x32_bf16 v[92:95], v[236:239], v[132:135], v[92:95]
  s_waitcnt lgkmcnt(7)
  ds_read_b64_tr_b16 v[226:227], v6 offset:9216
  buffer_load_dwordx4 v16, s[8:11], s57 offen offset:1024 nt lds
  buffer_load_dwordx4 v17, s[8:11], s57 offen offset:2048 nt lds
  v_mfma_f32_16x16x32_bf16 v[96:99], v[240:243], v[128:131], v[96:99]
  ds_read_b64_tr_b16 v[228:229], v7 offset:8192
  v_add_u32 v6, s72, v6
  v_mfma_f32_16x16x32_bf16 v[100:103], v[240:243], v[132:135], v[100:103]
  s_waitcnt lgkmcnt(7)
  ds_read_b64_tr_b16 v[230:231], v7 offset:9216
  buffer_load_dwordx4 v17, s[8:11], s57 offen offset:3072 nt lds
  s_add_u32 s57, s57, 16384
  s_waitcnt vmcnt(10)
  s_barrier
  s_add_u32 s58, s54, 1
  s_and_b32 s58, s58, 3
  s_lshl_b32 s58, s58, 17
  s_add_u32 s58, s58, s48
  s_add_u32 m0, s60, 0
  s_mov_b32 s68, s58
  buffer_load_dwordx4 v18, s[24:27], s68 offen offset:0 lds
  v_mfma_f32_16x16x32_bf16 v[104:107], v[244:247], v[128:131], v[104:107]
  ds_read_b64_tr_b16 v[232:233], v8 offset:8192
  v_add_u32 v7, s72, v7
  v_mfma_f32_16x16x32_bf16 v[108:111], v[244:247], v[132:135], v[108:111]
  s_waitcnt lgkmcnt(7)
  ds_read_b64_tr_b16 v[234:235], v8 offset:9216
  s_add_u32 m0, s60, 0
  s_add_u32 s68, s58, 3072
  buffer_load_dwordx4 v18, s[24:27], s68 offen offset:1024 lds
  v_mfma_f32_16x16x32_bf16 v[112:115], v[248:251], v[128:131], v[112:115]
  ds_read_b64_tr_b16 v[236:237], v9 offset:8192
  v_add_u32 v8, s72, v8
  v_mfma_f32_16x16x32_bf16 v[116:119], v[248:251], v[132:135], v[116:119]
  s_waitcnt lgkmcnt(7)
  ds_read_b64_tr_b16 v[238:239], v9 offset:9216
  s_add_u32 m0, s60, 32768
  s_nop 0
  buffer_load_dwordx4 v14, s[4:7], s56 offen offset:0 nt lds
  buffer_load_dwordx4 v14, s[4:7], s56 offen offset:1024 nt lds
  v_mfma_f32_16x16x32_bf16 v[120:123], v[252:255], v[128:131], v[120:123]
  ds_read_b64_tr_b16 v[240:241], v10 offset:8192
  v_add_u32 v9, s72, v9
  v_mfma_f32_16x16x32_bf16 v[124:127], v[252:255], v[132:135], v[124:127]
  s_waitcnt lgkmcnt(7)
  ds_read_b64_tr_b16 v[242:243], v10 offset:9216
  buffer_load_dwordx4 v15, s[4:7], s56 offen offset:2048 nt lds
  buffer_load_dwordx4 v15, s[4:7], s56 offen offset:3072 nt lds
  s_add_u32 s56, s56, 16384
  v_mfma_f32_16x16x32_bf16 v[64:67], v[224:227], v[136:139], v[64:67]
  ds_read_b64_tr_b16 v[244:245], v11 offset:8192
  v_add_u32 v10, s72, v10
  v_mfma_f32_16x16x32_bf16 v[68:71], v[224:227], v[140:143], v[68:71]
  s_waitcnt lgkmcnt(7)
  ds_read_b64_tr_b16 v[246:247], v11 offset:9216
  s_add_u32 m0, s60, 81920
  s_nop 0
  buffer_load_dwordx4 v16, s[8:11], s57 offen offset:0 nt lds
  v_mfma_f32_16x16x32_bf16 v[72:75], v[228:231], v[136:139], v[72:75]
  ds_read_b64_tr_b16 v[248:249], v12 offset:8192
  v_add_u32 v11, s72, v11
  v_mfma_f32_16x16x32_bf16 v[76:79], v[228:231], v[140:143], v[76:79]
  s_waitcnt lgkmcnt(7)
  ds_read_b64_tr_b16 v[250:251], v12 offset:9216
  buffer_load_dwordx4 v16, s[8:11], s57 offen offset:1024 nt lds
  buffer_load_dwordx4 v17, s[8:11], s57 offen offset:2048 nt lds
  v_mfma_f32_16x16x32_bf16 v[80:83], v[232:235], v[136:139], v[80:83]
  ds_read_b64_tr_b16 v[252:253], v13 offset:8192
  v_add_u32 v12, s72, v12
  v_mfma_f32_16x16x32_bf16 v[84:87], v[232:235], v[140:143], v[84:87]
  s_waitcnt lgkmcnt(7)
  ds_read_b64_tr_b16 v[254:255], v13 offset:9216
  v_add_u32 v13, s72, v13
  buffer_load_dwordx4 v17, s[8:11], s57 offen offset:3072 nt lds
  s_add_u32 s57, s57, 16384
  s_waitcnt vmcnt(10)
  s_barrier
  s_add_u32 m0, s60, 0
  s_add_u32 s68, s58, 6144
  buffer_load_dwordx4 v19, s[24:27], s68 offen offset:2048 lds
  v_mfma_f32_16x16x32_bf16 v[88:91], v[236:239], v[136:139], v[88:91]
  ds_read_b64_tr_b16 v[224:225], v6 offset:0
  v_mfma_f32_16x16x32_bf16 v[92:95], v[236:239], v[140:143], v[92:95]
  s_waitcnt lgkmcnt(7)
  ds_read_b64_tr_b16 v[226:227], v6 offset:1024
  s_add_u32 m0, s60, 0
  s_add_u32 s68, s58, 9216
  buffer_load_dwordx4 v19, s[24:27], s68 offen offset:3072 lds
  v_mfma_f32_16x16x32_bf16 v[96:99], v[240:243], v[136:139], v[96:99]
  ds_read_b64_tr_b16 v[228:229], v7 offset:0
  v_mfma_f32_16x16x32_bf16 v[100:103], v[240:243], v[140:143], v[100:103]
  s_waitcnt lgkmcnt(7)
  ds_read_b64_tr_b16 v[230:231], v7 offset:1024
  s_add_u32 m0, s60, 49152
  s_nop 0
  buffer_load_dwordx4 v14, s[4:7], s56 offen offset:0 nt lds
  buffer_load_dwordx4 v14, s[4:7], s56 offen offset:1024 nt lds
  v_mfma_f32_16x16x32_bf16 v[104:107], v[244:247], v[136:139], v[104:107]
  ds_read_b64_tr_b16 v[232:233], v8 offset:0
  v_mfma_f32_16x16x32_bf16 v[108:111], v[244:247], v[140:143], v[108:111]
  s_waitcnt lgkmcnt(7)
  ds_read_b64_tr_b16 v[234:235], v8 offset:1024
  buffer_load_dwordx4 v15, s[4:7], s56 offen offset:2048 nt lds
  buffer_load_dwordx4 v15, s[4:7], s56 offen offset:3072 nt lds
  s_add_u32 s56, s56, 16384
  v_mfma_f32_16x16x32_bf16 v[112:115], v[248:251], v[136:139], v[112:115]
  ds_read_b64_tr_b16 v[236:237], v9 offset:0
  v_mfma_f32_16x16x32_bf16 v[116:119], v[248:251], v[140:143], v[116:119]
  s_waitcnt lgkmcnt(7)
  ds_read_b64_tr_b16 v[238:239], v9 offset:1024
  s_add_u32 m0, s60, 98304
  s_nop 0
  buffer_load_dwordx4 v16, s[8:11], s57 offen offset:0 nt lds
  v_mfma_f32_16x16x32_bf16 v[120:123], v[252:255], v[136:139], v[120:123]
  ds_read_b64_tr_b16 v[240:241], v10 offset:0
  v_mfma_f32_16x16x32_bf16 v[124:127], v[252:255], v[140:143], v[124:127]
  s_waitcnt lgkmcnt(7)
  ds_read_b64_tr_b16 v[242:243], v10 offset:1024
  buffer_load_dwordx4 v16, s[8:11], s57 offen offset:1024 nt lds
  buffer_load_dwordx4 v17, s[8:11], s57 offen offset:2048 nt lds
  v_mfma_f32_16x16x32_bf16 v[64:67], v[224:227], v[144:147], v[64:67]
  ds_read_b64_tr_b16 v[244:245], v11 offset:0
  v_mfma_f32_16x16x32_bf16 v[68:71], v[224:227], v[148:151], v[68:71]
  s_waitcnt lgkmcnt(7)
  ds_read_b64_tr_b16 v[246:247], v11 offset:1024
  buffer_load_dwordx4 v17, s[8:11], s57 offen offset:3072 nt lds
  s_add_u32 s57, s57, 16384
  s_waitcnt vmcnt(10)
  s_barrier
  s_add_u32 s58, s54, 1
  s_and_b32 s58, s58, 3
  s_lshl_b32 s58, s58, 17
  s_add_u32 s58, s58, s48
  s_add_u32 s58, s58, 65536
  s_add_u32 m0, s60, 65536
  s_mov_b32 s68, s58
  buffer_load_dwordx4 v18, s[24:27], s68 offen offset:0 lds
  v_mfma_f32_16x16x32_bf16 v[72:75], v[228:231], v[144:147], v[72:75]
  ds_read_b64_tr_b16 v[248:249], v12 offset:0
  v_mfma_f32_16x16x32_bf16 v[76:79], v[228:231], v[148:151], v[76:79]
  s_waitcnt lgkmcnt(7)
  ds_read_b64_tr_b16 v[250:251], v12 offset:1024
  s_add_u32 m0, s60, 65536
  s_add_u32 s68, s58, 3072
  buffer_load_dwordx4 v18, s[24:27], s68 offen offset:1024 lds
  v_mfma_f32_16x16x32_bf16 v[80:83], v[232:235], v[144:147], v[80:83]
  ds_read_b64_tr_b16 v[252:253], v13 offset:0
  v_mfma_f32_16x16x32_bf16 v[84:87], v[232:235], v[148:151], v[84:87]
  s_waitcnt lgkmcnt(7)
  ds_read_b64_tr_b16 v[254:255], v13 offset:1024
  s_add_u32 m0, s60, 16384
  s_nop 0
  buffer_load_dwordx4 v14, s[4:7], s56 offen offset:0 nt lds
  buffer_load_dwordx4 v14, s[4:7], s56 offen offset:1024 nt lds
  s_mov_b32 s72, 0xfffe4000
  v_mfma_f32_16x16x32_bf16 v[88:91], v[236:239], v[144:147], v[88:91]
  ds_read_b64_tr_b16 v[224:225], v6 offset:8192
  v_mfma_f32_16x16x32_bf16 v[92:95], v[236:239], v[148:151], v[92:95]
  s_waitcnt lgkmcnt(7)
  ds_read_b64_tr_b16 v[226:227], v6 offset:9216
  buffer_load_dwordx4 v15, s[4:7], s56 offen offset:2048 nt lds
  buffer_load_dwordx4 v15, s[4:7], s56 offen offset:3072 nt lds
  s_add_u32 s56, s56, 16384
  v_mfma_f32_16x16x32_bf16 v[96:99], v[240:243], v[144:147], v[96:99]
  ds_read_b64_tr_b16 v[228:229], v7 offset:8192
  v_add_u32 v6, s72, v6
  v_mfma_f32_16x16x32_bf16 v[100:103], v[240:243], v[148:151], v[100:103]
  s_waitcnt lgkmcnt(7)
  ds_read_b64_tr_b16 v[230:231], v7 offset:9216
  s_add_u32 m0, s60, 114688
  s_nop 0
  buffer_load_dwordx4 v16, s[8:11], s57 offen offset:0 nt lds
  v_mfma_f32_16x16x32_bf16 v[104:107], v[244:247], v[144:147], v[104:107]
  ds_read_b64_tr_b16 v[232:233], v8 offset:8192
  v_add_u32 v7, s72, v7
  v_mfma_f32_16x16x32_bf16 v[108:111], v[244:247], v[148:151], v[108:111]
  s_waitcnt lgkmcnt(7)
  ds_read_b64_tr_b16 v[234:235], v8 offset:9216
  buffer_load_dwordx4 v16, s[8:11], s57 offen offset:1024 nt lds
  buffer_load_dwordx4 v17, s[8:11], s57 offen offset:2048 nt lds
  v_mfma_f32_16x16x32_bf16 v[112:115], v[248:251], v[144:147], v[112:115]
  ds_read_b64_tr_b16 v[236:237], v9 offset:8192
  v_add_u32 v8, s72, v8
  v_mfma_f32_16x16x32_bf16 v[116:119], v[248:251], v[148:151], v[116:119]
  s_waitcnt lgkmcnt(7)
  ds_read_b64_tr_b16 v[238:239], v9 offset:9216
  buffer_load_dwordx4 v17, s[8:11], s57 offen offset:3072 nt lds
  s_add_u32 s57, s57, 16384
  s_waitcnt vmcnt(10)
  s_barrier
  s_add_u32 m0, s60, 65536
  s_add_u32 s68, s58, 6144
  buffer_load_dwordx4 v19, s[24:27], s68 offen offset:2048 lds
  v_mfma_f32_16x16x32_bf16 v[120:123], v[252:255], v[144:147], v[120:123]
  ds_read_b64_tr_b16 v[240:241], v10 offset:8192
  v_add_u32 v9, s72, v9
  v_mfma_f32_16x16x32_bf16 v[124:127], v[252:255], v[148:151], v[124:127]
  s_waitcnt lgkmcnt(7)
  ds_read_b64_tr_b16 v[242:243], v10 offset:9216
  s_add_u32 m0, s60, 65536
  s_add_u32 s68, s58, 9216
  buffer_load_dwordx4 v19, s[24:27], s68 offen offset:3072 lds
  s_add_u32 m0, s60, 32768
  s_nop 0
  buffer_load_dwordx4 v14, s[4:7], s56 offen offset:0 nt lds
  v_mfma_f32_16x16x32_bf16 v[64:67], v[224:227], v[152:155], v[64:67]
  ds_read_b64_tr_b16 v[244:245], v11 offset:8192
  v_add_u32 v10, s72, v10
  v_mfma_f32_16x16x32_bf16 v[68:71], v[224:227], v[156:159], v[68:71]
  s_waitcnt lgkmcnt(7)
  ds_read_b64_tr_b16 v[246:247], v11 offset:9216
  buffer_load_dwordx4 v14, s[4:7], s56 offen offset:1024 nt lds
  buffer_load_dwordx4 v15, s[4:7], s56 offen offset:2048 nt lds
  buffer_load_dwordx4 v15, s[4:7], s56 offen offset:3072 nt lds
  s_add_u32 s56, s56, 16384
  v_mfma_f32_16x16x32_bf16 v[72:75], v[228:231], v[152:155], v[72:75]
  ds_read_b64_tr_b16 v[248:249], v12 offset:8192
  v_add_u32 v11, s72, v11
  v_mfma_f32_16x16x32_bf16 v[76:79], v[228:231], v[156:159], v[76:79]
  s_waitcnt lgkmcnt(7)
  ds_read_b64_tr_b16 v[250:251], v12 offset:9216
  s_add_u32 m0, s60, 81920
  s_nop 0
  buffer_load_dwordx4 v16, s[8:11], s57 offen offset:0 nt lds
  buffer_load_dwordx4 v16, s[8:11], s57 offen offset:1024 nt lds
  v_mfma_f32_16x16x32_bf16 v[80:83], v[232:235], v[152:155], v[80:83]
  ds_read_b64_tr_b16 v[252:253], v13 offset:8192
  v_add_u32 v12, s72, v12
  v_mfma_f32_16x16x32_bf16 v[84:87], v[232:235], v[156:159], v[84:87]
  s_waitcnt lgkmcnt(7)
  ds_read_b64_tr_b16 v[254:255], v13 offset:9216
  v_add_u32 v13, s72, v13
  buffer_load_dwordx4 v17, s[8:11], s57 offen offset:2048 nt lds
  buffer_load_dwordx4 v17, s[8:11], s57 offen offset:3072 nt lds
  s_add_u32 s57, s57, 16384
  s_waitcnt lgkmcnt(0)
  s_waitcnt vmcnt(10)
  s_barrier
  s_add_u32 s58, s54, 2
  s_and_b32 s58, s58, 3
  s_lshl_b32 s58, s58, 17
  s_add_u32 s58, s58, s48
  s_add_u32 m0, s60, 131072
  s_mov_b32 s68, s58
  buffer_load_dwordx4 v18, s[24:27], s68 offen offset:0 lds
  s_add_u32 m0, s60, 131072
  s_add_u32 s68, s58, 3072
  buffer_load_dwordx4 v18, s[24:27], s68 offen offset:1024 lds
  s_add_u32 m0, s60, 49152
  s_nop 0
  buffer_load_dwordx4 v14, s[4:7], s56 offen offset:0 nt lds
  buffer_load_dwordx4 v14, s[4:7], s56 offen offset:1024 nt lds
  buffer_load_dwordx4 v15, s[4:7], s56 offen offset:2048 nt lds
  buffer_load_dwordx4 v15, s[4:7], s56 offen offset:3072 nt lds
  s_add_u32 s56, s56, 16384
  s_add_u32 m0, s60, 98304
  s_nop 0
  buffer_load_dwordx4 v16, s[8:11], s57 offen offset:0 nt lds
  buffer_load_dwordx4 v16, s[8:11], s57 offen offset:1024 nt lds
  buffer_load_dwordx4 v17, s[8:11], s57 offen offset:2048 nt lds
  buffer_load_dwordx4 v17, s[8:11], s57 offen offset:3072 nt lds
  s_add_u32 s57, s57, 16384
  v_mfma_f32_16x16x32_bf16 v[88:91], v[236:239], v[152:155], v[88:91]
  v_mfma_f32_16x16x32_bf16 v[92:95], v[236:239], v[156:159], v[92:95]
  v_mfma_f32_16x16x32_bf16 v[96:99], v[240:243], v[152:155], v[96:99]
  v_mfma_f32_16x16x32_bf16 v[100:103], v[240:243], v[156:159], v[100:103]
  v_mfma_f32_16x16x32_bf16 v[104:107], v[244:247], v[152:155], v[104:107]
  v_mfma_f32_16x16x32_bf16 v[108:111], v[244:247], v[156:159], v[108:111]
  v_mfma_f32_16x16x32_bf16 v[112:115], v[248:251], v[152:155], v[112:115]
  v_mfma_f32_16x16x32_bf16 v[116:119], v[248:251], v[156:159], v[116:119]
  v_mfma_f32_16x16x32_bf16 v[120:123], v[252:255], v[152:155], v[120:123]
  v_mfma_f32_16x16x32_bf16 v[124:127], v[252:255], v[156:159], v[124:127]
  s_waitcnt vmcnt(10)
  s_barrier
  s_add_u32 m0, s60, 131072
  s_add_u32 s68, s58, 6144
  buffer_load_dwordx4 v19, s[24:27], s68 offen offset:2048 lds
  s_add_u32 m0, s60, 131072
  s_add_u32 s68, s58, 9216
  buffer_load_dwordx4 v19, s[24:27], s68 offen offset:3072 lds
  s_add_u32 m0, s60, 16384
  s_nop 0
  buffer_load_dwordx4 v14, s[4:7], s56 offen offset:0 nt lds
  buffer_load_dwordx4 v14, s[4:7], s56 offen offset:1024 nt lds
  buffer_load_dwordx4 v15, s[4:7], s56 offen offset:2048 nt lds
  buffer_load_dwordx4 v15, s[4:7], s56 offen offset:3072 nt lds
  s_add_u32 s56, s56, 16384
  s_add_u32 m0, s60, 114688
  s_nop 0
  buffer_load_dwordx4 v16, s[8:11], s57 offen offset:0 nt lds
  buffer_load_dwordx4 v16, s[8:11], s57 offen offset:1024 nt lds
  buffer_load_dwordx4 v17, s[8:11], s57 offen offset:2048 nt lds
  buffer_load_dwordx4 v17, s[8:11], s57 offen offset:3072 nt lds
  s_add_u32 s57, s57, 16384
  s_waitcnt vmcnt(10)
  s_barrier
  s_add_u32 s58, s54, 2
  s_and_b32 s58, s58, 3
  s_lshl_b32 s58, s58, 17
  s_add_u32 s58, s58, s48
  s_add_u32 s58, s58, 65536
  s_add_u32 m0, s60, 147456
  s_mov_b32 s68, s58
  buffer_load_dwordx4 v18, s[24:27], s68 offen offset:0 lds
  s_add_u32 m0, s60, 147456
  s_add_u32 s68, s58, 3072
  buffer_load_dwordx4 v18, s[24:27], s68 offen offset:1024 lds
  s_add_u32 m0, s60, 32768
  s_nop 0
  buffer_load_dwordx4 v14, s[4:7], s56 offen offset:0 nt lds
  buffer_load_dwordx4 v14, s[4:7], s56 offen offset:1024 nt lds
  buffer_load_dwordx4 v15, s[4:7], s56 offen offset:2048 nt lds
  buffer_load_dwordx4 v15, s[4:7], s56 offen offset:3072 nt lds
  s_add_u32 s56, s56, 16384
  s_add_u32 m0, s60, 81920
  s_nop 0
  buffer_load_dwordx4 v16, s[8:11], s57 offen offset:0 nt lds
  buffer_load_dwordx4 v16, s[8:11], s57 offen offset:1024 nt lds
  buffer_load_dwordx4 v17, s[8:11], s57 offen offset:2048 nt lds
  buffer_load_dwordx4 v17, s[8:11], s57 offen offset:3072 nt lds
  s_add_u32 s57, s57, 16384
  s_waitcnt vmcnt(10)
  s_barrier
  s_add_u32 m0, s60, 147456
  s_add_u32 s68, s58, 6144
  buffer_load_dwordx4 v19, s[24:27], s68 offen offset:2048 lds
  s_add_u32 m0, s60, 147456
  s_add_u32 s68, s58, 9216
  buffer_load_dwordx4 v19, s[24:27], s68 offen offset:3072 lds
  s_add_u32 m0, s60, 49152
  s_nop 0
  buffer_load_dwordx4 v14, s[4:7], s56 offen offset:0 nt lds
  buffer_load_dwordx4 v14, s[4:7], s56 offen offset:1024 nt lds
  buffer_load_dwordx4 v15, s[4:7], s56 offen offset:2048 nt lds
  buffer_load_dwordx4 v15, s[4:7], s56 offen offset:3072 nt lds
  s_add_u32 s56, s56, 16384
  s_add_u32 m0, s60, 98304
  s_nop 0
  buffer_load_dwordx4 v16, s[8:11], s57 offen offset:0 nt lds
  buffer_load_dwordx4 v16, s[8:11], s57 offen offset:1024 nt lds
  buffer_load_dwordx4 v17, s[8:11], s57 offen offset:2048 nt lds
  buffer_load_dwordx4 v17, s[8:11], s57 offen offset:3072 nt lds
  s_add_u32 s57, s57, 16384
  s_waitcnt vmcnt(10)
  s_barrier
  v_lshrrev_b32 v22, 4, v1
  v_and_b32 v23, 15, v1
  v_lshlrev_b32 v23, 4, v23
  v_lshl_add_u32 v22, v22, 10, v23
  s_add_u32 s64, s54, s34
  s_and_b32 s64, s64, 3
  s_lshl_b32 s64, s64, 17
  s_add_u32 s64, s64, s48
  s_lshl_b32 s68, s53, 14
  s_add_u32 s64, s64, s68
  s_add_u32 s64, s64, 524288
  buffer_load_dwordx4 v[160:163], v22, s[24:27], s64 offen
  s_add_u32 s64, s64, 4096
  buffer_load_dwordx4 v[164:167], v22, s[24:27], s64 offen
  s_add_u32 m0, s60, 16384
  s_nop 0
  buffer_load_dwordx4 v14, s[4:7], s56 offen offset:0 nt lds
  buffer_load_dwordx4 v14, s[4:7], s56 offen offset:1024 nt lds
  buffer_load_dwordx4 v15, s[4:7], s56 offen offset:2048 nt lds
  buffer_load_dwordx4 v15, s[4:7], s56 offen offset:3072 nt lds
  s_add_u32 s56, s56, 16384
  s_add_u32 m0, s60, 114688
  s_nop 0
  buffer_load_dwordx4 v16, s[8:11], s57 offen offset:0 nt lds
  buffer_load_dwordx4 v16, s[8:11], s57 offen offset:1024 nt lds
  buffer_load_dwordx4 v17, s[8:11], s57 offen offset:2048 nt lds
  buffer_load_dwordx4 v17, s[8:11], s57 offen offset:3072 nt lds
  s_add_u32 s57, s57, 16384
  s_waitcnt vmcnt(10)
  s_barrier
  s_add_u32 s64, s64, 4096
  buffer_load_dwordx4 v[168:171], v22, s[24:27], s64 offen
  s_add_u32 s64, s64, 4096
  buffer_load_dwordx4 v[172:175], v22, s[24:27], s64 offen
  s_add_u32 m0, s60, 81920
  s_nop 0
  buffer_load_dwordx4 v16, s[8:11], s57 offen offset:0 nt lds
  buffer_load_dwordx4 v16, s[8:11], s57 offen offset:1024 nt lds
  buffer_load_dwordx4 v17, s[8:11], s57 offen offset:2048 nt lds
  buffer_load_dwordx4 v17, s[8:11], s57 offen offset:3072 nt lds
  s_add_u32 s57, s57, 16384
  s_waitcnt vmcnt(6)
  s_barrier
  buffer_store_dwordx4 v[128:131], v30, s[20:23], s70 offen offset:0 sc1
  buffer_store_dwordx4 v[132:135], v30, s[20:23], s70 offen offset:1024 sc1
  buffer_store_dwordx4 v[136:139], v30, s[20:23], s70 offen offset:2048 sc1
  buffer_store_dwordx4 v[140:143], v30, s[20:23], s70 offen offset:3072 sc1
  s_add_u32 s70, s70, 4096
  buffer_store_dwordx4 v[144:147], v30, s[20:23], s70 offen offset:0 sc1
  buffer_store_dwordx4 v[148:151], v30, s[20:23], s70 offen offset:1024 sc1
  buffer_store_dwordx4 v[152:155], v30, s[20:23], s70 offen offset:2048 sc1
  buffer_store_dwordx4 v[156:159], v30, s[20:23], s70 offen offset:3072 sc1
  s_add_u32 s58, s54, 0
  s_and_b32 s58, s58, 3
  s_lshl_b32 s58, s58, 17
  s_add_u32 s58, s58, s48
  s_add_u32 s58, s58, 524288
  s_add_u32 m0, s60, 32768
  s_mov_b32 s68, s58
  buffer_load_dwordx4 v18, s[24:27], s68 offen offset:0 lds
  s_add_u32 m0, s60, 32768
  s_add_u32 s68, s58, 3072
  buffer_load_dwordx4 v18, s[24:27], s68 offen offset:1024 lds
  s_add_u32 m0, s60, 32768
  s_add_u32 s68, s58, 6144
  buffer_load_dwordx4 v19, s[24:27], s68 offen offset:2048 lds
  s_add_u32 m0, s60, 32768
  s_add_u32 s68, s58, 9216
  buffer_load_dwordx4 v19, s[24:27], s68 offen offset:3072 lds
  s_add_u32 s58, s54, 0
  s_and_b32 s58, s58, 3
  s_lshl_b32 s58, s58, 17
  s_add_u32 s58, s58, s48
  s_add_u32 s58, s58, 589824
  s_add_u32 m0, s60, 49152
  s_mov_b32 s68, s58
  buffer_load_dwordx4 v18, s[24:27], s68 offen offset:0 lds
  s_add_u32 m0, s60, 49152
  s_add_u32 s68, s58, 3072
  buffer_load_dwordx4 v18, s[24:27], s68 offen offset:1024 lds
  s_add_u32 m0, s60, 49152
  s_add_u32 s68, s58, 6144
  buffer_load_dwordx4 v19, s[24:27], s68 offen offset:2048 lds
  s_add_u32 m0, s60, 49152
  s_add_u32 s68, s58, 9216
  buffer_load_dwordx4 v19, s[24:27], s68 offen offset:3072 lds
  s_waitcnt vmcnt(16)
  s_barrier
  s_add_u32 s58, s54, 3
  s_and_b32 s58, s58, 3
  s_lshl_b32 s58, s58, 17
  s_add_u32 s58, s58, s48
  s_add_u32 m0, s60, 98304
  s_mov_b32 s68, s58
  buffer_load_dwordx4 v18, s[24:27], s68 offen offset:0 lds
  s_add_u32 m0, s60, 98304
  s_add_u32 s68, s58, 3072
  buffer_load_dwordx4 v18, s[24:27], s68 offen offset:1024 lds
  s_add_u32 m0, s60, 98304
  s_add_u32 s68, s58, 6144
  buffer_load_dwordx4 v19, s[24:27], s68 offen offset:2048 lds
  s_add_u32 m0, s60, 98304
  s_add_u32 s68, s58, 9216
  buffer_load_dwordx4 v19, s[24:27], s68 offen offset:3072 lds
  s_waitcnt vmcnt(12)
  v_mov_b32 v28, s86
  v_mov_b32 v29, s87
  s_mov_b64 exec, 1
  buffer_store_dwordx2 v[28:29], off, s[20:23], s46 offset:0 sc1
  s_mov_b64 exec, -1
  s_waitcnt vmcnt(5)
  s_barrier
  ds_read_b128 v[128:131], v26 offset:0
  ds_read_b128 v[132:135], v26 offset:1024
  ds_read_b64_tr_b16 v[224:225], v6 offset:0
  ds_read_b64_tr_b16 v[226:227], v6 offset:1024
  s_add_u32 s58, s54, 3
  s_and_b32 s58, s58, 3
  s_lshl_b32 s58, s58, 17
  s_add_u32 s58, s58, s48
  s_add_u32 s58, s58, 65536
  s_add_u32 m0, s60, 81920
  s_mov_b32 s68, s58
  buffer_load_dwordx4 v18, s[24:27], s68 offen offset:0 lds
  ds_read_b64_tr_b16 v[228:229], v7 offset:0
  ds_read_b64_tr_b16 v[230:231], v7 offset:1024
  ds_read_b128 v[136:139], v26 offset:2048
  ds_read_b64_tr_b16 v[232:233], v8 offset:0
  ds_read_b64_tr_b16 v[234:235], v8 offset:1024
  ds_read_b128 v[140:143], v26 offset:3072
  ds_read_b64_tr_b16 v[236:237], v9 offset:0
  ds_read_b64_tr_b16 v[238:239], v9 offset:1024
  s_add_u32 m0, s60, 81920
  s_add_u32 s68, s58, 3072
  buffer_load_dwordx4 v18, s[24:27], s68 offen offset:1024 lds
  ds_read_b128 v[144:147], v26 offset:4096
  ds_read_b64_tr_b16 v[240:241], v10 offset:0
  s_waitcnt lgkmcnt(10)
  ds_read_b64_tr_b16 v[242:243], v10 offset:1024
  v_mfma_f32_16x16x32_bf16 v[64:67], v[224:227], v[128:131], v[64:67]
  ds_read_b128 v[148:151], v26 offset:5120
  ds_read_b64_tr_b16 v[244:245], v11 offset:0
  v_mfma_f32_16x16x32_bf16 v[68:71], v[224:227], v[132:135], v[68:71]
  s_waitcnt lgkmcnt(11)
  ds_read_b64_tr_b16 v[246:247], v11 offset:1024
  v_mfma_f32_16x16x32_bf16 v[72:75], v[228:231], v[128:131], v[72:75]
  ds_read_b128 v[152:155], v26 offset:6144
  ds_read_b64_tr_b16 v[248:249], v12 offset:0
  v_mfma_f32_16x16x32_bf16 v[76:79], v[228:231], v[132:135], v[76:79]
  s_waitcnt lgkmcnt(11)
  ds_read_b64_tr_b16 v[250:251], v12 offset:1024
  v_mfma_f32_16x16x32_bf16 v[80:83], v[232:235], v[128:131], v[80:83]
  ds_read_b128 v[156:159], v26 offset:7168
  ds_read_b64_tr_b16 v[252:253], v13 offset:0
  v_mfma_f32_16x16x32_bf16 v[84:87], v[232:235], v[132:135], v[84:87]
  s_waitcnt lgkmcnt(11)
  ds_read_b64_tr_b16 v[254:255], v13 offset:1024
  s_add_u32 m0, s60, 81920
  s_add_u32 s68, s58, 6144
  buffer_load_dwordx4 v19, s[24:27], s68 offen offset:2048 lds
  s_mov_b32 s72, 0x4000
  v_mfma_f32_16x16x32_bf16 v[88:91], v[236:239], v[128:131], v[88:91]
  ds_read_b64_tr_b16 v[224:225], v6 offset:8192
  v_mfma_f32_16x16x32_bf16 v[92:95], v[236:239], v[132:135], v[92:95]
  s_waitcnt lgkmcnt(10)
  ds_read_b64_tr_b16 v[226:227], v6 offset:9216
  v_mfma_f32_16x16x32_bf16 v[96:99], v[240:243], v[128:131], v[96:99]
  ds_read_b64_tr_b16 v[228:229], v7 offset:8192
  v_add_u32 v6, s72, v6
  v_mfma_f32_16x16x32_bf16 v[100:103], v[240:243], v[132:135], v[100:103]
  s_waitcnt lgkmcnt(9)
  ds_read_b64_tr_b16 v[230:231], v7 offset:9216
  v_mfma_f32_16x16x32_bf16 v[104:107], v[244:247], v[128:131], v[104:107]
  ds_read_b64_tr_b16 v[232:233], v8 offset:8192
  v_add_u32 v7, s72, v7
  v_mfma_f32_16x16x32_bf16 v[108:111], v[244:247], v[132:135], v[108:111]
  s_waitcnt lgkmcnt(8)
  ds_read_b64_tr_b16 v[234:235], v8 offset:9216
  s_add_u32 m0, s60, 81920
  s_add_u32 s68, s58, 9216
  buffer_load_dwordx4 v19, s[24:27], s68 offen offset:3072 lds
  v_mfma_f32_16x16x32_bf16 v[112:115], v[248:251], v[128:131], v[112:115]
  ds_read_b64_tr_b16 v[236:237], v9 offset:8192
  v_add_u32 v8, s72, v8
  v_mfma_f32_16x16x32_bf16 v[116:119], v[248:251], v[132:135], v[116:119]
  s_waitcnt lgkmcnt(7)
  ds_read_b64_tr_b16 v[238:239], v9 offset:9216
  v_mfma_f32_16x16x32_bf16 v[120:123], v[252:255], v[128:131], v[120:123]
  ds_read_b64_tr_b16 v[240:241], v10 offset:8192
  v_add_u32 v9, s72, v9
  v_mfma_f32_16x16x32_bf16 v[124:127], v[252:255], v[132:135], v[124:127]
  s_waitcnt lgkmcnt(7)
  ds_read_b64_tr_b16 v[242:243], v10 offset:9216
  v_mfma_f32_16x16x32_bf16 v[64:67], v[224:227], v[136:139], v[64:67]
  ds_read_b64_tr_b16 v[244:245], v11 offset:8192
  v_add_u32 v10, s72, v10
  v_mfma_f32_16x16x32_bf16 v[68:71], v[224:227], v[140:143], v[68:71]
  s_waitcnt lgkmcnt(7)
  ds_read_b64_tr_b16 v[246:247], v11 offset:9216
  v_mfma_f32_16x16x32_bf16 v[72:75], v[228:231], v[136:139], v[72:75]
  ds_read_b64_tr_b16 v[248:249], v12 offset:8192
  v_add_u32 v11, s72, v11
  v_mfma_f32_16x16x32_bf16 v[76:79], v[228:231], v[140:143], v[76:79]
  s_waitcnt lgkmcnt(7)
  ds_read_b64_tr_b16 v[250:251], v12 offset:9216
  v_mfma_f32_16x16x32_bf16 v[80:83], v[232:235], v[136:139], v[80:83]
  ds_read_b64_tr_b16 v[252:253], v13 offset:8192
  v_add_u32 v12, s72, v12
  v_mfma_f32_16x16x32_bf16 v[84:87], v[232:235], v[140:143], v[84:87]
  s_waitcnt lgkmcnt(7)
  ds_read_b64_tr_b16 v[254:255], v13 offset:9216
  v_add_u32 v13, s72, v13
  v_mfma_f32_16x16x32_bf16 v[88:91], v[236:239], v[136:139], v[88:91]
  ds_read_b64_tr_b16 v[224:225], v6 offset:0
  v_mfma_f32_16x16x32_bf16 v[92:95], v[236:239], v[140:143], v[92:95]
  s_waitcnt lgkmcnt(7)
  ds_read_b64_tr_b16 v[226:227], v6 offset:1024
  v_mfma_f32_16x16x32_bf16 v[96:99], v[240:243], v[136:139], v[96:99]
  ds_read_b64_tr_b16 v[228:229], v7 offset:0
  v_mfma_f32_16x16x32_bf16 v[100:103], v[240:243], v[140:143], v[100:103]
  s_waitcnt lgkmcnt(7)
  ds_read_b64_tr_b16 v[230:231], v7 offset:1024
  v_mfma_f32_16x16x32_bf16 v[104:107], v[244:247], v[136:139], v[104:107]
  ds_read_b64_tr_b16 v[232:233], v8 offset:0
  v_mfma_f32_16x16x32_bf16 v[108:111], v[244:247], v[140:143], v[108:111]
  s_waitcnt lgkmcnt(7)
  ds_read_b64_tr_b16 v[234:235], v8 offset:1024
  v_mfma_f32_16x16x32_bf16 v[112:115], v[248:251], v[136:139], v[112:115]
  ds_read_b64_tr_b16 v[236:237], v9 offset:0
  v_mfma_f32_16x16x32_bf16 v[116:119], v[248:251], v[140:143], v[116:119]
  s_waitcnt lgkmcnt(7)
  ds_read_b64_tr_b16 v[238:239], v9 offset:1024
  v_mfma_f32_16x16x32_bf16 v[120:123], v[252:255], v[136:139], v[120:123]
  ds_read_b64_tr_b16 v[240:241], v10 offset:0
  v_mfma_f32_16x16x32_bf16 v[124:127], v[252:255], v[140:143], v[124:127]
  s_waitcnt lgkmcnt(7)
  ds_read_b64_tr_b16 v[242:243], v10 offset:1024
  v_mfma_f32_16x16x32_bf16 v[64:67], v[224:227], v[144:147], v[64:67]
  ds_read_b64_tr_b16 v[244:245], v11 offset:0
  v_mfma_f32_16x16x32_bf16 v[68:71], v[224:227], v[148:151], v[68:71]
  s_waitcnt lgkmcnt(7)
  ds_read_b64_tr_b16 v[246:247], v11 offset:1024
  v_mfma_f32_16x16x32_bf16 v[72:75], v[228:231], v[144:147], v[72:75]
  ds_read_b64_tr_b16 v[248:249], v12 offset:0
  v_mfma_f32_16x16x32_bf16 v[76:79], v[228:231], v[148:151], v[76:79]
  s_waitcnt lgkmcnt(7)
  ds_read_b64_tr_b16 v[250:251], v12 offset:1024
  s_mov_b64 exec, 7
  buffer_load_dwordx2 v[24:25], v20, s[20:23], 0 offen offset:0 sc1
  s_mov_b64 exec, -1
  v_mfma_f32_16x16x32_bf16 v[80:83], v[232:235], v[144:147], v[80:83]
  ds_read_b64_tr_b16 v[252:253], v13 offset:0
  v_mfma_f32_16x16x32_bf16 v[84:87], v[232:235], v[148:151], v[84:87]
  s_waitcnt lgkmcnt(7)
  ds_read_b64_tr_b16 v[254:255], v13 offset:1024
  s_mov_b32 s72, 0xffff4000
  v_mfma_f32_16x16x32_bf16 v[88:91], v[236:239], v[144:147], v[88:91]
  ds_read_b64_tr_b16 v[224:225], v6 offset:8192
  v_mfma_f32_16x16x32_bf16 v[92:95], v[236:239], v[148:151], v[92:95]
  s_waitcnt lgkmcnt(7)
  ds_read_b64_tr_b16 v[226:227], v6 offset:9216
  v_mfma_f32_16x16x32_bf16 v[96:99], v[240:243], v[144:147], v[96:99]
  ds_read_b64_tr_b16 v[228:229], v7 offset:8192
  v_add_u32 v6, s72, v6
  v_mfma_f32_16x16x32_bf16 v[100:103], v[240:243], v[148:151], v[100:103]
  s_waitcnt lgkmcnt(7)
  ds_read_b64_tr_b16 v[230:231], v7 offset:9216
  v_mfma_f32_16x16x32_bf16 v[104:107], v[244:247], v[144:147], v[104:107]
  ds_read_b64_tr_b16 v[232:233], v8 offset:8192
  v_add_u32 v7, s72, v7
  v_mfma_f32_16x16x32_bf16 v[108:111], v[244:247], v[148:151], v[108:111]
  s_waitcnt lgkmcnt(7)
  ds_read_b64_tr_b16 v[234:235], v8 offset:9216
  v_mfma_f32_16x16x32_bf16 v[112:115], v[248:251], v[144:147], v[112:115]
  ds_read_b64_tr_b16 v[236:237], v9 offset:8192
  v_add_u32 v8, s72, v8
  v_mfma_f32_16x16x32_bf16 v[116:119], v[248:251], v[148:151], v[116:119]
  s_waitcnt lgkmcnt(7)
  ds_read_b64_tr_b16 v[238:239], v9 offset:9216
  v_mfma_f32_16x16x32_bf16 v[120:123], v[252:255], v[144:147], v[120:123]
  ds_read_b64_tr_b16 v[240:241], v10 offset:8192
  v_add_u32 v9, s72, v9
  v_mfma_f32_16x16x32_bf16 v[124:127], v[252:255], v[148:151], v[124:127]
  s_waitcnt lgkmcnt(7)
  ds_read_b64_tr_b16 v[242:243], v10 offset:9216
  v_mfma_f32_16x16x32_bf16 v[64:67], v[224:227], v[152:155], v[64:67]
  ds_read_b64_tr_b16 v[244:245], v11 offset:8192
  v_add_u32 v10, s72, v10
  v_mfma_f32_16x16x32_bf16 v[68:71], v[224:227], v[156:159], v[68:71]
  s_waitcnt lgkmcnt(7)
  ds_read_b64_tr_b16 v[246:247], v11 offset:9216
  v_mfma_f32_16x16x32_bf16 v[72:75], v[228:231], v[152:155], v[72:75]
  ds_read_b64_tr_b16 v[248:249], v12 offset:8192
  v_add_u32 v11, s72, v11
  v_mfma_f32_16x16x32_bf16 v[76:79], v[228:231], v[156:159], v[76:79]
  s_waitcnt lgkmcnt(7)
  ds_read_b64_tr_b16 v[250:251], v12 offset:9216
  v_mfma_f32_16x16x32_bf16 v[80:83], v[232:235], v[152:155], v[80:83]
  ds_read_b64_tr_b16 v[252:253], v13 offset:8192
  v_add_u32 v12, s72, v12
  v_mfma_f32_16x16x32_bf16 v[84:87], v[232:235], v[156:159], v[84:87]
  s_waitcnt lgkmcnt(7)
  ds_read_b64_tr_b16 v[254:255], v13 offset:9216
  v_add_u32 v13, s72, v13
  v_mfma_f32_16x16x32_bf16 v[88:91], v[236:239], v[152:155], v[88:91]
  v_mfma_f32_16x16x32_bf16 v[92:95], v[236:239], v[156:159], v[92:95]
  s_waitcnt lgkmcnt(6)
  v_mfma_f32_16x16x32_bf16 v[96:99], v[240:243], v[152:155], v[96:99]
  v_mfma_f32_16x16x32_bf16 v[100:103], v[240:243], v[156:159], v[100:103]
  s_waitcnt lgkmcnt(4)
  v_mfma_f32_16x16x32_bf16 v[104:107], v[244:247], v[152:155], v[104:107]
  s_waitcnt lgkmcnt(0)
  s_waitcnt vmcnt(0)
  s_mov_b32 s62, 262144
  s_mov_b64 exec, 7
  s_branch L_pollc1
L_poll1:
  s_sub_u32 s62, s62, 1
  s_cbranch_scc1 L_pollx1
  s_sleep 2
L_pollf1:
  buffer_load_dwordx2 v[24:25], v20, s[20:23], 0 offen offset:0 sc1
  s_waitcnt vmcnt(0)
L_pollc1:
  v_cmp_ne_u64 vcc, s[86:87], v[24:25]
  s_cbranch_vccnz L_poll1
L_pollx1:
  s_mov_b64 exec, -1
  s_add_u32 s69, s54, 1
  s_and_b32 s69, s69, 3
  s_lshl_b32 s69, s69, 15
  s_add_u32 s69, s69, s45
  buffer_load_dwordx4 v[160:163], v30, s[20:23], s69 offen offset:0 sc1
  buffer_load_dwordx4 v[164:167], v30, s[20:23], s69 offen offset:1024 sc1
  buffer_load_dwordx4 v[168:171], v30, s[20:23], s69 offen offset:2048 sc1
  buffer_load_dwordx4 v[172:175], v30, s[20:23], s69 offen offset:3072 sc1
  s_add_u32 s69, s69, 4096
  buffer_load_dwordx4 v[176:179], v30, s[20:23], s69 offen offset:0 sc1
  buffer_load_dwordx4 v[180:183], v30, s[20:23], s69 offen offset:1024 sc1
  buffer_load_dwordx4 v[184:187], v30, s[20:23], s69 offen offset:2048 sc1
  buffer_load_dwordx4 v[188:191], v30, s[20:23], s69 offen offset:3072 sc1
  s_barrier
  ds_read_b64_tr_b16 v[224:225], v6 offset:0
  ds_read_b64_tr_b16 v[226:227], v6 offset:1024
  v_mfma_f32_16x16x32_bf16 v[108:111], v[244:247], v[156:159], v[108:111]
  ds_read_b64_tr_b16 v[228:229], v7 offset:0
  ds_read_b64_tr_b16 v[230:231], v7 offset:1024
  s_add_u32 s69, s54, 2
  s_and_b32 s69, s69, 3
  s_lshl_b32 s69, s69, 15
  s_add_u32 s69, s69, s45
  buffer_load_dwordx4 v[192:195], v30, s[20:23], s69 offen offset:0 sc1
  v_mfma_f32_16x16x32_bf16 v[112:115], v[248:251], v[152:155], v[112:115]
  ds_read_b64_tr_b16 v[232:233], v8 offset:0
  ds_read_b64_tr_b16 v[234:235], v8 offset:1024
  v_mfma_f32_16x16x32_bf16 v[116:119], v[248:251], v[156:159], v[116:119]
  ds_read_b64_tr_b16 v[236:237], v9 offset:0
  ds_read_b64_tr_b16 v[238:239], v9 offset:1024
  buffer_load_dwordx4 v[196:199], v30, s[20:23], s69 offen offset:1024 sc1
  v_mfma_f32_16x16x32_bf16 v[120:123], v[252:255], v[152:155], v[120:123]
  ds_read_b64_tr_b16 v[240:241], v10 offset:0
  v_mfma_f32_16x16x32_bf16 v[124:127], v[252:255], v[156:159], v[124:127]
  s_waitcnt lgkmcnt(7)
  ds_read_b64_tr_b16 v[242:243], v10 offset:1024
  buffer_load_dwordx4 v[200:203], v30, s[20:23], s69 offen offset:2048 sc1
  s_waitcnt vmcnt(9)
  v_mfma_f32_16x16x32_bf16 v[64:67], v[224:227], v[160:163], v[64:67]
  ds_read_b64_tr_b16 v[244:245], v11 offset:0
  v_mfma_f32_16x16x32_bf16 v[68:71], v[224:227], v[164:167], v[68:71]
  s_waitcnt lgkmcnt(7)
  ds_read_b64_tr_b16 v[246:247], v11 offset:1024
  buffer_load_dwordx4 v[204:207], v30, s[20:23], s69 offen offset:3072 sc1
  v_mfma_f32_16x16x32_bf16 v[72:75], v[228:231], v[160:163], v[72:75]
  ds_read_b64_tr_b16 v[248:249], v12 offset:0
  v_mfma_f32_16x16x32_bf16 v[76:79], v[228:231], v[164:167], v[76:79]
  s_waitcnt lgkmcnt(7)
  ds_read_b64_tr_b16 v[250:251], v12 offset:1024
  s_add_u32 s69, s69, 4096
  buffer_load_dwordx4 v[208:211], v30, s[20:23], s69 offen offset:0 sc1
  v_mfma_f32_16x16x32_bf16 v[80:83], v[232:235], v[160:163], v[80:83]
  ds_read_b64_tr_b16 v[252:253], v13 offset:0
  v_mfma_f32_16x16x32_bf16 v[84:87], v[232:235], v[164:167], v[84:87]
  s_waitcnt lgkmcnt(7)
  ds_read_b64_tr_b16 v[254:255], v13 offset:1024
  buffer_load_dwordx4 v[212:215], v30, s[20:23], s69 offen offset:1024 sc1
  s_mov_b32 s72, 0x10000
  v_mfma_f32_16x16x32_bf16 v[88:91], v[236:239], v[160:163], v[88:91]
  ds_read_b64_tr_b16 v[224:225], v6 offset:8192
  v_mfma_f32_16x16x32_bf16 v[92:95], v[236:239], v[164:167], v[92:95]
  s_waitcnt lgkmcnt(7)
  ds_read_b64_tr_b16 v[226:227], v6 offset:9216
  buffer_load_dwordx4 v[216:219], v30, s[20:23], s69 offen offset:2048 sc1
  v_mfma_f32_16x16x32_bf16 v[96:99], v[240:243], v[160:163], v[96:99]
  ds_read_b64_tr_b16 v[228:229], v7 offset:8192
  v_add_u32 v6, s72, v6
  v_mfma_f32_16x16x32_bf16 v[100:103], v[240:243], v[164:167], v[100:103]
  s_waitcnt lgkmcnt(7)
  ds_read_b64_tr_b16 v[230:231], v7 offset:9216
  buffer_load_dwordx4 v[220:223], v30, s[20:23], s69 offen offset:3072 sc1
  v_mfma_f32_16x16x32_bf16 v[104:107], v[244:247], v[160:163], v[104:107]
  ds_read_b64_tr_b16 v[232:233], v8 offset:8192
  v_add_u32 v7, s72, v7
  v_mfma_f32_16x16x32_bf16 v[108:111], v[244:247], v[164:167], v[108:111]
  s_waitcnt lgkmcnt(7)
  ds_read_b64_tr_b16 v[234:235], v8 offset:9216
  s_add_u32 s58, s54, 1
  s_and_b32 s58, s58, 3
  s_lshl_b32 s58, s58, 17
  s_add_u32 s58, s58, s48
  s_add_u32 s58, s58, 524288
  s_add_u32 m0, s60, 32768
  s_mov_b32 s68, s58
  buffer_load_dwordx4 v18, s[24:27], s68 offen offset:0 lds
  v_mfma_f32_16x16x32_bf16 v[112:115], v[248:251], v[160:163], v[112:115]
  ds_read_b64_tr_b16 v[236:237], v9 offset:8192
  v_add_u32 v8, s72, v8
  v_mfma_f32_16x16x32_bf16 v[116:119], v[248:251], v[164:167], v[116:119]
  s_waitcnt lgkmcnt(7)
  ds_read_b64_tr_b16 v[238:239], v9 offset:9216
  s_add_u32 m0, s60, 32768
  s_add_u32 s68, s58, 3072
  buffer_load_dwordx4 v18, s[24:27], s68 offen offset:1024 lds
  v_mfma_f32_16x16x32_bf16 v[120:123], v[252:255], v[160:163], v[120:123]
  ds_read_b64_tr_b16 v[240:241], v10 offset:8192
  v_add_u32 v9, s72, v9
  v_mfma_f32_16x16x32_bf16 v[124:127], v[252:255], v[164:167], v[124:127]
  s_waitcnt lgkmcnt(7)
  ds_read_b64_tr_b16 v[242:243], v10 offset:9216
  s_add_u32 m0, s60, 32768
  s_add_u32 s68, s58, 6144
  buffer_load_dwordx4 v19, s[24:27], s68 offen offset:2048 lds
  s_waitcnt vmcnt(15)
  v_mfma_f32_16x16x32_bf16 v[64:67], v[224:227], v[168:171], v[64:67]
  ds_read_b64_tr_b16 v[244:245], v11 offset:8192
  v_add_u32 v10, s72, v10
  v_mfma_f32_16x16x32_bf16 v[68:71], v[224:227], v[172:175], v[68:71]
  s_waitcnt lgkmcnt(7)
  ds_read_b64_tr_b16 v[246:247], v11 offset:9216
  s_add_u32 m0, s60, 32768
  s_add_u32 s68, s58, 9216
  buffer_load_dwordx4 v19, s[24:27], s68 offen offset:3072 lds
  v_mfma_f32_16x16x32_bf16 v[72:75], v[228:231], v[168:171], v[72:75]
  ds_read_b64_tr_b16 v[248:249], v12 offset:8192
  v_add_u32 v11, s72, v11
  v_mfma_f32_16x16x32_bf16 v[76:79], v[228:231], v[172:175], v[76:79]
  s_waitcnt lgkmcnt(7)
  ds_read_b64_tr_b16 v[250:251], v12 offset:9216
  v_mfma_f32_16x16x32_bf16 v[80:83], v[232:235], v[168:171], v[80:83]
  ds_read_b64_tr_b16 v[252:253], v13 offset:8192
  v_add_u32 v12, s72, v12
  v_mfma_f32_16x16x32_bf16 v[84:87], v[232:235], v[172:175], v[84:87]
  s_waitcnt lgkmcnt(7)
  ds_read_b64_tr_b16 v[254:255], v13 offset:9216
  v_add_u32 v13, s72, v13
  v_mfma_f32_16x16x32_bf16 v[88:91], v[236:239], v[168:171], v[88:91]
  ds_read_b64_tr_b16 v[224:225], v6 offset:0
  v_mfma_f32_16x16x32_bf16 v[92:95], v[236:239], v[172:175], v[92:95]
  s_waitcnt lgkmcnt(7)
  ds_read_b64_tr_b16 v[226:227], v6 offset:1024
  s_add_u32 s69, s54, 3
  s_and_b32 s69, s69, 3
  s_lshl_b32 s69, s69, 15
  s_add_u32 s69, s69, s45
  buffer_load_dwordx4 v[32:35], v30, s[20:23], s69 offen offset:0 sc1
  v_mfma_f32_16x16x32_bf16 v[96:99], v[240:243], v[168:171], v[96:99]
  ds_read_b64_tr_b16 v[228:229], v7 offset:0
  v_mfma_f32_16x16x32_bf16 v[100:103], v[240:243], v[172:175], v[100:103]
  s_waitcnt lgkmcnt(7)
  ds_read_b64_tr_b16 v[230:231], v7 offset:1024
  buffer_load_dwordx4 v[36:39], v30, s[20:23], s69 offen offset:1024 sc1
  v_mfma_f32_16x16x32_bf16 v[104:107], v[244:247], v[168:171], v[104:107]
  ds_read_b64_tr_b16 v[232:233], v8 offset:0
  v_mfma_f32_16x16x32_bf16 v[108:111], v[244:247], v[172:175], v[108:111]
  s_waitcnt lgkmcnt(7)
  ds_read_b64_tr_b16 v[234:235], v8 offset:1024
  buffer_load_dwordx4 v[40:43], v30, s[20:23], s69 offen offset:2048 sc1
  v_mfma_f32_16x16x32_bf16 v[112:115], v[248:251], v[168:171], v[112:115]
  ds_read_b64_tr_b16 v[236:237], v9 offset:0
  v_mfma_f32_16x16x32_bf16 v[116:119], v[248:251], v[172:175], v[116:119]
  s_waitcnt lgkmcnt(7)
  ds_read_b64_tr_b16 v[238:239], v9 offset:1024
  buffer_load_dwordx4 v[44:47], v30, s[20:23], s69 offen offset:3072 sc1
  v_mfma_f32_16x16x32_bf16 v[120:123], v[252:255], v[168:171], v[120:123]
  ds_read_b64_tr_b16 v[240:241], v10 offset:0
  v_mfma_f32_16x16x32_bf16 v[124:127], v[252:255], v[172:175], v[124:127]
  s_waitcnt lgkmcnt(7)
  ds_read_b64_tr_b16 v[242:243], v10 offset:1024
  s_add_u32 s69, s69, 4096
  buffer_load_dwordx4 v[48:51], v30, s[20:23], s69 offen offset:0 sc1
  s_waitcnt vmcnt(19)
  v_mfma_f32_16x16x32_bf16 v[64:67], v[224:227], v[176:179], v[64:67]
  ds_read_b64_tr_b16 v[244:245], v11 offset:0
  v_mfma_f32_16x16x32_bf16 v[68:71], v[224:227], v[180:183], v[68:71]
  s_waitcnt lgkmcnt(7)
  ds_read_b64_tr_b16 v[246:247], v11 offset:1024
  buffer_load_dwordx4 v[52:55], v30, s[20:23], s69 offen offset:1024 sc1
  v_mfma_f32_16x16x32_bf16 v[72:75], v[228:231], v[176:179], v[72:75]
  ds_read_b64_tr_b16 v[248:249], v12 offset:0
  v_mfma_f32_16x16x32_bf16 v[76:79], v[228:231], v[180:183], v[76:79]
  s_waitcnt lgkmcnt(7)
  ds_read_b64_tr_b16 v[250:251], v12 offset:1024
  v_mfma_f32_16x16x32_bf16 v[80:83], v[232:235], v[176:179], v[80:83]
  ds_read_b64_tr_b16 v[252:253], v13 offset:0
  v_mfma_f32_16x16x32_bf16 v[84:87], v[232:235], v[180:183], v[84:87]
  s_waitcnt lgkmcnt(7)
  ds_read_b64_tr_b16 v[254:255], v13 offset:1024
  buffer_load_dwordx4 v[56:59], v30, s[20:23], s69 offen offset:2048 sc1
  s_mov_b32 s72, 0x10000
  v_mfma_f32_16x16x32_bf16 v[88:91], v[236:239], v[176:179], v[88:91]
  ds_read_b64_tr_b16 v[224:225], v6 offset:8192
  v_mfma_f32_16x16x32_bf16 v[92:95], v[236:239], v[180:183], v[92:95]
  s_waitcnt lgkmcnt(7)
  ds_read_b64_tr_b16 v[226:227], v6 offset:9216
  buffer_load_dwordx4 v[60:63], v30, s[20:23], s69 offen offset:3072 sc1
  v_mfma_f32_16x16x32_bf16 v[96:99], v[240:243], v[176:179], v[96:99]
  ds_read_b64_tr_b16 v[228:229], v7 offset:8192
  v_add_u32 v6, s72, v6
  v_mfma_f32_16x16x32_bf16 v[100:103], v[240:243], v[180:183], v[100:103]
  s_waitcnt lgkmcnt(7)
  ds_read_b64_tr_b16 v[230:231], v7 offset:9216
  s_add_u32 s58, s54, 1
  s_and_b32 s58, s58, 3
  s_lshl_b32 s58, s58, 17
  s_add_u32 s58, s58, s48
  s_add_u32 s58, s58, 589824
  s_add_u32 m0, s60, 49152
  s_mov_b32 s68, s58
  buffer_load_dwordx4 v18, s[24:27], s68 offen offset:0 lds
  v_mfma_f32_16x16x32_bf16 v[104:107], v[244:247], v[176:179], v[104:107]
  ds_read_b64_tr_b16 v[232:233], v8 offset:8192
  v_add_u32 v7, s72, v7
  v_mfma_f32_16x16x32_bf16 v[108:111], v[244:247], v[180:183], v[108:111]
  s_waitcnt lgkmcnt(7)
  ds_read_b64_tr_b16 v[234:235], v8 offset:9216
  s_add_u32 m0, s60, 49152
  s_add_u32 s68, s58, 3072
  buffer_load_dwordx4 v18, s[24:27], s68 offen offset:1024 lds
  v_mfma_f32_16x16x32_bf16 v[112:115], v[248:251], v[176:179], v[112:115]
  ds_read_b64_tr_b16 v[236:237], v9 offset:8192
  v_add_u32 v8, s72, v8
  v_mfma_f32_16x16x32_bf16 v[116:119], v[248:251], v[180:183], v[116:119]
  s_waitcnt lgkmcnt(7)
  ds_read_b64_tr_b16 v[238:239], v9 offset:9216
  s_add_u32 m0, s60, 49152
  s_add_u32 s68, s58, 6144
  buffer_load_dwordx4 v19, s[24:27], s68 offen offset:2048 lds
  v_mfma_f32_16x16x32_bf16 v[120:123], v[252:255], v[176:179], v[120:123]
  ds_read_b64_tr_b16 v[240:241], v10 offset:8192
  v_add_u32 v9, s72, v9
  v_mfma_f32_16x16x32_bf16 v[124:127], v[252:255], v[180:183], v[124:127]
  s_waitcnt lgkmcnt(7)
  ds_read_b64_tr_b16 v[242:243], v10 offset:9216
  s_add_u32 m0, s60, 49152
  s_add_u32 s68, s58, 9216
  buffer_load_dwordx4 v19, s[24:27], s68 offen offset:3072 lds
  s_waitcnt vmcnt(24)
  v_mfma_f32_16x16x32_bf16 v[64:67], v[224:227], v[184:187], v[64:67]
  ds_read_b64_tr_b16 v[244:245], v11 offset:8192
  v_add_u32 v10, s72, v10
  v_mfma_f32_16x16x32_bf16 v[68:71], v[224:227], v[188:191], v[68:71]
  s_waitcnt lgkmcnt(7)
  ds_read_b64_tr_b16 v[246:247], v11 offset:9216
  v_mfma_f32_16x16x32_bf16 v[72:75], v[228:231], v[184:187], v[72:75]
  ds_read_b64_tr_b16 v[248:249], v12 offset:8192
  v_add_u32 v11, s72, v11
  v_mfma_f32_16x16x32_bf16 v[76:79], v[228:231], v[188:191], v[76:79]
  s_waitcnt lgkmcnt(7)
  ds_read_b64_tr_b16 v[250:251], v12 offset:9216
  v_mfma_f32_16x16x32_bf16 v[80:83], v[232:235], v[184:187], v[80:83]
  ds_read_b64_tr_b16 v[252:253], v13 offset:8192
  v_add_u32 v12, s72, v12
  v_mfma_f32_16x16x32_bf16 v[84:87], v[232:235], v[188:191], v[84:87]
  s_waitcnt lgkmcnt(7)
  ds_read_b64_tr_b16 v[254:255], v13 offset:9216
  v_add_u32 v13, s72, v13
  v_mfma_f32_16x16x32_bf16 v[88:91], v[236:239], v[184:187], v[88:91]
  v_mfma_f32_16x16x32_bf16 v[92:95], v[236:239], v[188:191], v[92:95]
  s_waitcnt lgkmcnt(6)
  v_mfma_f32_16x16x32_bf16 v[96:99], v[240:243], v[184:187], v[96:99]
  v_mfma_f32_16x16x32_bf16 v[100:103], v[240:243], v[188:191], v[100:103]
  s_waitcnt lgkmcnt(4)
  v_mfma_f32_16x16x32_bf16 v[104:107], v[244:247], v[184:187], v[104:107]
  s_waitcnt lgkmcnt(0)
  s_barrier
  ds_read_b64_tr_b16 v[224:225], v6 offset:0
  ds_read_b64_tr_b16 v[226:227], v6 offset:1024
  v_mfma_f32_16x16x32_bf16 v[108:111], v[244:247], v[188:191], v[108:111]
  ds_read_b64_tr_b16 v[228:229], v7 offset:0
  ds_read_b64_tr_b16 v[230:231], v7 offset:1024
  s_add_u32 s58, s54, 2
  s_and_b32 s58, s58, 3
  s_lshl_b32 s58, s58, 17
  s_add_u32 s58, s58, s48
  s_add_u32 s58, s58, 524288
  s_add_u32 m0, s60, 0
  s_mov_b32 s68, s58
  buffer_load_dwordx4 v18, s[24:27], s68 offen offset:0 lds
  v_mfma_f32_16x16x32_bf16 v[112:115], v[248:251], v[184:187], v[112:115]
  ds_read_b64_tr_b16 v[232:233], v8 offset:0
  ds_read_b64_tr_b16 v[234:235], v8 offset:1024
  v_mfma_f32_16x16x32_bf16 v[116:119], v[248:251], v[188:191], v[116:119]
  ds_read_b64_tr_b16 v[236:237], v9 offset:0
  ds_read_b64_tr_b16 v[238:239], v9 offset:1024
  v_mfma_f32_16x16x32_bf16 v[120:123], v[252:255], v[184:187], v[120:123]
  ds_read_b64_tr_b16 v[240:241], v10 offset:0
  v_mfma_f32_16x16x32_bf16 v[124:127], v[252:255], v[188:191], v[124:127]
  s_waitcnt lgkmcnt(7)
  ds_read_b64_tr_b16 v[242:243], v10 offset:1024
  s_waitcnt vmcnt(23)
  v_mfma_f32_16x16x32_bf16 v[64:67], v[224:227], v[192:195], v[64:67]
  ds_read_b64_tr_b16 v[244:245], v11 offset:0
  v_mfma_f32_16x16x32_bf16 v[68:71], v[224:227], v[196:199], v[68:71]
  s_waitcnt lgkmcnt(7)
  ds_read_b64_tr_b16 v[246:247], v11 offset:1024
  s_add_u32 m0, s60, 0
  s_add_u32 s68, s58, 3072
  buffer_load_dwordx4 v18, s[24:27], s68 offen offset:1024 lds
  v_mfma_f32_16x16x32_bf16 v[72:75], v[228:231], v[192:195], v[72:75]
  ds_read_b64_tr_b16 v[248:249], v12 offset:0
  v_mfma_f32_16x16x32_bf16 v[76:79], v[228:231], v[196:199], v[76:79]
  s_waitcnt lgkmcnt(7)
  ds_read_b64_tr_b16 v[250:251], v12 offset:1024
  v_mfma_f32_16x16x32_bf16 v[80:83], v[232:235], v[192:195], v[80:83]
  ds_read_b64_tr_b16 v[252:253], v13 offset:0
  v_mfma_f32_16x16x32_bf16 v[84:87], v[232:235], v[196:199], v[84:87]
  s_waitcnt lgkmcnt(7)
  ds_read_b64_tr_b16 v[254:255], v13 offset:1024
  s_mov_b32 s72, 0x4000
  v_mfma_f32_16x16x32_bf16 v[88:91], v[236:239], v[192:195], v[88:91]
  ds_read_b64_tr_b16 v[224:225], v6 offset:8192
  v_mfma_f32_16x16x32_bf16 v[92:95], v[236:239], v[196:199], v[92:95]
  s_waitcnt lgkmcnt(7)
  ds_read_b64_tr_b16 v[226:227], v6 offset:9216
  s_add_u32 m0, s60, 0
  s_add_u32 s68, s58, 6144
  buffer_load_dwordx4 v19, s[24:27], s68 offen offset:2048 lds
  v_mfma_f32_16x16x32_bf16 v[96:99], v[240:243], v[192:195], v[96:99]
  ds_read_b64_tr_b16 v[228:229], v7 offset:8192
  v_add_u32 v6, s72, v6
  v_mfma_f32_16x16x32_bf16 v[100:103], v[240:243], v[196:199], v[100:103]
  s_waitcnt lgkmcnt(7)
  ds_read_b64_tr_b16 v[230:231], v7 offset:9216
  v_mfma_f32_16x16x32_bf16 v[104:107], v[244:247], v[192:195], v[104:107]
  ds_read_b64_tr_b16 v[232:233], v8 offset:8192
  v_add_u32 v7, s72, v7
  v_mfma_f32_16x16x32_bf16 v[108:111], v[244:247], v[196:199], v[108:111]
  s_waitcnt lgkmcnt(7)
  ds_read_b64_tr_b16 v[234:235], v8 offset:9216
  v_mfma_f32_16x16x32_bf16 v[112:115], v[248:251], v[192:195], v[112:115]
  ds_read_b64_tr_b16 v[236:237], v9 offset:8192
  v_add_u32 v8, s72, v8
  v_mfma_f32_16x16x32_bf16 v[116:119], v[248:251], v[196:199], v[116:119]
  s_waitcnt lgkmcnt(7)
  ds_read_b64_tr_b16 v[238:239], v9 offset:9216
  s_add_u32 m0, s60, 0
  s_add_u32 s68, s58, 9216
  buffer_load_dwordx4 v19, s[24:27], s68 offen offset:3072 lds
  v_mfma_f32_16x16x32_bf16 v[120:123], v[252:255], v[192:195], v[120:123]
  ds_read_b64_tr_b16 v[240:241], v10 offset:8192
  v_add_u32 v9, s72, v9
  v_mfma_f32_16x16x32_bf16 v[124:127], v[252:255], v[196:199], v[124:127]
  s_waitcnt lgkmcnt(7)
  ds_read_b64_tr_b16 v[242:243], v10 offset:9216
  s_waitcnt vmcnt(24)
  v_mfma_f32_16x16x32_bf16 v[64:67], v[224:227], v[200:203], v[64:67]
  ds_read_b64_tr_b16 v[244:245], v11 offset:8192
  v_add_u32 v10, s72, v10
  v_mfma_f32_16x16x32_bf16 v[68:71], v[224:227], v[204:207], v[68:71]
  s_waitcnt lgkmcnt(7)
  ds_read_b64_tr_b16 v[246:247], v11 offset:9216
  v_mfma_f32_16x16x32_bf16 v[72:75], v[228:231], v[200:203], v[72:75]
  ds_read_b64_tr_b16 v[248:249], v12 offset:8192
  v_add_u32 v11, s72, v11
  v_mfma_f32_16x16x32_bf16 v[76:79], v[228:231], v[204:207], v[76:79]
  s_waitcnt lgkmcnt(7)
  ds_read_b64_tr_b16 v[250:251], v12 offset:9216
  v_mfma_f32_16x16x32_bf16 v[80:83], v[232:235], v[200:203], v[80:83]
  ds_read_b64_tr_b16 v[252:253], v13 offset:8192
  v_add_u32 v12, s72, v12
  v_mfma_f32_16x16x32_bf16 v[84:87], v[232:235], v[204:207], v[84:87]
  s_waitcnt lgkmcnt(7)
  ds_read_b64_tr_b16 v[254:255], v13 offset:9216
  v_add_u32 v13, s72, v13
  v_mfma_f32_16x16x32_bf16 v[88:91], v[236:239], v[200:203], v[88:91]
  ds_read_b64_tr_b16 v[224:225], v6 offset:0
  v_mfma_f32_16x16x32_bf16 v[92:95], v[236:239], v[204:207], v[92:95]
  s_waitcnt lgkmcnt(7)
  ds_read_b64_tr_b16 v[226:227], v6 offset:1024
  s_add_u32 s58, s54, 2
  s_and_b32 s58, s58, 3
  s_lshl_b32 s58, s58, 17
  s_add_u32 s58, s58, s48
  s_add_u32 s58, s58, 589824
  s_add_u32 m0, s60, 65536
  s_mov_b32 s68, s58
  buffer_load_dwordx4 v18, s[24:27], s68 offen offset:0 lds
  v_mfma_f32_16x16x32_bf16 v[96:99], v[240:243], v[200:203], v[96:99]
  ds_read_b64_tr_b16 v[228:229], v7 offset:0
  v_mfma_f32_16x16x32_bf16 v[100:103], v[240:243], v[204:207], v[100:103]
  s_waitcnt lgkmcnt(7)
  ds_read_b64_tr_b16 v[230:231], v7 offset:1024
  v_mfma_f32_16x16x32_bf16 v[104:107], v[244:247], v[200:203], v[104:107]
  ds_read_b64_tr_b16 v[232:233], v8 offset:0
  v_mfma_f32_16x16x32_bf16 v[108:111], v[244:247], v[204:207], v[108:111]
  s_waitcnt lgkmcnt(7)
  ds_read_b64_tr_b16 v[234:235], v8 offset:1024
  v_mfma_f32_16x16x32_bf16 v[112:115], v[248:251], v[200:203], v[112:115]
  ds_read_b64_tr_b16 v[236:237], v9 offset:0
  v_mfma_f32_16x16x32_bf16 v[116:119], v[248:251], v[204:207], v[116:119]
  s_waitcnt lgkmcnt(7)
  ds_read_b64_tr_b16 v[238:239], v9 offset:1024
  s_add_u32 m0, s60, 65536
  s_add_u32 s68, s58, 3072
  buffer_load_dwordx4 v18, s[24:27], s68 offen offset:1024 lds
  v_mfma_f32_16x16x32_bf16 v[120:123], v[252:255], v[200:203], v[120:123]
  ds_read_b64_tr_b16 v[240:241], v10 offset:0
  v_mfma_f32_16x16x32_bf16 v[124:127], v[252:255], v[204:207], v[124:127]
  s_waitcnt lgkmcnt(7)
  ds_read_b64_tr_b16 v[242:243], v10 offset:1024
  s_waitcnt vmcnt(24)
  v_mfma_f32_16x16x32_bf16 v[64:67], v[224:227], v[208:211], v[64:67]
  ds_read_b64_tr_b16 v[244:245], v11 offset:0
  v_mfma_f32_16x16x32_bf16 v[68:71], v[224:227], v[212:215], v[68:71]
  s_waitcnt lgkmcnt(7)
  ds_read_b64_tr_b16 v[246:247], v11 offset:1024
  v_mfma_f32_16x16x32_bf16 v[72:75], v[228:231], v[208:211], v[72:75]
  ds_read_b64_tr_b16 v[248:249], v12 offset:0
  v_mfma_f32_16x16x32_bf16 v[76:79], v[228:231], v[212:215], v[76:79]
  s_waitcnt lgkmcnt(7)
  ds_read_b64_tr_b16 v[250:251], v12 offset:1024
  s_mov_b64 exec, 7
  buffer_load_dwordx2 v[24:25], v20, s[20:23], 0 offen offset:128 sc1
  s_mov_b64 exec, -1
  v_mfma_f32_16x16x32_bf16 v[80:83], v[232:235], v[208:211], v[80:83]
  ds_read_b64_tr_b16 v[252:253], v13 offset:0
  v_mfma_f32_16x16x32_bf16 v[84:87], v[232:235], v[212:215], v[84:87]
  s_waitcnt lgkmcnt(7)
  ds_read_b64_tr_b16 v[254:255], v13 offset:1024
  s_add_u32 m0, s60, 65536
  s_add_u32 s68, s58, 6144
  buffer_load_dwordx4 v19, s[24:27], s68 offen offset:2048 lds
  s_mov_b32 s72, 0xffff4000
  v_mfma_f32_16x16x32_bf16 v[88:91], v[236:239], v[208:211], v[88:91]
  ds_read_b64_tr_b16 v[224:225], v6 offset:8192
  v_mfma_f32_16x16x32_bf16 v[92:95], v[236:239], v[212:215], v[92:95]
  s_waitcnt lgkmcnt(7)
  ds_read_b64_tr_b16 v[226:227], v6 offset:9216
  v_mfma_f32_16x16x32_bf16 v[96:99], v[240:243], v[208:211], v[96:99]
  ds_read_b64_tr_b16 v[228:229], v7 offset:8192
  v_add_u32 v6, s72, v6
  v_mfma_f32_16x16x32_bf16 v[100:103], v[240:243], v[212:215], v[100:103]
  s_waitcnt lgkmcnt(7)
  ds_read_b64_tr_b16 v[230:231], v7 offset:9216
  v_mfma_f32_16x16x32_bf16 v[104:107], v[244:247], v[208:211], v[104:107]
  ds_read_b64_tr_b16 v[232:233], v8 offset:8192
  v_add_u32 v7, s72, v7
  v_mfma_f32_16x16x32_bf16 v[108:111], v[244:247], v[212:215], v[108:111]
  s_waitcnt lgkmcnt(7)
  ds_read_b64_tr_b16 v[234:235], v8 offset:9216
  s_add_u32 m0, s60, 65536
  s_add_u32 s68, s58, 9216
  buffer_load_dwordx4 v19, s[24:27], s68 offen offset:3072 lds
  v_mfma_f32_16x16x32_bf16 v[112:115], v[248:251], v[208:211], v[112:115]
  ds_read_b64_tr_b16 v[236:237], v9 offset:8192
  v_add_u32 v8, s72, v8
  v_mfma_f32_16x16x32_bf16 v[116:119], v[248:251], v[212:215], v[116:119]
  s_waitcnt lgkmcnt(7)
  ds_read_b64_tr_b16 v[238:239], v9 offset:9216
  v_mfma_f32_16x16x32_bf16 v[120:123], v[252:255], v[208:211], v[120:123]
  ds_read_b64_tr_b16 v[240:241], v10 offset:8192
  v_add_u32 v9, s72, v9
  v_mfma_f32_16x16x32_bf16 v[124:127], v[252:255], v[212:215], v[124:127]
  s_waitcnt lgkmcnt(7)
  ds_read_b64_tr_b16 v[242:243], v10 offset:9216
  s_waitcnt vmcnt(25)
  v_mfma_f32_16x16x32_bf16 v[64:67], v[224:227], v[216:219], v[64:67]
  ds_read_b64_tr_b16 v[244:245], v11 offset:8192
  v_add_u32 v10, s72, v10
  v_mfma_f32_16x16x32_bf16 v[68:71], v[224:227], v[220:223], v[68:71]
  s_waitcnt lgkmcnt(7)
  ds_read_b64_tr_b16 v[246:247], v11 offset:9216
  v_mfma_f32_16x16x32_bf16 v[72:75], v[228:231], v[216:219], v[72:75]
  ds_read_b64_tr_b16 v[248:249], v12 offset:8192
  v_add_u32 v11, s72, v11
  v_mfma_f32_16x16x32_bf16 v[76:79], v[228:231], v[220:223], v[76:79]
  s_waitcnt lgkmcnt(7)
  ds_read_b64_tr_b16 v[250:251], v12 offset:9216
  v_mfma_f32_16x16x32_bf16 v[80:83], v[232:235], v[216:219], v[80:83]
  ds_read_b64_tr_b16 v[252:253], v13 offset:8192
  v_add_u32 v12, s72, v12
  v_mfma_f32_16x16x32_bf16 v[84:87], v[232:235], v[220:223], v[84:87]
  s_waitcnt lgkmcnt(7)
  ds_read_b64_tr_b16 v[254:255], v13 offset:9216
  v_add_u32 v13, s72, v13
  v_mfma_f32_16x16x32_bf16 v[88:91], v[236:239], v[216:219], v[88:91]
  v_mfma_f32_16x16x32_bf16 v[92:95], v[236:239], v[220:223], v[92:95]
  s_waitcnt lgkmcnt(6)
  v_mfma_f32_16x16x32_bf16 v[96:99], v[240:243], v[216:219], v[96:99]
  v_mfma_f32_16x16x32_bf16 v[100:103], v[240:243], v[220:223], v[100:103]
  s_waitcnt lgkmcnt(4)
  v_mfma_f32_16x16x32_bf16 v[104:107], v[244:247], v[216:219], v[104:107]
  s_waitcnt lgkmcnt(0)
  s_waitcnt vmcnt(2)
  s_barrier
  s_mov_b32 s62, 262144
  s_mov_b64 exec, 7
  s_branch L_pollc2
L_poll2:
  s_sub_u32 s62, s62, 1
  s_cbranch_scc1 L_pollx2
  s_sleep 2
L_pollf2:
  buffer_load_dwordx2 v[24:25], v20, s[20:23], 0 offen offset:128 sc1
  s_waitcnt vmcnt(0)
L_pollc2:
  v_cmp_ne_u64 vcc, s[86:87], v[24:25]
  s_cbranch_vccnz L_poll2
L_pollx2:
  s_mov_b64 exec, -1
  s_add_u32 s69, s54, 1
  s_and_b32 s69, s69, 3
  s_lshl_b32 s69, s69, 15
  s_add_u32 s69, s69, s45
  s_add_u32 s69, s69, 131072
  buffer_load_dwordx4 v[160:163], v30, s[20:23], s69 offen offset:0 sc1
  buffer_load_dwordx4 v[164:167], v30, s[20:23], s69 offen offset:1024 sc1
  buffer_load_dwordx4 v[168:171], v30, s[20:23], s69 offen offset:2048 sc1
  buffer_load_dwordx4 v[172:175], v30, s[20:23], s69 offen offset:3072 sc1
  s_add_u32 s69, s69, 4096
  buffer_load_dwordx4 v[176:179], v30, s[20:23], s69 offen offset:0 sc1
  buffer_load_dwordx4 v[180:183], v30, s[20:23], s69 offen offset:1024 sc1
  buffer_load_dwordx4 v[184:187], v30, s[20:23], s69 offen offset:2048 sc1
  buffer_load_dwordx4 v[188:191], v30, s[20:23], s69 offen offset:3072 sc1
  ds_read_b64_tr_b16 v[224:225], v6 offset:0
  ds_read_b64_tr_b16 v[226:227], v6 offset:1024
  v_mfma_f32_16x16x32_bf16 v[108:111], v[244:247], v[220:223], v[108:111]
  ds_read_b64_tr_b16 v[228:229], v7 offset:0
  ds_read_b64_tr_b16 v[230:231], v7 offset:1024
  s_add_u32 s58, s54, 3
  s_and_b32 s58, s58, 3
  s_lshl_b32 s58, s58, 17
  s_add_u32 s58, s58, s48
  s_add_u32 s58, s58, 524288
  s_add_u32 m0, s60, 131072
  s_mov_b32 s68, s58
  buffer_load_dwordx4 v18, s[24:27], s68 offen offset:0 lds
  v_mfma_f32_16x16x32_bf16 v[112:115], v[248:251], v[216:219], v[112:115]
  ds_read_b64_tr_b16 v[232:233], v8 offset:0
  ds_read_b64_tr_b16 v[234:235], v8 offset:1024
  v_mfma_f32_16x16x32_bf16 v[116:119], v[248:251], v[220:223], v[116:119]
  ds_read_b64_tr_b16 v[236:237], v9 offset:0
  ds_read_b64_tr_b16 v[238:239], v9 offset:1024
  v_mfma_f32_16x16x32_bf16 v[120:123], v[252:255], v[216:219], v[120:123]
  ds_read_b64_tr_b16 v[240:241], v10 offset:0
  v_mfma_f32_16x16x32_bf16 v[124:127], v[252:255], v[220:223], v[124:127]
  s_waitcnt lgkmcnt(7)
  ds_read_b64_tr_b16 v[242:243], v10 offset:1024
  v_mfma_f32_16x16x32_bf16 v[64:67], v[224:227], v[32:35], v[64:67]
  ds_read_b64_tr_b16 v[244:245], v11 offset:0
  v_mfma_f32_16x16x32_bf16 v[68:71], v[224:227], v[36:39], v[68:71]
  s_waitcnt lgkmcnt(7)
  ds_read_b64_tr_b16 v[246:247], v11 offset:1024
  s_add_u32 m0, s60, 131072
  s_add_u32 s68, s58, 3072
  buffer_load_dwordx4 v18, s[24:27], s68 offen offset:1024 lds
  v_mfma_f32_16x16x32_bf16 v[72:75], v[228:231], v[32:35], v[72:75]
  ds_read_b64_tr_b16 v[248:249], v12 offset:0
  v_mfma_f32_16x16x32_bf16 v[76:79], v[228:231], v[36:39], v[76:79]
  s_waitcnt lgkmcnt(7)
  ds_read_b64_tr_b16 v[250:251], v12 offset:1024
  v_mfma_f32_16x16x32_bf16 v[80:83], v[232:235], v[32:35], v[80:83]
  ds_read_b64_tr_b16 v[252:253], v13 offset:0
  v_mfma_f32_16x16x32_bf16 v[84:87], v[232:235], v[36:39], v[84:87]
  s_waitcnt lgkmcnt(7)
  ds_read_b64_tr_b16 v[254:255], v13 offset:1024
  s_mov_b32 s72, 0xffffc000
  v_mfma_f32_16x16x32_bf16 v[88:91], v[236:239], v[32:35], v[88:91]
  ds_read_b64_tr_b16 v[224:225], v6 offset:8192
  v_mfma_f32_16x16x32_bf16 v[92:95], v[236:239], v[36:39], v[92:95]
  s_waitcnt lgkmcnt(7)
  ds_read_b64_tr_b16 v[226:227], v6 offset:9216
  s_add_u32 m0, s60, 131072
  s_add_u32 s68, s58, 6144
  buffer_load_dwordx4 v19, s[24:27], s68 offen offset:2048 lds
  v_mfma_f32_16x16x32_bf16 v[96:99], v[240:243], v[32:35], v[96:99]
  ds_read_b64_tr_b16 v[228:229], v7 offset:8192
  v_add_u32 v6, s72, v6
  v_mfma_f32_16x16x32_bf16 v[100:103], v[240:243], v[36:39], v[100:103]
  s_waitcnt lgkmcnt(7)
  ds_read_b64_tr_b16 v[230:231], v7 offset:9216
  v_mfma_f32_16x16x32_bf16 v[104:107], v[244:247], v[32:35], v[104:107]
  ds_read_b64_tr_b16 v[232:233], v8 offset:8192
  v_add_u32 v7, s72, v7
  v_mfma_f32_16x16x32_bf16 v[108:111], v[244:247], v[36:39], v[108:111]
  s_waitcnt lgkmcnt(7)
  ds_read_b64_tr_b16 v[234:235], v8 offset:9216
  v_mfma_f32_16x16x32_bf16 v[112:115], v[248:251], v[32:35], v[112:115]
  ds_read_b64_tr_b16 v[236:237], v9 offset:8192
  v_add_u32 v8, s72, v8
  v_mfma_f32_16x16x32_bf16 v[116:119], v[248:251], v[36:39], v[116:119]
  s_waitcnt lgkmcnt(7)
  ds_read_b64_tr_b16 v[238:239], v9 offset:9216
  s_add_u32 m0, s60, 131072
  s_add_u32 s68, s58, 9216
  buffer_load_dwordx4 v19, s[24:27], s68 offen offset:3072 lds
  v_mfma_f32_16x16x32_bf16 v[120:123], v[252:255], v[32:35], v[120:123]
  ds_read_b64_tr_b16 v[240:241], v10 offset:8192
  v_add_u32 v9, s72, v9
  v_mfma_f32_16x16x32_bf16 v[124:127], v[252:255], v[36:39], v[124:127]
  s_waitcnt lgkmcnt(7)
  ds_read_b64_tr_b16 v[242:243], v10 offset:9216
  v_mfma_f32_16x16x32_bf16 v[64:67], v[224:227], v[40:43], v[64:67]
  ds_read_b64_tr_b16 v[244:245], v11 offset:8192
  v_add_u32 v10, s72, v10
  v_mfma_f32_16x16x32_bf16 v[68:71], v[224:227], v[44:47], v[68:71]
  s_waitcnt lgkmcnt(7)
  ds_read_b64_tr_b16 v[246:247], v11 offset:9216
  v_mfma_f32_16x16x32_bf16 v[72:75], v[228:231], v[40:43], v[72:75]
  ds_read_b64_tr_b16 v[248:249], v12 offset:8192
  v_add_u32 v11, s72, v11
  v_mfma_f32_16x16x32_bf16 v[76:79], v[228:231], v[44:47], v[76:79]
  s_waitcnt lgkmcnt(7)
  ds_read_b64_tr_b16 v[250:251], v12 offset:9216
  v_mfma_f32_16x16x32_bf16 v[80:83], v[232:235], v[40:43], v[80:83]
  ds_read_b64_tr_b16 v[252:253], v13 offset:8192
  v_add_u32 v12, s72, v12
  v_mfma_f32_16x16x32_bf16 v[84:87], v[232:235], v[44:47], v[84:87]
  s_waitcnt lgkmcnt(7)
  ds_read_b64_tr_b16 v[254:255], v13 offset:9216
  v_add_u32 v13, s72, v13
  v_mfma_f32_16x16x32_bf16 v[88:91], v[236:239], v[40:43], v[88:91]
  ds_read_b64_tr_b16 v[224:225], v6 offset:0
  v_mfma_f32_16x16x32_bf16 v[92:95], v[236:239], v[44:47], v[92:95]
  s_waitcnt lgkmcnt(7)
  ds_read_b64_tr_b16 v[226:227], v6 offset:1024
  s_add_u32 s69, s54, 2
  s_and_b32 s69, s69, 3
  s_lshl_b32 s69, s69, 15
  s_add_u32 s69, s69, s45
  s_add_u32 s69, s69, 131072
  buffer_load_dwordx4 v[192:195], v30, s[20:23], s69 offen offset:0 sc1
  v_mfma_f32_16x16x32_bf16 v[96:99], v[240:243], v[40:43], v[96:99]
  ds_read_b64_tr_b16 v[228:229], v7 offset:0
  v_mfma_f32_16x16x32_bf16 v[100:103], v[240:243], v[44:47], v[100:103]
  s_waitcnt lgkmcnt(7)
  ds_read_b64_tr_b16 v[230:231], v7 offset:1024
  buffer_load_dwordx4 v[196:199], v30, s[20:23], s69 offen offset:1024 sc1
  v_mfma_f32_16x16x32_bf16 v[104:107], v[244:247], v[40:43], v[104:107]
  ds_read_b64_tr_b16 v[232:233], v8 offset:0
  v_mfma_f32_16x16x32_bf16 v[108:111], v[244:247], v[44:47], v[108:111]
  s_waitcnt lgkmcnt(7)
  ds_read_b64_tr_b16 v[234:235], v8 offset:1024
  buffer_load_dwordx4 v[200:203], v30, s[20:23], s69 offen offset:2048 sc1
  v_mfma_f32_16x16x32_bf16 v[112:115], v[248:251], v[40:43], v[112:115]
  ds_read_b64_tr_b16 v[236:237], v9 offset:0
  v_mfma_f32_16x16x32_bf16 v[116:119], v[248:251], v[44:47], v[116:119]
  s_waitcnt lgkmcnt(7)
  ds_read_b64_tr_b16 v[238:239], v9 offset:1024
  buffer_load_dwordx4 v[204:207], v30, s[20:23], s69 offen offset:3072 sc1
  v_mfma_f32_16x16x32_bf16 v[120:123], v[252:255], v[40:43], v[120:123]
  ds_read_b64_tr_b16 v[240:241], v10 offset:0
  v_mfma_f32_16x16x32_bf16 v[124:127], v[252:255], v[44:47], v[124:127]
  s_waitcnt lgkmcnt(7)
  ds_read_b64_tr_b16 v[242:243], v10 offset:1024
  s_add_u32 s69, s69, 4096
  buffer_load_dwordx4 v[208:211], v30, s[20:23], s69 offen offset:0 sc1
  v_mfma_f32_16x16x32_bf16 v[64:67], v[224:227], v[48:51], v[64:67]
  ds_read_b64_tr_b16 v[244:245], v11 offset:0
  v_mfma_f32_16x16x32_bf16 v[68:71], v[224:227], v[52:55], v[68:71]
  s_waitcnt lgkmcnt(7)
  ds_read_b64_tr_b16 v[246:247], v11 offset:1024
  buffer_load_dwordx4 v[212:215], v30, s[20:23], s69 offen offset:1024 sc1
  v_mfma_f32_16x16x32_bf16 v[72:75], v[228:231], v[48:51], v[72:75]
  ds_read_b64_tr_b16 v[248:249], v12 offset:0
  v_mfma_f32_16x16x32_bf16 v[76:79], v[228:231], v[52:55], v[76:79]
  s_waitcnt lgkmcnt(7)
  ds_read_b64_tr_b16 v[250:251], v12 offset:1024
  v_mfma_f32_16x16x32_bf16 v[80:83], v[232:235], v[48:51], v[80:83]
  ds_read_b64_tr_b16 v[252:253], v13 offset:0
  v_mfma_f32_16x16x32_bf16 v[84:87], v[232:235], v[52:55], v[84:87]
  s_waitcnt lgkmcnt(7)
  ds_read_b64_tr_b16 v[254:255], v13 offset:1024
  buffer_load_dwordx4 v[216:219], v30, s[20:23], s69 offen offset:2048 sc1
  s_mov_b32 s72, 0xffff4000
  v_mfma_f32_16x16x32_bf16 v[88:91], v[236:239], v[48:51], v[88:91]
  ds_read_b64_tr_b16 v[224:225], v6 offset:8192
  v_mfma_f32_16x16x32_bf16 v[92:95], v[236:239], v[52:55], v[92:95]
  s_waitcnt lgkmcnt(7)
  ds_read_b64_tr_b16 v[226:227], v6 offset:9216
  buffer_load_dwordx4 v[220:223], v30, s[20:23], s69 offen offset:3072 sc1
  v_mfma_f32_16x16x32_bf16 v[96:99], v[240:243], v[48:51], v[96:99]
  ds_read_b64_tr_b16 v[228:229], v7 offset:8192
  v_add_u32 v6, s72, v6
  v_mfma_f32_16x16x32_bf16 v[100:103], v[240:243], v[52:55], v[100:103]
  s_waitcnt lgkmcnt(7)
  ds_read_b64_tr_b16 v[230:231], v7 offset:9216
  s_add_u32 s58, s54, 3
  s_and_b32 s58, s58, 3
  s_lshl_b32 s58, s58, 17
  s_add_u32 s58, s58, s48
  s_add_u32 s58, s58, 589824
  s_add_u32 m0, s60, 147456
  s_mov_b32 s68, s58
  buffer_load_dwordx4 v18, s[24:27], s68 offen offset:0 lds
  v_mfma_f32_16x16x32_bf16 v[104:107], v[244:247], v[48:51], v[104:107]
  ds_read_b64_tr_b16 v[232:233], v8 offset:8192
  v_add_u32 v7, s72, v7
  v_mfma_f32_16x16x32_bf16 v[108:111], v[244:247], v[52:55], v[108:111]
  s_waitcnt lgkmcnt(7)
  ds_read_b64_tr_b16 v[234:235], v8 offset:9216
  s_add_u32 m0, s60, 147456
  s_add_u32 s68, s58, 3072
  buffer_load_dwordx4 v18, s[24:27], s68 offen offset:1024 lds
  v_mfma_f32_16x16x32_bf16 v[112:115], v[248:251], v[48:51], v[112:115]
  ds_read_b64_tr_b16 v[236:237], v9 offset:8192
  v_add_u32 v8, s72, v8
  v_mfma_f32_16x16x32_bf16 v[116:119], v[248:251], v[52:55], v[116:119]
  s_waitcnt lgkmcnt(7)
  ds_read_b64_tr_b16 v[238:239], v9 offset:9216
  s_add_u32 m0, s60, 147456
  s_add_u32 s68, s58, 6144
  buffer_load_dwordx4 v19, s[24:27], s68 offen offset:2048 lds
  v_mfma_f32_16x16x32_bf16 v[120:123], v[252:255], v[48:51], v[120:123]
  ds_read_b64_tr_b16 v[240:241], v10 offset:8192
  v_add_u32 v9, s72, v9
  v_mfma_f32_16x16x32_bf16 v[124:127], v[252:255], v[52:55], v[124:127]
  s_waitcnt lgkmcnt(7)
  ds_read_b64_tr_b16 v[242:243], v10 offset:9216
  s_add_u32 m0, s60, 147456
  s_add_u32 s68, s58, 9216
  buffer_load_dwordx4 v19, s[24:27], s68 offen offset:3072 lds
  v_mfma_f32_16x16x32_bf16 v[64:67], v[224:227], v[56:59], v[64:67]
  ds_read_b64_tr_b16 v[244:245], v11 offset:8192
  v_add_u32 v10, s72, v10
  v_mfma_f32_16x16x32_bf16 v[68:71], v[224:227], v[60:63], v[68:71]
  s_waitcnt lgkmcnt(7)
  ds_read_b64_tr_b16 v[246:247], v11 offset:9216
  v_mfma_f32_16x16x32_bf16 v[72:75], v[228:231], v[56:59], v[72:75]
  ds_read_b64_tr_b16 v[248:249], v12 offset:8192
  v_add_u32 v11, s72, v11
  v_mfma_f32_16x16x32_bf16 v[76:79], v[228:231], v[60:63], v[76:79]
  s_waitcnt lgkmcnt(7)
  ds_read_b64_tr_b16 v[250:251], v12 offset:9216
  v_mfma_f32_16x16x32_bf16 v[80:83], v[232:235], v[56:59], v[80:83]
  ds_read_b64_tr_b16 v[252:253], v13 offset:8192
  v_add_u32 v12, s72, v12
  v_mfma_f32_16x16x32_bf16 v[84:87], v[232:235], v[60:63], v[84:87]
  s_waitcnt lgkmcnt(7)
  ds_read_b64_tr_b16 v[254:255], v13 offset:9216
  v_add_u32 v13, s72, v13
  v_mfma_f32_16x16x32_bf16 v[88:91], v[236:239], v[56:59], v[88:91]
  s_waitcnt vmcnt(24)
  s_barrier
  ds_read_b64_tr_b16 v[224:225], v6 offset:0
  v_mfma_f32_16x16x32_bf16 v[92:95], v[236:239], v[60:63], v[92:95]
  s_waitcnt lgkmcnt(7)
  ds_read_b64_tr_b16 v[226:227], v6 offset:1024
  v_mfma_f32_16x16x32_bf16 v[96:99], v[240:243], v[56:59], v[96:99]
  ds_read_b64_tr_b16 v[228:229], v7 offset:0
  v_mfma_f32_16x16x32_bf16 v[100:103], v[240:243], v[60:63], v[100:103]
  s_waitcnt lgkmcnt(7)
  ds_read_b64_tr_b16 v[230:231], v7 offset:1024
  v_mfma_f32_16x16x32_bf16 v[104:107], v[244:247], v[56:59], v[104:107]
  ds_read_b64_tr_b16 v[232:233], v8 offset:0
  v_mfma_f32_16x16x32_bf16 v[108:111], v[244:247], v[60:63], v[108:111]
  s_waitcnt lgkmcnt(7)
  ds_read_b64_tr_b16 v[234:235], v8 offset:1024
  v_mfma_f32_16x16x32_bf16 v[112:115], v[248:251], v[56:59], v[112:115]
  ds_read_b64_tr_b16 v[236:237], v9 offset:0
  v_mfma_f32_16x16x32_bf16 v[116:119], v[248:251], v[60:63], v[116:119]
  s_waitcnt lgkmcnt(7)
  ds_read_b64_tr_b16 v[238:239], v9 offset:1024
  v_mfma_f32_16x16x32_bf16 v[120:123], v[252:255], v[56:59], v[120:123]
  ds_read_b64_tr_b16 v[240:241], v10 offset:0
  v_mfma_f32_16x16x32_bf16 v[124:127], v[252:255], v[60:63], v[124:127]
  s_waitcnt lgkmcnt(7)
  ds_read_b64_tr_b16 v[242:243], v10 offset:1024
  s_waitcnt vmcnt(22)
  v_mfma_f32_16x16x32_bf16 v[64:67], v[224:227], v[160:163], v[64:67]
  ds_read_b64_tr_b16 v[244:245], v11 offset:0
  v_mfma_f32_16x16x32_bf16 v[68:71], v[224:227], v[164:167], v[68:71]
  s_waitcnt lgkmcnt(7)
  ds_read_b64_tr_b16 v[246:247], v11 offset:1024
  v_mfma_f32_16x16x32_bf16 v[72:75], v[228:231], v[160:163], v[72:75]
  ds_read_b64_tr_b16 v[248:249], v12 offset:0
  v_mfma_f32_16x16x32_bf16 v[76:79], v[228:231], v[164:167], v[76:79]
  s_waitcnt lgkmcnt(7)
  ds_read_b64_tr_b16 v[250:251], v12 offset:1024
  s_add_u32 s69, s54, 3
  s_and_b32 s69, s69, 3
  s_lshl_b32 s69, s69, 15
  s_add_u32 s69, s69, s45
  s_add_u32 s69, s69, 131072
  buffer_load_dwordx4 v[32:35], v30, s[20:23], s69 offen offset:0 sc1
  v_mfma_f32_16x16x32_bf16 v[80:83], v[232:235], v[160:163], v[80:83]
  ds_read_b64_tr_b16 v[252:253], v13 offset:0
  v_mfma_f32_16x16x32_bf16 v[84:87], v[232:235], v[164:167], v[84:87]
  s_waitcnt lgkmcnt(7)
  ds_read_b64_tr_b16 v[254:255], v13 offset:1024
  buffer_load_dwordx4 v[36:39], v30, s[20:23], s69 offen offset:1024 sc1
  s_mov_b32 s72, 0x4000
  v_mfma_f32_16x16x32_bf16 v[88:91], v[236:239], v[160:163], v[88:91]
  ds_read_b64_tr_b16 v[224:225], v6 offset:8192
  v_mfma_f32_16x16x32_bf16 v[92:95], v[236:239], v[164:167], v[92:95]
  s_waitcnt lgkmcnt(7)
  ds_read_b64_tr_b16 v[226:227], v6 offset:9216
  buffer_load_dwordx4 v[40:43], v30, s[20:23], s69 offen offset:2048 sc1
  v_mfma_f32_16x16x32_bf16 v[96:99], v[240:243], v[160:163], v[96:99]
  ds_read_b64_tr_b16 v[228:229], v7 offset:8192
  v_add_u32 v6, s72, v6
  v_mfma_f32_16x16x32_bf16 v[100:103], v[240:243], v[164:167], v[100:103]
  s_waitcnt lgkmcnt(7)
  ds_read_b64_tr_b16 v[230:231], v7 offset:9216
  buffer_load_dwordx4 v[44:47], v30, s[20:23], s69 offen offset:3072 sc1
  v_mfma_f32_16x16x32_bf16 v[104:107], v[244:247], v[160:163], v[104:107]
  ds_read_b64_tr_b16 v[232:233], v8 offset:8192
  v_add_u32 v7, s72, v7
  v_mfma_f32_16x16x32_bf16 v[108:111], v[244:247], v[164:167], v[108:111]
  s_waitcnt lgkmcnt(7)
  ds_read_b64_tr_b16 v[234:235], v8 offset:9216
  s_add_u32 s69, s69, 4096
  buffer_load_dwordx4 v[48:51], v30, s[20:23], s69 offen offset:0 sc1
  v_mfma_f32_16x16x32_bf16 v[112:115], v[248:251], v[160:163], v[112:115]
  ds_read_b64_tr_b16 v[236:237], v9 offset:8192
  v_add_u32 v8, s72, v8
  v_mfma_f32_16x16x32_bf16 v[116:119], v[248:251], v[164:167], v[116:119]
  s_waitcnt lgkmcnt(7)
  ds_read_b64_tr_b16 v[238:239], v9 offset:9216
  buffer_load_dwordx4 v[52:55], v30, s[20:23], s69 offen offset:1024 sc1
  v_mfma_f32_16x16x32_bf16 v[120:123], v[252:255], v[160:163], v[120:123]
  ds_read_b64_tr_b16 v[240:241], v10 offset:8192
  v_add_u32 v9, s72, v9
  v_mfma_f32_16x16x32_bf16 v[124:127], v[252:255], v[164:167], v[124:127]
  s_waitcnt lgkmcnt(7)
  ds_read_b64_tr_b16 v[242:243], v10 offset:9216
  buffer_load_dwordx4 v[56:59], v30, s[20:23], s69 offen offset:2048 sc1
  s_waitcnt vmcnt(27)
  v_mfma_f32_16x16x32_bf16 v[64:67], v[224:227], v[168:171], v[64:67]
  ds_read_b64_tr_b16 v[244:245], v11 offset:8192
  v_add_u32 v10, s72, v10
  v_mfma_f32_16x16x32_bf16 v[68:71], v[224:227], v[172:175], v[68:71]
  s_waitcnt lgkmcnt(7)
  ds_read_b64_tr_b16 v[246:247], v11 offset:9216
  buffer_load_dwordx4 v[60:63], v30, s[20:23], s69 offen offset:3072 sc1
  v_mfma_f32_16x16x32_bf16 v[72:75], v[228:231], v[168:171], v[72:75]
  ds_read_b64_tr_b16 v[248:249], v12 offset:8192
  v_add_u32 v11, s72, v11
  v_mfma_f32_16x16x32_bf16 v[76:79], v[228:231], v[172:175], v[76:79]
  s_waitcnt lgkmcnt(7)
  ds_read_b64_tr_b16 v[250:251], v12 offset:9216
  v_mfma_f32_16x16x32_bf16 v[80:83], v[232:235], v[168:171], v[80:83]
  ds_read_b64_tr_b16 v[252:253], v13 offset:8192
  v_add_u32 v12, s72, v12
  v_mfma_f32_16x16x32_bf16 v[84:87], v[232:235], v[172:175], v[84:87]
  s_waitcnt lgkmcnt(7)
  ds_read_b64_tr_b16 v[254:255], v13 offset:9216
  v_add_u32 v13, s72, v13
  v_mfma_f32_16x16x32_bf16 v[88:91], v[236:239], v[168:171], v[88:91]
  ds_read_b64_tr_b16 v[224:225], v6 offset:0
  v_mfma_f32_16x16x32_bf16 v[92:95], v[236:239], v[172:175], v[92:95]
  s_waitcnt lgkmcnt(7)
  ds_read_b64_tr_b16 v[226:227], v6 offset:1024
  v_mfma_f32_16x16x32_bf16 v[96:99], v[240:243], v[168:171], v[96:99]
  ds_read_b64_tr_b16 v[228:229], v7 offset:0
  v_mfma_f32_16x16x32_bf16 v[100:103], v[240:243], v[172:175], v[100:103]
  s_waitcnt lgkmcnt(7)
  ds_read_b64_tr_b16 v[230:231], v7 offset:1024
  v_mfma_f32_16x16x32_bf16 v[104:107], v[244:247], v[168:171], v[104:107]
  ds_read_b64_tr_b16 v[232:233], v8 offset:0
  v_mfma_f32_16x16x32_bf16 v[108:111], v[244:247], v[172:175], v[108:111]
  s_waitcnt lgkmcnt(7)
  ds_read_b64_tr_b16 v[234:235], v8 offset:1024
  v_mfma_f32_16x16x32_bf16 v[112:115], v[248:251], v[168:171], v[112:115]
  ds_read_b64_tr_b16 v[236:237], v9 offset:0
  v_mfma_f32_16x16x32_bf16 v[116:119], v[248:251], v[172:175], v[116:119]
  s_waitcnt lgkmcnt(7)
  ds_read_b64_tr_b16 v[238:239], v9 offset:1024
  v_mfma_f32_16x16x32_bf16 v[120:123], v[252:255], v[168:171], v[120:123]
  ds_read_b64_tr_b16 v[240:241], v10 offset:0
  v_mfma_f32_16x16x32_bf16 v[124:127], v[252:255], v[172:175], v[124:127]
  s_waitcnt lgkmcnt(7)
  ds_read_b64_tr_b16 v[242:243], v10 offset:1024
  s_waitcnt vmcnt(26)
  v_mfma_f32_16x16x32_bf16 v[64:67], v[224:227], v[176:179], v[64:67]
  ds_read_b64_tr_b16 v[244:245], v11 offset:0
  v_mfma_f32_16x16x32_bf16 v[68:71], v[224:227], v[180:183], v[68:71]
  s_waitcnt lgkmcnt(7)
  ds_read_b64_tr_b16 v[246:247], v11 offset:1024
  v_mfma_f32_16x16x32_bf16 v[72:75], v[228:231], v[176:179], v[72:75]
  ds_read_b64_tr_b16 v[248:249], v12 offset:0
  v_mfma_f32_16x16x32_bf16 v[76:79], v[228:231], v[180:183], v[76:79]
  s_waitcnt lgkmcnt(7)
  ds_read_b64_tr_b16 v[250:251], v12 offset:1024
  v_mfma_f32_16x16x32_bf16 v[80:83], v[232:235], v[176:179], v[80:83]
  ds_read_b64_tr_b16 v[252:253], v13 offset:0
  v_mfma_f32_16x16x32_bf16 v[84:87], v[232:235], v[180:183], v[84:87]
  s_waitcnt lgkmcnt(7)
  ds_read_b64_tr_b16 v[254:255], v13 offset:1024
  s_mov_b32 s72, 0xffff4000
  v_mfma_f32_16x16x32_bf16 v[88:91], v[236:239], v[176:179], v[88:91]
  ds_read_b64_tr_b16 v[224:225], v6 offset:8192
  v_mfma_f32_16x16x32_bf16 v[92:95], v[236:239], v[180:183], v[92:95]
  s_waitcnt lgkmcnt(7)
  ds_read_b64_tr_b16 v[226:227], v6 offset:9216
  v_mfma_f32_16x16x32_bf16 v[96:99], v[240:243], v[176:179], v[96:99]
  ds_read_b64_tr_b16 v[228:229], v7 offset:8192
  v_add_u32 v6, s72, v6
  v_mfma_f32_16x16x32_bf16 v[100:103], v[240:243], v[180:183], v[100:103]
  s_waitcnt lgkmcnt(7)
  ds_read_b64_tr_b16 v[230:231], v7 offset:9216
  v_mfma_f32_16x16x32_bf16 v[104:107], v[244:247], v[176:179], v[104:107]
  ds_read_b64_tr_b16 v[232:233], v8 offset:8192
  v_add_u32 v7, s72, v7
  v_mfma_f32_16x16x32_bf16 v[108:111], v[244:247], v[180:183], v[108:111]
  s_waitcnt lgkmcnt(7)
  ds_read_b64_tr_b16 v[234:235], v8 offset:9216
  v_mfma_f32_16x16x32_bf16 v[112:115], v[248:251], v[176:179], v[112:115]
  ds_read_b64_tr_b16 v[236:237], v9 offset:8192
  v_add_u32 v8, s72, v8
  v_mfma_f32_16x16x32_bf16 v[116:119], v[248:251], v[180:183], v[116:119]
  s_waitcnt lgkmcnt(7)
  ds_read_b64_tr_b16 v[238:239], v9 offset:9216
  v_mfma_f32_16x16x32_bf16 v[120:123], v[252:255], v[176:179], v[120:123]
  ds_read_b64_tr_b16 v[240:241], v10 offset:8192
  v_add_u32 v9, s72, v9
  v_mfma_f32_16x16x32_bf16 v[124:127], v[252:255], v[180:183], v[124:127]
  s_waitcnt lgkmcnt(7)
  ds_read_b64_tr_b16 v[242:243], v10 offset:9216
  s_waitcnt vmcnt(24)
  v_mfma_f32_16x16x32_bf16 v[64:67], v[224:227], v[184:187], v[64:67]
  ds_read_b64_tr_b16 v[244:245], v11 offset:8192
  v_add_u32 v10, s72, v10
  v_mfma_f32_16x16x32_bf16 v[68:71], v[224:227], v[188:191], v[68:71]
  s_waitcnt lgkmcnt(7)
  ds_read_b64_tr_b16 v[246:247], v11 offset:9216
  v_mfma_f32_16x16x32_bf16 v[72:75], v[228:231], v[184:187], v[72:75]
  ds_read_b64_tr_b16 v[248:249], v12 offset:8192
  v_add_u32 v11, s72, v11
  v_mfma_f32_16x16x32_bf16 v[76:79], v[228:231], v[188:191], v[76:79]
  s_waitcnt lgkmcnt(7)
  ds_read_b64_tr_b16 v[250:251], v12 offset:9216
  v_mfma_f32_16x16x32_bf16 v[80:83], v[232:235], v[184:187], v[80:83]
  ds_read_b64_tr_b16 v[252:253], v13 offset:8192
  v_add_u32 v12, s72, v12
  v_mfma_f32_16x16x32_bf16 v[84:87], v[232:235], v[188:191], v[84:87]
  s_waitcnt lgkmcnt(7)
  ds_read_b64_tr_b16 v[254:255], v13 offset:9216
  v_add_u32 v13, s72, v13
  v_mfma_f32_16x16x32_bf16 v[88:91], v[236:239], v[184:187], v[88:91]
  ds_read_b64_tr_b16 v[224:225], v6 offset:0
  v_mfma_f32_16x16x32_bf16 v[92:95], v[236:239], v[188:191], v[92:95]
  s_waitcnt lgkmcnt(7)
  ds_read_b64_tr_b16 v[226:227], v6 offset:1024
  v_mfma_f32_16x16x32_bf16 v[96:99], v[240:243], v[184:187], v[96:99]
  ds_read_b64_tr_b16 v[228:229], v7 offset:0
  v_mfma_f32_16x16x32_bf16 v[100:103], v[240:243], v[188:191], v[100:103]
  s_waitcnt lgkmcnt(7)
  ds_read_b64_tr_b16 v[230:231], v7 offset:1024
  v_mfma_f32_16x16x32_bf16 v[104:107], v[244:247], v[184:187], v[104:107]
  ds_read_b64_tr_b16 v[232:233], v8 offset:0
  v_mfma_f32_16x16x32_bf16 v[108:111], v[244:247], v[188:191], v[108:111]
  s_waitcnt lgkmcnt(7)
  ds_read_b64_tr_b16 v[234:235], v8 offset:1024
  v_mfma_f32_16x16x32_bf16 v[112:115], v[248:251], v[184:187], v[112:115]
  ds_read_b64_tr_b16 v[236:237], v9 offset:0
  v_mfma_f32_16x16x32_bf16 v[116:119], v[248:251], v[188:191], v[116:119]
  s_waitcnt lgkmcnt(7)
  ds_read_b64_tr_b16 v[238:239], v9 offset:1024
  v_mfma_f32_16x16x32_bf16 v[120:123], v[252:255], v[184:187], v[120:123]
  ds_read_b64_tr_b16 v[240:241], v10 offset:0
  v_mfma_f32_16x16x32_bf16 v[124:127], v[252:255], v[188:191], v[124:127]
  s_waitcnt lgkmcnt(7)
  ds_read_b64_tr_b16 v[242:243], v10 offset:1024
  s_waitcnt vmcnt(18)
  v_mfma_f32_16x16x32_bf16 v[64:67], v[224:227], v[192:195], v[64:67]
  ds_read_b64_tr_b16 v[244:245], v11 offset:0
  v_mfma_f32_16x16x32_bf16 v[68:71], v[224:227], v[196:199], v[68:71]
  s_waitcnt lgkmcnt(7)
  ds_read_b64_tr_b16 v[246:247], v11 offset:1024
  v_mfma_f32_16x16x32_bf16 v[72:75], v[228:231], v[192:195], v[72:75]
  ds_read_b64_tr_b16 v[248:249], v12 offset:0
  v_mfma_f32_16x16x32_bf16 v[76:79], v[228:231], v[196:199], v[76:79]
  s_waitcnt lgkmcnt(7)
  ds_read_b64_tr_b16 v[250:251], v12 offset:1024
  v_mfma_f32_16x16x32_bf16 v[80:83], v[232:235], v[192:195], v[80:83]
  ds_read_b64_tr_b16 v[252:253], v13 offset:0
  v_mfma_f32_16x16x32_bf16 v[84:87], v[232:235], v[196:199], v[84:87]
  s_waitcnt lgkmcnt(7)
  ds_read_b64_tr_b16 v[254:255], v13 offset:1024
  s_mov_b32 s72, 0x10000
  v_mfma_f32_16x16x32_bf16 v[88:91], v[236:239], v[192:195], v[88:91]
  ds_read_b64_tr_b16 v[224:225], v6 offset:8192
  v_mfma_f32_16x16x32_bf16 v[92:95], v[236:239], v[196:199], v[92:95]
  s_waitcnt lgkmcnt(7)
  ds_read_b64_tr_b16 v[226:227], v6 offset:9216
  v_mfma_f32_16x16x32_bf16 v[96:99], v[240:243], v[192:195], v[96:99]
  ds_read_b64_tr_b16 v[228:229], v7 offset:8192
  v_add_u32 v6, s72, v6
  v_mfma_f32_16x16x32_bf16 v[100:103], v[240:243], v[196:199], v[100:103]
  s_waitcnt lgkmcnt(7)
  ds_read_b64_tr_b16 v[230:231], v7 offset:9216
  v_mfma_f32_16x16x32_bf16 v[104:107], v[244:247], v[192:195], v[104:107]
  ds_read_b64_tr_b16 v[232:233], v8 offset:8192
  v_add_u32 v7, s72, v7
  v_mfma_f32_16x16x32_bf16 v[108:111], v[244:247], v[196:199], v[108:111]
  s_waitcnt lgkmcnt(7)
  ds_read_b64_tr_b16 v[234:235], v8 offset:9216
  v_mfma_f32_16x16x32_bf16 v[112:115], v[248:251], v[192:195], v[112:115]
  ds_read_b64_tr_b16 v[236:237], v9 offset:8192
  v_add_u32 v8, s72, v8
  v_mfma_f32_16x16x32_bf16 v[116:119], v[248:251], v[196:199], v[116:119]
  s_waitcnt lgkmcnt(7)
  ds_read_b64_tr_b16 v[238:239], v9 offset:9216
  v_mfma_f32_16x16x32_bf16 v[120:123], v[252:255], v[192:195], v[120:123]
  ds_read_b64_tr_b16 v[240:241], v10 offset:8192
  v_add_u32 v9, s72, v9
  v_mfma_f32_16x16x32_bf16 v[124:127], v[252:255], v[196:199], v[124:127]
  s_waitcnt lgkmcnt(7)
  ds_read_b64_tr_b16 v[242:243], v10 offset:9216
  s_waitcnt vmcnt(16)
  v_mfma_f32_16x16x32_bf16 v[64:67], v[224:227], v[200:203], v[64:67]
  ds_read_b64_tr_b16 v[244:245], v11 offset:8192
  v_add_u32 v10, s72, v10
  v_mfma_f32_16x16x32_bf16 v[68:71], v[224:227], v[204:207], v[68:71]
  s_waitcnt lgkmcnt(7)
  ds_read_b64_tr_b16 v[246:247], v11 offset:9216
  v_mfma_f32_16x16x32_bf16 v[72:75], v[228:231], v[200:203], v[72:75]
  ds_read_b64_tr_b16 v[248:249], v12 offset:8192
  v_add_u32 v11, s72, v11
  v_mfma_f32_16x16x32_bf16 v[76:79], v[228:231], v[204:207], v[76:79]
  s_waitcnt lgkmcnt(7)
  ds_read_b64_tr_b16 v[250:251], v12 offset:9216
  v_mfma_f32_16x16x32_bf16 v[80:83], v[232:235], v[200:203], v[80:83]
  ds_read_b64_tr_b16 v[252:253], v13 offset:8192
  v_add_u32 v12, s72, v12
  v_mfma_f32_16x16x32_bf16 v[84:87], v[232:235], v[204:207], v[84:87]
  s_waitcnt lgkmcnt(7)
  ds_read_b64_tr_b16 v[254:255], v13 offset:9216
  v_add_u32 v13, s72, v13
  v_mfma_f32_16x16x32_bf16 v[88:91], v[236:239], v[200:203], v[88:91]
  ds_read_b64_tr_b16 v[224:225], v6 offset:0
  v_mfma_f32_16x16x32_bf16 v[92:95], v[236:239], v[204:207], v[92:95]
  s_waitcnt lgkmcnt(7)
  ds_read_b64_tr_b16 v[226:227], v6 offset:1024
  v_mfma_f32_16x16x32_bf16 v[96:99], v[240:243], v[200:203], v[96:99]
  ds_read_b64_tr_b16 v[228:229], v7 offset:0
  v_mfma_f32_16x16x32_bf16 v[100:103], v[240:243], v[204:207], v[100:103]
  s_waitcnt lgkmcnt(7)
  ds_read_b64_tr_b16 v[230:231], v7 offset:1024
  v_mfma_f32_16x16x32_bf16 v[104:107], v[244:247], v[200:203], v[104:107]
  ds_read_b64_tr_b16 v[232:233], v8 offset:0
  v_mfma_f32_16x16x32_bf16 v[108:111], v[244:247], v[204:207], v[108:111]
  s_waitcnt lgkmcnt(7)
  ds_read_b64_tr_b16 v[234:235], v8 offset:1024
  v_mfma_f32_16x16x32_bf16 v[112:115], v[248:251], v[200:203], v[112:115]
  ds_read_b64_tr_b16 v[236:237], v9 offset:0
  v_mfma_f32_16x16x32_bf16 v[116:119], v[248:251], v[204:207], v[116:119]
  s_waitcnt lgkmcnt(7)
  ds_read_b64_tr_b16 v[238:239], v9 offset:1024
  v_mfma_f32_16x16x32_bf16 v[120:123], v[252:255], v[200:203], v[120:123]
  ds_read_b64_tr_b16 v[240:241], v10 offset:0
  v_mfma_f32_16x16x32_bf16 v[124:127], v[252:255], v[204:207], v[124:127]
  s_waitcnt lgkmcnt(7)
  ds_read_b64_tr_b16 v[242:243], v10 offset:1024
  s_waitcnt vmcnt(14)
  v_mfma_f32_16x16x32_bf16 v[64:67], v[224:227], v[208:211], v[64:67]
  ds_read_b64_tr_b16 v[244:245], v11 offset:0
  v_mfma_f32_16x16x32_bf16 v[68:71], v[224:227], v[212:215], v[68:71]
  s_waitcnt lgkmcnt(7)
  ds_read_b64_tr_b16 v[246:247], v11 offset:1024
  v_mfma_f32_16x16x32_bf16 v[72:75], v[228:231], v[208:211], v[72:75]
  ds_read_b64_tr_b16 v[248:249], v12 offset:0
  v_mfma_f32_16x16x32_bf16 v[76:79], v[228:231], v[212:215], v[76:79]
  s_waitcnt lgkmcnt(7)
  ds_read_b64_tr_b16 v[250:251], v12 offset:1024
  v_mfma_f32_16x16x32_bf16 v[80:83], v[232:235], v[208:211], v[80:83]
  ds_read_b64_tr_b16 v[252:253], v13 offset:0
  v_mfma_f32_16x16x32_bf16 v[84:87], v[232:235], v[212:215], v[84:87]
  s_waitcnt lgkmcnt(7)
  ds_read_b64_tr_b16 v[254:255], v13 offset:1024
  s_mov_b32 s72, 0x10000
  v_mfma_f32_16x16x32_bf16 v[88:91], v[236:239], v[208:211], v[88:91]
  ds_read_b64_tr_b16 v[224:225], v6 offset:8192
  v_mfma_f32_16x16x32_bf16 v[92:95], v[236:239], v[212:215], v[92:95]
  s_waitcnt lgkmcnt(7)
  ds_read_b64_tr_b16 v[226:227], v6 offset:9216
  v_mfma_f32_16x16x32_bf16 v[96:99], v[240:243], v[208:211], v[96:99]
  ds_read_b64_tr_b16 v[228:229], v7 offset:8192
  v_add_u32 v6, s72, v6
  v_mfma_f32_16x16x32_bf16 v[100:103], v[240:243], v[212:215], v[100:103]
  s_waitcnt lgkmcnt(7)
  ds_read_b64_tr_b16 v[230:231], v7 offset:9216
  v_mfma_f32_16x16x32_bf16 v[104:107], v[244:247], v[208:211], v[104:107]
  ds_read_b64_tr_b16 v[232:233], v8 offset:8192
  v_add_u32 v7, s72, v7
  v_mfma_f32_16x16x32_bf16 v[108:111], v[244:247], v[212:215], v[108:111]
  s_waitcnt lgkmcnt(7)
  ds_read_b64_tr_b16 v[234:235], v8 offset:9216
  v_mfma_f32_16x16x32_bf16 v[112:115], v[248:251], v[208:211], v[112:115]
  ds_read_b64_tr_b16 v[236:237], v9 offset:8192
  v_add_u32 v8, s72, v8
  v_mfma_f32_16x16x32_bf16 v[116:119], v[248:251], v[212:215], v[116:119]
  s_waitcnt lgkmcnt(7)
  ds_read_b64_tr_b16 v[238:239], v9 offset:9216
  v_mfma_f32_16x16x32_bf16 v[120:123], v[252:255], v[208:211], v[120:123]
  ds_read_b64_tr_b16 v[240:241], v10 offset:8192
  v_add_u32 v9, s72, v9
  v_mfma_f32_16x16x32_bf16 v[124:127], v[252:255], v[212:215], v[124:127]
  s_waitcnt lgkmcnt(7)
  ds_read_b64_tr_b16 v[242:243], v10 offset:9216
  s_waitcnt vmcnt(12)
  v_mfma_f32_16x16x32_bf16 v[64:67], v[224:227], v[216:219], v[64:67]
  ds_read_b64_tr_b16 v[244:245], v11 offset:8192
  v_add_u32 v10, s72, v10
  v_mfma_f32_16x16x32_bf16 v[68:71], v[224:227], v[220:223], v[68:71]
  s_waitcnt lgkmcnt(7)
  ds_read_b64_tr_b16 v[246:247], v11 offset:9216
  v_mfma_f32_16x16x32_bf16 v[72:75], v[228:231], v[216:219], v[72:75]
  ds_read_b64_tr_b16 v[248:249], v12 offset:8192
  v_add_u32 v11, s72, v11
  v_mfma_f32_16x16x32_bf16 v[76:79], v[228:231], v[220:223], v[76:79]
  s_waitcnt lgkmcnt(7)
  ds_read_b64_tr_b16 v[250:251], v12 offset:9216
  v_mfma_f32_16x16x32_bf16 v[80:83], v[232:235], v[216:219], v[80:83]
  ds_read_b64_tr_b16 v[252:253], v13 offset:8192
  v_add_u32 v12, s72, v12
  v_mfma_f32_16x16x32_bf16 v[84:87], v[232:235], v[220:223], v[84:87]
  s_waitcnt lgkmcnt(7)
  ds_read_b64_tr_b16 v[254:255], v13 offset:9216
  v_add_u32 v13, s72, v13
  v_mfma_f32_16x16x32_bf16 v[88:91], v[236:239], v[216:219], v[88:91]
  s_waitcnt vmcnt(8)
  s_barrier
  ds_read_b64_tr_b16 v[224:225], v6 offset:0
  v_mfma_f32_16x16x32_bf16 v[92:95], v[236:239], v[220:223], v[92:95]
  s_waitcnt lgkmcnt(7)
  ds_read_b64_tr_b16 v[226:227], v6 offset:1024
  v_mfma_f32_16x16x32_bf16 v[96:99], v[240:243], v[216:219], v[96:99]
  ds_read_b64_tr_b16 v[228:229], v7 offset:0
  v_mfma_f32_16x16x32_bf16 v[100:103], v[240:243], v[220:223], v[100:103]
  s_waitcnt lgkmcnt(7)
  ds_read_b64_tr_b16 v[230:231], v7 offset:1024
  v_mfma_f32_16x16x32_bf16 v[104:107], v[244:247], v[216:219], v[104:107]
  ds_read_b64_tr_b16 v[232:233], v8 offset:0
  v_mfma_f32_16x16x32_bf16 v[108:111], v[244:247], v[220:223], v[108:111]
  s_waitcnt lgkmcnt(7)
  ds_read_b64_tr_b16 v[234:235], v8 offset:1024
  v_mfma_f32_16x16x32_bf16 v[112:115], v[248:251], v[216:219], v[112:115]
  ds_read_b64_tr_b16 v[236:237], v9 offset:0
  v_mfma_f32_16x16x32_bf16 v[116:119], v[248:251], v[220:223], v[116:119]
  s_waitcnt lgkmcnt(7)
  ds_read_b64_tr_b16 v[238:239], v9 offset:1024
  v_mfma_f32_16x16x32_bf16 v[120:123], v[252:255], v[216:219], v[120:123]
  ds_read_b64_tr_b16 v[240:241], v10 offset:0
  v_mfma_f32_16x16x32_bf16 v[124:127], v[252:255], v[220:223], v[124:127]
  s_waitcnt lgkmcnt(7)
  ds_read_b64_tr_b16 v[242:243], v10 offset:1024
  s_waitcnt vmcnt(6)
  v_mfma_f32_16x16x32_bf16 v[64:67], v[224:227], v[32:35], v[64:67]
  ds_read_b64_tr_b16 v[244:245], v11 offset:0
  v_mfma_f32_16x16x32_bf16 v[68:71], v[224:227], v[36:39], v[68:71]
  s_waitcnt lgkmcnt(7)
  ds_read_b64_tr_b16 v[246:247], v11 offset:1024
  v_mfma_f32_16x16x32_bf16 v[72:75], v[228:231], v[32:35], v[72:75]
  ds_read_b64_tr_b16 v[248:249], v12 offset:0
  v_mfma_f32_16x16x32_bf16 v[76:79], v[228:231], v[36:39], v[76:79]
  s_waitcnt lgkmcnt(7)
  ds_read_b64_tr_b16 v[250:251], v12 offset:1024
  v_mfma_f32_16x16x32_bf16 v[80:83], v[232:235], v[32:35], v[80:83]
  ds_read_b64_tr_b16 v[252:253], v13 offset:0
  v_mfma_f32_16x16x32_bf16 v[84:87], v[232:235], v[36:39], v[84:87]
  s_waitcnt lgkmcnt(7)
  ds_read_b64_tr_b16 v[254:255], v13 offset:1024
  s_mov_b32 s72, 0x4000
  v_mfma_f32_16x16x32_bf16 v[88:91], v[236:239], v[32:35], v[88:91]
  ds_read_b64_tr_b16 v[224:225], v6 offset:8192
  v_mfma_f32_16x16x32_bf16 v[92:95], v[236:239], v[36:39], v[92:95]
  s_waitcnt lgkmcnt(7)
  ds_read_b64_tr_b16 v[226:227], v6 offset:9216
  v_mfma_f32_16x16x32_bf16 v[96:99], v[240:243], v[32:35], v[96:99]
  ds_read_b64_tr_b16 v[228:229], v7 offset:8192
  v_add_u32 v6, s72, v6
  v_mfma_f32_16x16x32_bf16 v[100:103], v[240:243], v[36:39], v[100:103]
  s_waitcnt lgkmcnt(7)
  ds_read_b64_tr_b16 v[230:231], v7 offset:9216
  v_mfma_f32_16x16x32_bf16 v[104:107], v[244:247], v[32:35], v[104:107]
  ds_read_b64_tr_b16 v[232:233], v8 offset:8192
  v_add_u32 v7, s72, v7
  v_mfma_f32_16x16x32_bf16 v[108:111], v[244:247], v[36:39], v[108:111]
  s_waitcnt lgkmcnt(7)
  ds_read_b64_tr_b16 v[234:235], v8 offset:9216
  v_mfma_f32_16x16x32_bf16 v[112:115], v[248:251], v[32:35], v[112:115]
  ds_read_b64_tr_b16 v[236:237], v9 offset:8192
  v_add_u32 v8, s72, v8
  v_mfma_f32_16x16x32_bf16 v[116:119], v[248:251], v[36:39], v[116:119]
  s_waitcnt lgkmcnt(7)
  ds_read_b64_tr_b16 v[238:239], v9 offset:9216
  v_mfma_f32_16x16x32_bf16 v[120:123], v[252:255], v[32:35], v[120:123]
  ds_read_b64_tr_b16 v[240:241], v10 offset:8192
  v_add_u32 v9, s72, v9
  v_mfma_f32_16x16x32_bf16 v[124:127], v[252:255], v[36:39], v[124:127]
  s_waitcnt lgkmcnt(7)
  ds_read_b64_tr_b16 v[242:243], v10 offset:9216
  s_waitcnt vmcnt(4)
  v_mfma_f32_16x16x32_bf16 v[64:67], v[224:227], v[40:43], v[64:67]
  ds_read_b64_tr_b16 v[244:245], v11 offset:8192
  v_add_u32 v10, s72, v10
  v_mfma_f32_16x16x32_bf16 v[68:71], v[224:227], v[44:47], v[68:71]
  s_waitcnt lgkmcnt(7)
  ds_read_b64_tr_b16 v[246:247], v11 offset:9216
  v_mfma_f32_16x16x32_bf16 v[72:75], v[228:231], v[40:43], v[72:75]
  ds_read_b64_tr_b16 v[248:249], v12 offset:8192
  v_add_u32 v11, s72, v11
  v_mfma_f32_16x16x32_bf16 v[76:79], v[228:231], v[44:47], v[76:79]
  s_waitcnt lgkmcnt(7)
  ds_read_b64_tr_b16 v[250:251], v12 offset:9216
  v_mfma_f32_16x16x32_bf16 v[80:83], v[232:235], v[40:43], v[80:83]
  ds_read_b64_tr_b16 v[252:253], v13 offset:8192
  v_add_u32 v12, s72, v12
  v_mfma_f32_16x16x32_bf16 v[84:87], v[232:235], v[44:47], v[84:87]
  s_waitcnt lgkmcnt(7)
  ds_read_b64_tr_b16 v[254:255], v13 offset:9216
  v_add_u32 v13, s72, v13
  v_mfma_f32_16x16x32_bf16 v[88:91], v[236:239], v[40:43], v[88:91]
  ds_read_b64_tr_b16 v[224:225], v6 offset:0
  v_mfma_f32_16x16x32_bf16 v[92:95], v[236:239], v[44:47], v[92:95]
  s_waitcnt lgkmcnt(7)
  ds_read_b64_tr_b16 v[226:227], v6 offset:1024
  v_mfma_f32_16x16x32_bf16 v[96:99], v[240:243], v[40:43], v[96:99]
  ds_read_b64_tr_b16 v[228:229], v7 offset:0
  v_mfma_f32_16x16x32_bf16 v[100:103], v[240:243], v[44:47], v[100:103]
  s_waitcnt lgkmcnt(7)
  ds_read_b64_tr_b16 v[230:231], v7 offset:1024
  v_mfma_f32_16x16x32_bf16 v[104:107], v[244:247], v[40:43], v[104:107]
  ds_read_b64_tr_b16 v[232:233], v8 offset:0
  v_mfma_f32_16x16x32_bf16 v[108:111], v[244:247], v[44:47], v[108:111]
  s_waitcnt lgkmcnt(7)
  ds_read_b64_tr_b16 v[234:235], v8 offset:1024
  v_mfma_f32_16x16x32_bf16 v[112:115], v[248:251], v[40:43], v[112:115]
  ds_read_b64_tr_b16 v[236:237], v9 offset:0
  v_mfma_f32_16x16x32_bf16 v[116:119], v[248:251], v[44:47], v[116:119]
  s_waitcnt lgkmcnt(7)
  ds_read_b64_tr_b16 v[238:239], v9 offset:1024
  v_mfma_f32_16x16x32_bf16 v[120:123], v[252:255], v[40:43], v[120:123]
  ds_read_b64_tr_b16 v[240:241], v10 offset:0
  v_mfma_f32_16x16x32_bf16 v[124:127], v[252:255], v[44:47], v[124:127]
  s_waitcnt lgkmcnt(7)
  ds_read_b64_tr_b16 v[242:243], v10 offset:1024
  s_waitcnt vmcnt(2)
  v_mfma_f32_16x16x32_bf16 v[64:67], v[224:227], v[48:51], v[64:67]
  ds_read_b64_tr_b16 v[244:245], v11 offset:0
  v_mfma_f32_16x16x32_bf16 v[68:71], v[224:227], v[52:55], v[68:71]
  s_waitcnt lgkmcnt(7)
  ds_read_b64_tr_b16 v[246:247], v11 offset:1024
  v_mfma_f32_16x16x32_bf16 v[72:75], v[228:231], v[48:51], v[72:75]
  ds_read_b64_tr_b16 v[248:249], v12 offset:0
  v_mfma_f32_16x16x32_bf16 v[76:79], v[228:231], v[52:55], v[76:79]
  s_waitcnt lgkmcnt(7)
  ds_read_b64_tr_b16 v[250:251], v12 offset:1024
  v_mfma_f32_16x16x32_bf16 v[80:83], v[232:235], v[48:51], v[80:83]
  ds_read_b64_tr_b16 v[252:253], v13 offset:0
  v_mfma_f32_16x16x32_bf16 v[84:87], v[232:235], v[52:55], v[84:87]
  s_waitcnt lgkmcnt(7)
  ds_read_b64_tr_b16 v[254:255], v13 offset:1024
  s_mov_b32 s72, 0x0
  v_mfma_f32_16x16x32_bf16 v[88:91], v[236:239], v[48:51], v[88:91]
  ds_read_b64_tr_b16 v[224:225], v6 offset:8192
  v_mfma_f32_16x16x32_bf16 v[92:95], v[236:239], v[52:55], v[92:95]
  s_waitcnt lgkmcnt(7)
  ds_read_b64_tr_b16 v[226:227], v6 offset:9216
  v_mfma_f32_16x16x32_bf16 v[96:99], v[240:243], v[48:51], v[96:99]
  ds_read_b64_tr_b16 v[228:229], v7 offset:8192
  v_add_u32 v6, s72, v6
  v_mfma_f32_16x16x32_bf16 v[100:103], v[240:243], v[52:55], v[100:103]
  s_waitcnt lgkmcnt(7)
  ds_read_b64_tr_b16 v[230:231], v7 offset:9216
  v_mfma_f32_16x16x32_bf16 v[104:107], v[244:247], v[48:51], v[104:107]
  ds_read_b64_tr_b16 v[232:233], v8 offset:8192
  v_add_u32 v7, s72, v7
  v_mfma_f32_16x16x32_bf16 v[108:111], v[244:247], v[52:55], v[108:111]
  s_waitcnt lgkmcnt(7)
  ds_read_b64_tr_b16 v[234:235], v8 offset:9216
  v_mfma_f32_16x16x32_bf16 v[112:115], v[248:251], v[48:51], v[112:115]
  ds_read_b64_tr_b16 v[236:237], v9 offset:8192
  v_add_u32 v8, s72, v8
  v_mfma_f32_16x16x32_bf16 v[116:119], v[248:251], v[52:55], v[116:119]
  s_waitcnt lgkmcnt(7)
  ds_read_b64_tr_b16 v[238:239], v9 offset:9216
  v_mfma_f32_16x16x32_bf16 v[120:123], v[252:255], v[48:51], v[120:123]
  ds_read_b64_tr_b16 v[240:241], v10 offset:8192
  v_add_u32 v9, s72, v9
  v_mfma_f32_16x16x32_bf16 v[124:127], v[252:255], v[52:55], v[124:127]
  s_waitcnt lgkmcnt(7)
  ds_read_b64_tr_b16 v[242:243], v10 offset:9216
  s_waitcnt vmcnt(0)
  v_mfma_f32_16x16x32_bf16 v[64:67], v[224:227], v[56:59], v[64:67]
  ds_read_b64_tr_b16 v[244:245], v11 offset:8192
  v_add_u32 v10, s72, v10
  v_mfma_f32_16x16x32_bf16 v[68:71], v[224:227], v[60:63], v[68:71]
  s_waitcnt lgkmcnt(7)
  ds_read_b64_tr_b16 v[246:247], v11 offset:9216
  v_mfma_f32_16x16x32_bf16 v[72:75], v[228:231], v[56:59], v[72:75]
  ds_read_b64_tr_b16 v[248:249], v12 offset:8192
  v_add_u32 v11, s72, v11
  v_mfma_f32_16x16x32_bf16 v[76:79], v[228:231], v[60:63], v[76:79]
  s_waitcnt lgkmcnt(7)
  ds_read_b64_tr_b16 v[250:251], v12 offset:9216
  v_mfma_f32_16x16x32_bf16 v[80:83], v[232:235], v[56:59], v[80:83]
  ds_read_b64_tr_b16 v[252:253], v13 offset:8192
  v_add_u32 v12, s72, v12
  v_mfma_f32_16x16x32_bf16 v[84:87], v[232:235], v[60:63], v[84:87]
  s_waitcnt lgkmcnt(7)
  ds_read_b64_tr_b16 v[254:255], v13 offset:9216
  v_add_u32 v13, s72, v13
  v_mfma_f32_16x16x32_bf16 v[88:91], v[236:239], v[56:59], v[88:91]
  v_mfma_f32_16x16x32_bf16 v[92:95], v[236:239], v[60:63], v[92:95]
  s_waitcnt lgkmcnt(6)
  v_mfma_f32_16x16x32_bf16 v[96:99], v[240:243], v[56:59], v[96:99]
  v_mfma_f32_16x16x32_bf16 v[100:103], v[240:243], v[60:63], v[100:103]
  s_waitcnt lgkmcnt(4)
  v_mfma_f32_16x16x32_bf16 v[104:107], v[244:247], v[56:59], v[104:107]
  v_mfma_f32_16x16x32_bf16 v[108:111], v[244:247], v[60:63], v[108:111]
  s_waitcnt lgkmcnt(2)
  v_mfma_f32_16x16x32_bf16 v[112:115], v[248:251], v[56:59], v[112:115]
  v_mfma_f32_16x16x32_bf16 v[116:119], v[248:251], v[60:63], v[116:119]
  s_waitcnt lgkmcnt(0)
  v_mfma_f32_16x16x32_bf16 v[120:123], v[252:255], v[56:59], v[120:123]
  v_mfma_f32_16x16x32_bf16 v[124:127], v[252:255], v[60:63], v[124:127]
  s_lshl_b32 s69, s2, 2
  s_add_u32 s69, s69, s34
  s_lshl_b32 s69, s69, 14
  s_add_u32 s69, s69, 16777216
  v_add_u32 v20, 1, v1
  v_and_b32 v20, 3, v20
  v_xor_b32 v20, s2, v20
  v_lshlrev_b32 v20, 2, v20
  v_add_u32 v20, s34, v20
  v_mul_u32_u24 v20, 384, v20
  v_add_u32 v20, 33554432, v20
  s_add_u32 s69, s69, 4096
  v_cvt_pk_bf16_f32 v136, v80, v81
  v_cvt_pk_bf16_f32 v137, v82, v83
  v_cvt_pk_bf16_f32 v138, v84, v85
  v_cvt_pk_bf16_f32 v139, v86, v87
  v_cvt_pk_bf16_f32 v140, v88, v89
  v_cvt_pk_bf16_f32 v141, v90, v91
  v_cvt_pk_bf16_f32 v142, v92, v93
  v_cvt_pk_bf16_f32 v143, v94, v95
  buffer_store_dwordx4 v[136:139], v30, s[20:23], s69 offen offset:0 sc1
  buffer_store_dwordx4 v[140:143], v30, s[20:23], s69 offen offset:1024 sc1
  s_add_u32 s69, s69, 4096
  v_cvt_pk_bf16_f32 v144, v96, v97
  v_cvt_pk_bf16_f32 v145, v98, v99
  v_cvt_pk_bf16_f32 v146, v100, v101
  v_cvt_pk_bf16_f32 v147, v102, v103
  v_cvt_pk_bf16_f32 v148, v104, v105
  v_cvt_pk_bf16_f32 v149, v106, v107
  v_cvt_pk_bf16_f32 v150, v108, v109
  v_cvt_pk_bf16_f32 v151, v110, v111
  buffer_store_dwordx4 v[144:147], v30, s[20:23], s69 offen offset:0 sc1
  buffer_store_dwordx4 v[148:151], v30, s[20:23], s69 offen offset:1024 sc1
  s_add_u32 s69, s69, 4096
  v_cvt_pk_bf16_f32 v152, v112, v113
  v_cvt_pk_bf16_f32 v153, v114, v115
  v_cvt_pk_bf16_f32 v154, v116, v117
  v_cvt_pk_bf16_f32 v155, v118, v119
  v_cvt_pk_bf16_f32 v156, v120, v121
  v_cvt_pk_bf16_f32 v157, v122, v123
  v_cvt_pk_bf16_f32 v158, v124, v125
  v_cvt_pk_bf16_f32 v159, v126, v127
  buffer_store_dwordx4 v[152:155], v30, s[20:23], s69 offen offset:0 sc1
  buffer_store_dwordx4 v[156:159], v30, s[20:23], s69 offen offset:1024 sc1
  v_bfe_u32 v27, v1, 2, 2
  v_and_b32 v26, 3, v1
  v_lshl_or_b32 v26, v27, 3, v26
  v_and_b32 v27, 0x30, v1
  v_lshl_add_u32 v26, v26, 11, v27
  s_lshl_b32 s71, s53, 2
  s_add_u32 s71, s71, s34
  s_lshl_b32 s71, s71, 16
  s_lshl_b32 s68, s52, 10
  s_add_u32 s71, s71, s68
  s_lshl_b32 s68, s54, 8
  s_add_u32 s71, s71, s68
  s_lshl_b32 s68, s55, 6
  s_add_u32 s71, s71, s68
  s_add_u32 s63, s71, 8192
  s_waitcnt vmcnt(0)
  v_mov_b32 v28, s86
  v_mov_b32 v29, s87
  s_mov_b64 exec, 1
  buffer_store_dwordx2 v[28:29], off, s[20:23], s46 offset:256 sc1
  s_mov_b64 exec, -1
  s_mov_b32 s62, 262144
  s_mov_b64 exec, 7
  s_branch L_pollf3
L_poll3:
  s_sub_u32 s62, s62, 1
  s_cbranch_scc1 L_pollx3
  s_sleep 2
L_pollf3:
  buffer_load_dwordx2 v[24:25], v20, s[20:23], 0 offen offset:256 sc1
  s_waitcnt vmcnt(0)
L_pollc3:
  v_cmp_ne_u64 vcc, s[86:87], v[24:25]
  s_cbranch_vccnz L_poll3
L_pollx3:
  s_mov_b64 exec, -1
  s_xor_b32 s69, s2, 1
  s_lshl_b32 s69, s69, 2
  s_add_u32 s69, s69, s34
  s_lshl_b32 s69, s69, 14
  s_add_u32 s69, s69, 16781312
  buffer_load_dwordx4 v[136:139], v30, s[20:23], s69 offen offset:0 sc1
  buffer_load_dwordx4 v[140:143], v30, s[20:23], s69 offen offset:1024 sc1
  s_xor_b32 s69, s2, 2
  s_lshl_b32 s69, s69, 2
  s_add_u32 s69, s69, s34
  s_lshl_b32 s69, s69, 14
  s_add_u32 s69, s69, 16785408
  buffer_load_dwordx4 v[144:147], v30, s[20:23], s69 offen offset:0 sc1
  buffer_load_dwordx4 v[148:151], v30, s[20:23], s69 offen offset:1024 sc1
  s_xor_b32 s69, s2, 3
  s_lshl_b32 s69, s69, 2
  s_add_u32 s69, s69, s34
  s_lshl_b32 s69, s69, 14
  s_add_u32 s69, s69, 16789504
  buffer_load_dwordx4 v[152:155], v30, s[20:23], s69 offen offset:0 sc1
  buffer_load_dwordx4 v[156:159], v30, s[20:23], s69 offen offset:1024 sc1
  s_waitcnt vmcnt(4)
  v_lshlrev_b32 v28, 16, v136
  v_and_b32 v29, 0xffff0000, v136
  v_add_f32 v64, v64, v28
  v_add_f32 v65, v65, v29
  v_lshlrev_b32 v28, 16, v137
  v_and_b32 v29, 0xffff0000, v137
  v_add_f32 v66, v66, v28
  v_add_f32 v67, v67, v29
  v_lshlrev_b32 v28, 16, v138
  v_and_b32 v29, 0xffff0000, v138
  v_add_f32 v68, v68, v28
  v_add_f32 v69, v69, v29
  v_lshlrev_b32 v28, 16, v139
  v_and_b32 v29, 0xffff0000, v139
  v_add_f32 v70, v70, v28
  v_add_f32 v71, v71, v29
  v_lshlrev_b32 v28, 16, v140
  v_and_b32 v29, 0xffff0000, v140
  v_add_f32 v72, v72, v28
  v_add_f32 v73, v73, v29
  v_lshlrev_b32 v28, 16, v141
  v_and_b32 v29, 0xffff0000, v141
  v_add_f32 v74, v74, v28
  v_add_f32 v75, v75, v29
  v_lshlrev_b32 v28, 16, v142
  v_and_b32 v29, 0xffff0000, v142
  v_add_f32 v76, v76, v28
  v_add_f32 v77, v77, v29
  v_lshlrev_b32 v28, 16, v143
  v_and_b32 v29, 0xffff0000, v143
  v_add_f32 v78, v78, v28
  v_add_f32 v79, v79, v29
  s_waitcnt vmcnt(2)
  v_lshlrev_b32 v28, 16, v144
  v_and_b32 v29, 0xffff0000, v144
  v_add_f32 v64, v64, v28
  v_add_f32 v65, v65, v29
  v_lshlrev_b32 v28, 16, v145
  v_and_b32 v29, 0xffff0000, v145
  v_add_f32 v66, v66, v28
  v_add_f32 v67, v67, v29
  v_lshlrev_b32 v28, 16, v146
  v_and_b32 v29, 0xffff0000, v146
  v_add_f32 v68, v68, v28
  v_add_f32 v69, v69, v29
  v_lshlrev_b32 v28, 16, v147
  v_and_b32 v29, 0xffff0000, v147
  v_add_f32 v70, v70, v28
  v_add_f32 v71, v71, v29
  v_lshlrev_b32 v28, 16, v148
  v_and_b32 v29, 0xffff0000, v148
  v_add_f32 v72, v72, v28
  v_add_f32 v73, v73, v29
  v_lshlrev_b32 v28, 16, v149
  v_and_b32 v29, 0xffff0000, v149
  v_add_f32 v74, v74, v28
  v_add_f32 v75, v75, v29
  v_lshlrev_b32 v28, 16, v150
  v_and_b32 v29, 0xffff0000, v150
  v_add_f32 v76, v76, v28
  v_add_f32 v77, v77, v29
  v_lshlrev_b32 v28, 16, v151
  v_and_b32 v29, 0xffff0000, v151
  v_add_f32 v78, v78, v28
  v_add_f32 v79, v79, v29
  s_waitcnt vmcnt(0)
  v_lshlrev_b32 v28, 16, v152
  v_and_b32 v29, 0xffff0000, v152
  v_add_f32 v64, v64, v28
  v_add_f32 v65, v65, v29
  v_lshlrev_b32 v28, 16, v153
  v_and_b32 v29, 0xffff0000, v153
  v_add_f32 v66, v66, v28
  v_add_f32 v67, v67, v29
  v_lshlrev_b32 v28, 16, v154
  v_and_b32 v29, 0xffff0000, v154
  v_add_f32 v68, v68, v28
  v_add_f32 v69, v69, v29
  v_lshlrev_b32 v28, 16, v155
  v_and_b32 v29, 0xffff0000, v155
  v_add_f32 v70, v70, v28
  v_add_f32 v71, v71, v29
  v_lshlrev_b32 v28, 16, v156
  v_and_b32 v29, 0xffff0000, v156
  v_add_f32 v72, v72, v28
  v_add_f32 v73, v73, v29
  v_lshlrev_b32 v28, 16, v157
  v_and_b32 v29, 0xffff0000, v157
  v_add_f32 v74, v74, v28
  v_add_f32 v75, v75, v29
  v_lshlrev_b32 v28, 16, v158
  v_and_b32 v29, 0xffff0000, v158
  v_add_f32 v76, v76, v28
  v_add_f32 v77, v77, v29
  v_lshlrev_b32 v28, 16, v159
  v_and_b32 v29, 0xffff0000, v159
  v_add_f32 v78, v78, v28
  v_add_f32 v79, v79, v29
  v_cvt_pk_bf16_f32 v32, v64, v65
  v_cvt_pk_bf16_f32 v33, v66, v67
  v_cvt_pk_bf16_f32 v34, v72, v73
  v_cvt_pk_bf16_f32 v35, v74, v75
  v_cvt_pk_bf16_f32 v36, v68, v69
  v_cvt_pk_bf16_f32 v37, v70, v71
  v_cvt_pk_bf16_f32 v38, v76, v77
  v_cvt_pk_bf16_f32 v39, v78, v79
  s_nop 1
  v_permlane32_swap_b32 v32, v34
  v_permlane32_swap_b32 v33, v35
  v_permlane32_swap_b32 v36, v38
  v_permlane32_swap_b32 v37, v39
  v_permlane16_swap_b32 v32, v34
  v_permlane16_swap_b32 v33, v35
  v_permlane16_swap_b32 v36, v38
  v_permlane16_swap_b32 v37, v39
  buffer_store_dwordx4 v[32:35], v26, s[28:31], s71 offen
  buffer_store_dwordx4 v[36:39], v26, s[28:31], s63 offen
  s_or_b32 s68, s55, s54
  s_or_b32 s68, s68, s34
  s_cbranch_scc1 L_noep
  v_mov_b32 v28, s86
  v_mov_b32 v29, s87
  s_mov_b64 exec, 1
  buffer_store_dwordx2 v[28:29], off, s[20:23], s47 sc1
  s_mov_b64 exec, -1
L_noep:
  s_endpgm
L_B_fin:
  s_nop 7
  v_rcp_f32 v24, v136
  v_rcp_f32 v25, v138
  v_rcp_f32 v26, v140
  v_rcp_f32 v27, v142
  s_nop 0
  v_mul_f32 v64, v24, v64
  v_mul_f32 v65, v24, v65
  v_mul_f32 v66, v24, v66
  v_mul_f32 v67, v24, v67
  v_cvt_pk_bf16_f32 v128, v64, v65
  v_cvt_pk_bf16_f32 v129, v66, v67
  v_mul_f32 v72, v24, v72
  v_mul_f32 v73, v24, v73
  v_mul_f32 v74, v24, v74
  v_mul_f32 v75, v24, v75
  v_cvt_pk_bf16_f32 v130, v72, v73
  v_cvt_pk_bf16_f32 v131, v74, v75
  v_mul_f32 v68, v26, v68
  v_mul_f32 v69, v26, v69
  v_mul_f32 v70, v26, v70
  v_mul_f32 v71, v26, v71
  v_cvt_pk_bf16_f32 v132, v68, v69
  v_cvt_pk_bf16_f32 v133, v70, v71
  v_mul_f32 v76, v26, v76
  v_mul_f32 v77, v26, v77
  v_mul_f32 v78, v26, v78
  v_mul_f32 v79, v26, v79
  v_cvt_pk_bf16_f32 v134, v76, v77
  v_cvt_pk_bf16_f32 v135, v78, v79
  v_mul_f32 v80, v24, v80
  v_mul_f32 v81, v24, v81
  v_mul_f32 v82, v24, v82
  v_mul_f32 v83, v24, v83
  v_cvt_pk_bf16_f32 v136, v80, v81
  v_cvt_pk_bf16_f32 v137, v82, v83
  v_mul_f32 v88, v24, v88
  v_mul_f32 v89, v24, v89
  v_mul_f32 v90, v24, v90
  v_mul_f32 v91, v24, v91
  v_cvt_pk_bf16_f32 v138, v88, v89
  v_cvt_pk_bf16_f32 v139, v90, v91
  v_mul_f32 v84, v26, v84
  v_mul_f32 v85, v26, v85
  v_mul_f32 v86, v26, v86
  v_mul_f32 v87, v26, v87
  v_cvt_pk_bf16_f32 v140, v84, v85
  v_cvt_pk_bf16_f32 v141, v86, v87
  v_mul_f32 v92, v26, v92
  v_mul_f32 v93, v26, v93
  v_mul_f32 v94, v26, v94
  v_mul_f32 v95, v26, v95
  v_cvt_pk_bf16_f32 v142, v92, v93
  v_cvt_pk_bf16_f32 v143, v94, v95
  v_mul_f32 v96, v24, v96
  v_mul_f32 v97, v24, v97
  v_mul_f32 v98, v24, v98
  v_mul_f32 v99, v24, v99
  v_cvt_pk_bf16_f32 v144, v96, v97
  v_cvt_pk_bf16_f32 v145, v98, v99
  v_mul_f32 v104, v24, v104
  v_mul_f32 v105, v24, v105
  v_mul_f32 v106, v24, v106
  v_mul_f32 v107, v24, v107
  v_cvt_pk_bf16_f32 v146, v104, v105
  v_cvt_pk_bf16_f32 v147, v106, v107
  v_mul_f32 v100, v26, v100
  v_mul_f32 v101, v26, v101
  v_mul_f32 v102, v26, v102
  v_mul_f32 v103, v26, v103
  v_cvt_pk_bf16_f32 v148, v100, v101
  v_cvt_pk_bf16_f32 v149, v102, v103
  v_mul_f32 v108, v26, v108
  v_mul_f32 v109, v26, v109
  v_mul_f32 v110, v26, v110
  v_mul_f32 v111, v26, v111
  v_cvt_pk_bf16_f32 v150, v108, v109
  v_cvt_pk_bf16_f32 v151, v110, v111
  v_mul_f32 v112, v24, v112
  v_mul_f32 v113, v24, v113
  v_mul_f32 v114, v24, v114
  v_mul_f32 v115, v24, v115
  v_cvt_pk_bf16_f32 v152, v112, v113
  v_cvt_pk_bf16_f32 v153, v114, v115
  v_mul_f32 v120, v24, v120
  v_mul_f32 v121, v24, v121
  v_mul_f32 v122, v24, v122
  v_mul_f32 v123, v24, v123
  v_cvt_pk_bf16_f32 v154, v120, v121
  v_cvt_pk_bf16_f32 v155, v122, v123
  v_mul_f32 v116, v26, v116
  v_mul_f32 v117, v26, v117
  v_mul_f32 v118, v26, v118
  v_mul_f32 v119, v26, v119
  v_cvt_pk_bf16_f32 v156, v116, v117
  v_cvt_pk_bf16_f32 v157, v118, v119
  v_mul_f32 v124, v26, v124
  v_mul_f32 v125, v26, v125
  v_mul_f32 v126, v26, v126
  v_mul_f32 v127, v26, v127
  v_cvt_pk_bf16_f32 v158, v124, v125
  v_cvt_pk_bf16_f32 v159, v126, v127
  v_permlane32_swap_b32 v128, v130
  v_permlane32_swap_b32 v129, v131
  v_permlane32_swap_b32 v132, v134
  v_permlane32_swap_b32 v133, v135
  v_permlane32_swap_b32 v136, v138
  v_permlane32_swap_b32 v137, v139
  v_permlane32_swap_b32 v140, v142
  v_permlane32_swap_b32 v141, v143
  v_permlane32_swap_b32 v144, v146
  v_permlane32_swap_b32 v145, v147
  v_permlane32_swap_b32 v148, v150
  v_permlane32_swap_b32 v149, v151
  v_permlane32_swap_b32 v152, v154
  v_permlane32_swap_b32 v153, v155
  v_permlane32_swap_b32 v156, v158
  v_permlane32_swap_b32 v157, v159
  v_permlane16_swap_b32 v128, v130
  v_permlane16_swap_b32 v129, v131
  v_permlane16_swap_b32 v132, v134
  v_permlane16_swap_b32 v133, v135
  v_permlane16_swap_b32 v136, v138
  v_permlane16_swap_b32 v137, v139
  v_permlane16_swap_b32 v140, v142
  v_permlane16_swap_b32 v141, v143
  v_permlane16_swap_b32 v144, v146
  v_permlane16_swap_b32 v145, v147
  v_permlane16_swap_b32 v148, v150
  v_permlane16_swap_b32 v149, v151
  v_permlane16_swap_b32 v152, v154
  v_permlane16_swap_b32 v153, v155
  v_permlane16_swap_b32 v156, v158
  v_permlane16_swap_b32 v157, v159
  buffer_store_dwordx4 v[128:131], v30, s[20:23], s70 offen offset:0 sc1
  buffer_store_dwordx4 v[132:135], v30, s[20:23], s70 offen offset:1024 sc1
  buffer_store_dwordx4 v[136:139], v30, s[20:23], s70 offen offset:2048 sc1
  buffer_store_dwordx4 v[140:143], v30, s[20:23], s70 offen offset:3072 sc1
  s_add_u32 s70, s70, 4096
  buffer_store_dwordx4 v[144:147], v30, s[20:23], s70 offen offset:0 sc1
  buffer_store_dwordx4 v[148:151], v30, s[20:23], s70 offen offset:1024 sc1
  buffer_store_dwordx4 v[152:155], v30, s[20:23], s70 offen offset:2048 sc1
  buffer_store_dwordx4 v[156:159], v30, s[20:23], s70 offen offset:3072 sc1
  s_cmp_lt_u32 s34, 2
  s_mov_b32 s69, 114688
  s_cselect_b32 s69, s69, 16384
  s_add_u32 s69, s69, s44
  v_add_u32 v24, s69, v30
  ds_write_b128 v24, v[128:131] offset:0
  ds_write_b128 v24, v[132:135] offset:1024
  ds_write_b128 v24, v[136:139] offset:2048
  ds_write_b128 v24, v[140:143] offset:3072
  ds_write_b128 v24, v[144:147] offset:4096
  ds_write_b128 v24, v[148:151] offset:5120
  ds_write_b128 v24, v[152:155] offset:6144
  ds_write_b128 v24, v[156:159] offset:7168
  s_waitcnt lgkmcnt(0)
  s_barrier
  s_waitcnt vmcnt(0)
  v_mov_b32 v28, s86
  v_mov_b32 v29, s87
  s_mov_b64 exec, 1
  buffer_store_dwordx2 v[28:29], off, s[20:23], s46 offset:128 sc1
  s_mov_b64 exec, -1
  s_endpgm
L_grpB:
  s_lshl_b32 s68, s52, 3
  s_add_u32 s68, s68, s53
  s_lshl_b32 s47, s68, 7
  s_add_u32 s47, s47, 34603008
  s_load_dwordx2 s[84:85], s[20:21], s47
  s_lshl_b32 s68, s68, 2
  s_add_u32 s68, s68, s55
  s_lshl_b32 s68, s68, 5
  s_add_u32 s68, s68, s34
  s_lshl_b32 s45, s68, 13
  s_lshl_b32 s68, s35, 2
  s_add_u32 s68, s68, s54
  s_lshl_b32 s68, s68, 15
  s_add_u32 s70, s45, s68
  s_lshl_b32 s68, s2, 2
  s_add_u32 s68, s68, s34
  s_mul_i32 s46, s68, 384
  s_add_u32 s46, s46, 33554432
  s_mov_b32 s49, 0x40004000
  s_and_b32 s44, s34, 1
  s_lshl_b32 s44, s44, 13
  s_lshl_b32 s48, s55, 20
  s_lshl_b32 s68, s54, 8
  s_add_u32 s48, s48, s68
  v_lshrrev_b32 v28, 4, v1
  v_and_b32 v29, 15, v1
  v_lshlrev_b32 v27, 1, v28
  v_xor_b32 v29, v29, v27
  v_lshlrev_b32 v29, 4, v29
  s_lshl_b32 s68, s34, 4
  v_add_u32 v28, s68, v28
  v_lshl_add_u32 v16, v28, 8, v29
  v_xor_b32 v17, 0x80, v16
  v_lshrrev_b32 v28, 4, v1
  v_and_b32 v29, 15, v1
  v_xor_b32 v29, v29, v28
  s_and_b32 s68, s34, 1
  s_lshl_b32 s68, s68, 3
  v_xor_b32 v29, s68, v29
  v_lshlrev_b32 v29, 4, v29
  s_lshl_b32 s68, s34, 4
  v_add_u32 v28, s68, v28
  v_lshl_add_u32 v14, v28, 8, v29
  v_xor_b32 v15, 0x40, v14
  v_bfe_u32 v29, v1, 2, 2
  v_and_b32 v28, 3, v1
  v_lshl_or_b32 v28, v29, 3, v28
  v_lshlrev_b32 v28, 8, v28
  v_and_b32 v29, 15, v1
  v_lshrrev_b32 v27, 4, v1
  v_xor_b32 v29, v29, v27
  v_xor_b32 v27, 0, v29
  v_lshl_add_u32 v2, v27, 4, v28
  v_xor_b32 v27, 4, v29
  v_lshl_add_u32 v3, v27, 4, v28
  v_xor_b32 v27, 8, v29
  v_lshl_add_u32 v4, v27, 4, v28
  v_xor_b32 v27, 12, v29
  v_lshl_add_u32 v5, v27, 4, v28
  s_cmp_lt_u32 s34, 2
  s_mov_b32 s69, 0x14000
  s_cselect_b32 s69, s69, 0xc000
  s_add_u32 s69, s69, s44
  v_add_u32 v2, s69, v2
  v_add_u32 v3, s69, v3
  v_add_u32 v4, s69, v4
  v_add_u32 v5, s69, v5
  s_add_u32 s59, s41, 1
  s_and_b32 s59, s59, 3
  s_lshl_b32 s59, s59, 8
  s_add_u32 s59, s59, s43
  s_add_u32 m0, s60, 147456
  s_mov_b32 s68, s59
  buffer_load_dwordx4 v24, s[12:15], s68 offen offset:0 lds
  s_add_u32 m0, s60, 147456
  s_add_u32 s68, s59, 3072
  buffer_load_dwordx4 v24, s[12:15], s68 offen offset:1024 lds
  s_add_u32 m0, s60, 147456
  s_add_u32 s68, s59, 6144
  buffer_load_dwordx4 v25, s[12:15], s68 offen offset:2048 lds
  s_add_u32 m0, s60, 147456
  s_add_u32 s68, s59, 9216
  buffer_load_dwordx4 v25, s[12:15], s68 offen offset:3072 lds
  v_bfe_u32 v28, v1, 2, 3
  v_bfe_u32 v27, v1, 2, 2
  v_lshrrev_b32 v29, 4, v1
  v_lshl_add_u32 v29, v29, 3, v27
  v_lshlrev_b32 v29, 8, v29
  v_and_b32 v27, 3, v1
  v_lshl_add_u32 v29, v27, 3, v29
  v_add_u32 v29, 49152, v29
  v_xor_b32 v27, 0, v28
  v_lshl_add_u32 v6, v27, 5, v29
  v_xor_b32 v27, 1, v28
  v_lshl_add_u32 v7, v27, 5, v29
  v_xor_b32 v27, 2, v28
  v_lshl_add_u32 v8, v27, 5, v29
  v_xor_b32 v27, 3, v28
  v_lshl_add_u32 v9, v27, 5, v29
  v_xor_b32 v27, 4, v28
  v_lshl_add_u32 v10, v27, 5, v29
  v_xor_b32 v27, 5, v28
  v_lshl_add_u32 v11, v27, 5, v29
  v_xor_b32 v27, 6, v28
  v_lshl_add_u32 v12, v27, 5, v29
  v_xor_b32 v27, 7, v28
  v_lshl_add_u32 v13, v27, 5, v29
  v_mov_b64 v[64:65], 0
  v_mov_b64 v[66:67], 0
  v_mov_b64 v[68:69], 0
  v_mov_b64 v[70:71], 0
  v_mov_b64 v[72:73], 0
  v_mov_b64 v[74:75], 0
  v_mov_b64 v[76:77], 0
  v_mov_b64 v[78:79], 0
  v_mov_b64 v[80:81], 0
  v_mov_b64 v[82:83], 0
  v_mov_b64 v[84:85], 0
  v_mov_b64 v[86:87], 0
  v_mov_b64 v[88:89], 0
  v_mov_b64 v[90:91], 0
  v_mov_b64 v[92:93], 0
  v_mov_b64 v[94:95], 0
  v_mov_b64 v[96:97], 0
  v_mov_b64 v[98:99], 0
  v_mov_b64 v[100:101], 0
  v_mov_b64 v[102:103], 0
  v_mov_b64 v[104:105], 0
  v_mov_b64 v[106:107], 0
  v_mov_b64 v[108:109], 0
  v_mov_b64 v[110:111], 0
  v_mov_b64 v[112:113], 0
  v_mov_b64 v[114:115], 0
  v_mov_b64 v[116:117], 0
  v_mov_b64 v[118:119], 0
  v_mov_b64 v[120:121], 0
  v_mov_b64 v[122:123], 0
  v_mov_b64 v[124:125], 0
  v_mov_b64 v[126:127], 0
  s_waitcnt lgkmcnt(0)
  s_mul_i32 s86, s84, 0x9E3779B1
  s_add_u32 s86, s86, 0x7F4A7C15
  s_mul_i32 s87, s85, 0x85EBCA6D
  s_add_u32 s87, s87, 0x27D4EB2F
  s_waitcnt vmcnt(4)
  s_barrier
  ds_read_b128 v[128:131], v2 offset:0
  ds_read_b128 v[132:135], v2 offset:1024
  ds_read_b128 v[136:139], v3 offset:0
  ds_read_b128 v[140:143], v3 offset:1024
  ds_read_b128 v[144:147], v4 offset:0
  ds_read_b128 v[148:151], v4 offset:1024
  ds_read_b128 v[152:155], v5 offset:0
  ds_read_b128 v[156:159], v5 offset:1024
  s_add_u32 s59, s41, 1
  s_and_b32 s59, s59, 3
  s_lshl_b32 s59, s59, 8
  s_add_u32 s59, s59, s43
  s_add_u32 s59, s59, 65536
  s_add_u32 m0, s60, 98304
  s_mov_b32 s68, s59
  buffer_load_dwordx4 v24, s[12:15], s68 offen offset:0 lds
  s_add_u32 m0, s60, 98304
  s_add_u32 s68, s59, 3072
  buffer_load_dwordx4 v24, s[12:15], s68 offen offset:1024 lds
  s_add_u32 m0, s60, 98304
  s_add_u32 s68, s59, 6144
  buffer_load_dwordx4 v25, s[12:15], s68 offen offset:2048 lds
  s_add_u32 m0, s60, 98304
  s_add_u32 s68, s59, 9216
  buffer_load_dwordx4 v25, s[12:15], s68 offen offset:3072 lds
  s_waitcnt lgkmcnt(0)
  s_cmp_lt_u32 s34, 2
  s_mov_b32 s69, 0x10000
  s_cselect_b32 s69, s69, 0xc000
  v_add_u32 v2, s69, v2
  v_add_u32 v3, s69, v3
  v_add_u32 v4, s69, v4
  v_add_u32 v5, s69, v5
  s_barrier
  s_add_u32 s59, s41, 2
  s_and_b32 s59, s59, 3
  s_lshl_b32 s59, s59, 8
  s_add_u32 s59, s59, s43
  s_add_u32 m0, s60, 65536
  s_mov_b32 s68, s59
  buffer_load_dwordx4 v24, s[12:15], s68 offen offset:0 lds
  s_add_u32 m0, s60, 65536
  s_add_u32 s68, s59, 3072
  buffer_load_dwordx4 v24, s[12:15], s68 offen offset:1024 lds
  s_add_u32 m0, s60, 65536
  s_add_u32 s68, s59, 6144
  buffer_load_dwordx4 v25, s[12:15], s68 offen offset:2048 lds
  s_add_u32 m0, s60, 65536
  s_add_u32 s68, s59, 9216
  buffer_load_dwordx4 v25, s[12:15], s68 offen offset:3072 lds
  s_add_u32 s59, s41, 2
  s_and_b32 s59, s59, 3
  s_lshl_b32 s59, s59, 8
  s_add_u32 s59, s59, s43
  s_add_u32 s59, s59, 65536
  s_add_u32 m0, s60, 32768
  s_mov_b32 s68, s59
  buffer_load_dwordx4 v24, s[12:15], s68 offen offset:0 lds
  s_add_u32 m0, s60, 32768
  s_add_u32 s68, s59, 3072
  buffer_load_dwordx4 v24, s[12:15], s68 offen offset:1024 lds
  s_add_u32 m0, s60, 32768
  s_add_u32 s68, s59, 6144
  buffer_load_dwordx4 v25, s[12:15], s68 offen offset:2048 lds
  s_add_u32 m0, s60, 32768
  s_add_u32 s68, s59, 9216
  buffer_load_dwordx4 v25, s[12:15], s68 offen offset:3072 lds
  s_waitcnt vmcnt(8)
  s_barrier
  ds_read_b128 v[160:163], v2 offset:0
  ds_read_b128 v[164:167], v2 offset:1024
  ds_read_b128 v[168:171], v3 offset:0
  ds_read_b128 v[172:175], v3 offset:1024
  ds_read_b128 v[176:179], v4 offset:0
  ds_read_b128 v[180:183], v4 offset:1024
  ds_read_b128 v[184:187], v5 offset:0
  ds_read_b128 v[188:191], v5 offset:1024
  s_add_u32 s59, s41, 3
  s_and_b32 s59, s59, 3
  s_lshl_b32 s59, s59, 8
  s_add_u32 s59, s59, s43
  s_add_u32 m0, s60, 114688
  s_mov_b32 s68, s59
  buffer_load_dwordx4 v24, s[12:15], s68 offen offset:0 lds
  s_add_u32 m0, s60, 114688
  s_add_u32 s68, s59, 3072
  buffer_load_dwordx4 v24, s[12:15], s68 offen offset:1024 lds
  s_add_u32 m0, s60, 114688
  s_add_u32 s68, s59, 6144
  buffer_load_dwordx4 v25, s[12:15], s68 offen offset:2048 lds
  s_add_u32 m0, s60, 114688
  s_add_u32 s68, s59, 9216
  buffer_load_dwordx4 v25, s[12:15], s68 offen offset:3072 lds
  s_waitcnt lgkmcnt(0)
  s_cmp_lt_u32 s34, 2
  s_mov_b32 s69, 0xfffec000
  s_cselect_b32 s69, s69, 0xffff0000
  v_add_u32 v2, s69, v2
  v_add_u32 v3, s69, v3
  v_add_u32 v4, s69, v4
  v_add_u32 v5, s69, v5
  s_barrier
  s_add_u32 s59, s41, 3
  s_and_b32 s59, s59, 3
  s_lshl_b32 s59, s59, 8
  s_add_u32 s59, s59, s43
  s_add_u32 s59, s59, 65536
  s_add_u32 m0, s60, 131072
  s_mov_b32 s68, s59
  buffer_load_dwordx4 v24, s[12:15], s68 offen offset:0 lds
  s_add_u32 m0, s60, 131072
  s_add_u32 s68, s59, 3072
  buffer_load_dwordx4 v24, s[12:15], s68 offen offset:1024 lds
  s_add_u32 m0, s60, 131072
  s_add_u32 s68, s59, 6144
  buffer_load_dwordx4 v25, s[12:15], s68 offen offset:2048 lds
  s_add_u32 m0, s60, 131072
  s_add_u32 s68, s59, 9216
  buffer_load_dwordx4 v25, s[12:15], s68 offen offset:3072 lds
  s_waitcnt vmcnt(8)
  s_barrier
  ds_read_b128 v[192:195], v2 offset:0
  ds_read_b128 v[196:199], v2 offset:1024
  ds_read_b128 v[200:203], v3 offset:0
  ds_read_b128 v[204:207], v3 offset:1024
  ds_read_b128 v[208:211], v4 offset:0
  ds_read_b128 v[212:215], v4 offset:1024
  ds_read_b128 v[216:219], v5 offset:0
  ds_read_b128 v[220:223], v5 offset:1024
  s_add_u32 m0, s60, 0
  s_nop 0
  buffer_load_dwordx4 v14, s[4:7], s56 offen offset:0 nt lds
  buffer_load_dwordx4 v14, s[4:7], s56 offen offset:1024 nt lds
  buffer_load_dwordx4 v15, s[4:7], s56 offen offset:2048 nt lds
  buffer_load_dwordx4 v15, s[4:7], s56 offen offset:3072 nt lds
  s_add_u32 s56, s56, 16384
  s_waitcnt lgkmcnt(0)
  s_cmp_lt_u32 s34, 2
  s_mov_b32 s69, 0xc000
  s_cselect_b32 s69, s69, 0x18000
  v_add_u32 v2, s69, v2
  v_add_u32 v3, s69, v3
  v_add_u32 v4, s69, v4
  v_add_u32 v5, s69, v5
  s_barrier
  s_add_u32 m0, s60, 16384
  s_nop 0
  buffer_load_dwordx4 v14, s[4:7], s56 offen offset:0 nt lds
  buffer_load_dwordx4 v14, s[4:7], s56 offen offset:1024 nt lds
  buffer_load_dwordx4 v15, s[4:7], s56 offen offset:2048 nt lds
  buffer_load_dwordx4 v15, s[4:7], s56 offen offset:3072 nt lds
  s_add_u32 s56, s56, 16384
  s_waitcnt vmcnt(8)
  s_barrier
  ds_read_b128 v[32:35], v2 offset:0
  ds_read_b128 v[36:39], v2 offset:1024
  ds_read_b128 v[40:43], v3 offset:0
  ds_read_b128 v[44:47], v3 offset:1024
  ds_read_b128 v[48:51], v4 offset:0
  ds_read_b128 v[52:55], v4 offset:1024
  ds_read_b128 v[56:59], v5 offset:0
  ds_read_b128 v[60:63], v5 offset:1024
  s_add_u32 m0, s60, 65536
  s_nop 0
  buffer_load_dwordx4 v16, s[8:11], s57 offen offset:0 nt lds
  buffer_load_dwordx4 v16, s[8:11], s57 offen offset:1024 nt lds
  buffer_load_dwordx4 v17, s[8:11], s57 offen offset:2048 nt lds
  buffer_load_dwordx4 v17, s[8:11], s57 offen offset:3072 nt lds
  s_add_u32 s57, s57, 16384
  s_waitcnt lgkmcnt(0)
  s_cmp_lt_u32 s34, 2
  s_mov_b32 s69, 0xfffe8000
  s_cselect_b32 s69, s69, 0xfffe4000
  s_sub_u32 s69, s69, s44
  v_add_u32 v2, s69, v2
  v_add_u32 v3, s69, v3
  v_add_u32 v4, s69, v4
  v_add_u32 v5, s69, v5
  s_barrier
  s_waitcnt vmcnt(8)
  s_barrier
  s_add_u32 m0, s60, 32768
  s_nop 0
  buffer_load_dwordx4 v14, s[4:7], s56 offen offset:0 nt lds
  buffer_load_dwordx4 v14, s[4:7], s56 offen offset:1024 nt lds
  buffer_load_dwordx4 v15, s[4:7], s56 offen offset:2048 nt lds
  buffer_load_dwordx4 v15, s[4:7], s56 offen offset:3072 nt lds
  s_add_u32 s56, s56, 16384
  s_add_u32 m0, s60, 81920
  s_nop 0
  buffer_load_dwordx4 v16, s[8:11], s57 offen offset:0 nt lds
  buffer_load_dwordx4 v16, s[8:11], s57 offen offset:1024 nt lds
  buffer_load_dwordx4 v17, s[8:11], s57 offen offset:2048 nt lds
  buffer_load_dwordx4 v17, s[8:11], s57 offen offset:3072 nt lds
  s_add_u32 s57, s57, 16384
  s_add_u32 s58, s41, 0
  s_and_b32 s58, s58, 3
  s_lshl_b32 s58, s58, 20
  s_add_u32 s58, s58, s42
  s_add_u32 s58, s58, 1024
  s_add_u32 m0, s60, 49152
  s_mov_b32 s68, s58
  buffer_load_dwordx4 v18, s[16:19], s68 offen offset:0 lds
  s_add_u32 m0, s60, 49152
  s_add_u32 s68, s58, 31744
  buffer_load_dwordx4 v18, s[16:19], s68 offen offset:1024 lds
  s_waitcnt vmcnt(10)
  s_barrier
  s_add_u32 m0, s60, 49152
  s_add_u32 s68, s58, 63488
  buffer_load_dwordx4 v19, s[16:19], s68 offen offset:2048 lds
  s_add_u32 m0, s60, 49152
  s_add_u32 s68, s58, 95232
  buffer_load_dwordx4 v19, s[16:19], s68 offen offset:3072 lds
  s_add_u32 m0, s60, 0
  s_nop 0
  buffer_load_dwordx4 v14, s[4:7], s56 offen offset:0 nt lds
  buffer_load_dwordx4 v14, s[4:7], s56 offen offset:1024 nt lds
  buffer_load_dwordx4 v15, s[4:7], s56 offen offset:2048 nt lds
  buffer_load_dwordx4 v15, s[4:7], s56 offen offset:3072 nt lds
  s_add_u32 s56, s56, 16384
  s_add_u32 m0, s60, 98304
  s_nop 0
  buffer_load_dwordx4 v16, s[8:11], s57 offen offset:0 nt lds
  buffer_load_dwordx4 v16, s[8:11], s57 offen offset:1024 nt lds
  buffer_load_dwordx4 v17, s[8:11], s57 offen offset:2048 nt lds
  buffer_load_dwordx4 v17, s[8:11], s57 offen offset:3072 nt lds
  s_add_u32 s57, s57, 16384
  s_waitcnt vmcnt(8)
  s_barrier
  s_add_u32 s58, s41, 0
  s_and_b32 s58, s58, 3
  s_lshl_b32 s58, s58, 20
  s_add_u32 s58, s58, s42
  s_add_u32 s58, s58, 525312
  s_add_u32 m0, s60, 114688
  s_mov_b32 s68, s58
  buffer_load_dwordx4 v18, s[16:19], s68 offen offset:0 lds
  ds_read_b64_tr_b16 v[224:225], v6 offset:0
  ds_read_b64_tr_b16 v[226:227], v6 offset:1024
  s_add_u32 m0, s60, 114688
  s_add_u32 s68, s58, 31744
  buffer_load_dwordx4 v18, s[16:19], s68 offen offset:1024 lds
  ds_read_b64_tr_b16 v[228:229], v7 offset:0
  ds_read_b64_tr_b16 v[230:231], v7 offset:1024
  s_add_u32 m0, s60, 114688
  s_add_u32 s68, s58, 63488
  buffer_load_dwordx4 v19, s[16:19], s68 offen offset:2048 lds
  ds_read_b64_tr_b16 v[232:233], v8 offset:0
  ds_read_b64_tr_b16 v[234:235], v8 offset:1024
  s_add_u32 m0, s60, 114688
  s_add_u32 s68, s58, 95232
  buffer_load_dwordx4 v19, s[16:19], s68 offen offset:3072 lds
  ds_read_b64_tr_b16 v[236:237], v9 offset:0
  ds_read_b64_tr_b16 v[238:239], v9 offset:1024
  s_add_u32 m0, s60, 16384
  s_nop 0
  buffer_load_dwordx4 v14, s[4:7], s56 offen offset:0 nt lds
  ds_read_b64_tr_b16 v[240:241], v10 offset:0
  s_waitcnt lgkmcnt(7)
  ds_read_b64_tr_b16 v[242:243], v10 offset:1024
  buffer_load_dwordx4 v14, s[4:7], s56 offen offset:1024 nt lds
  buffer_load_dwordx4 v15, s[4:7], s56 offen offset:2048 nt lds
  v_mfma_f32_16x16x32_bf16 v[64:67], v[224:227], v[128:131], v[64:67]
  ds_read_b64_tr_b16 v[244:245], v11 offset:0
  v_mfma_f32_16x16x32_bf16 v[68:71], v[224:227], v[132:135], v[68:71]
  s_waitcnt lgkmcnt(7)
  ds_read_b64_tr_b16 v[246:247], v11 offset:1024
  buffer_load_dwordx4 v15, s[4:7], s56 offen offset:3072 nt lds
  s_add_u32 s56, s56, 16384
  v_mfma_f32_16x16x32_bf16 v[72:75], v[228:231], v[128:131], v[72:75]
  ds_read_b64_tr_b16 v[248:249], v12 offset:0
  v_mfma_f32_16x16x32_bf16 v[76:79], v[228:231], v[132:135], v[76:79]
  s_waitcnt lgkmcnt(7)
  ds_read_b64_tr_b16 v[250:251], v12 offset:1024
  s_add_u32 m0, s60, 65536
  s_nop 0
  buffer_load_dwordx4 v16, s[8:11], s57 offen offset:0 nt lds
  v_mfma_f32_16x16x32_bf16 v[80:83], v[232:235], v[128:131], v[80:83]
  ds_read_b64_tr_b16 v[252:253], v13 offset:0
  v_mfma_f32_16x16x32_bf16 v[84:87], v[232:235], v[132:135], v[84:87]
  s_waitcnt lgkmcnt(7)
  ds_read_b64_tr_b16 v[254:255], v13 offset:1024
  buffer_load_dwordx4 v16, s[8:11], s57 offen offset:1024 nt lds
  s_mov_b32 s72, 0x10000
  v_mfma_f32_16x16x32_bf16 v[88:91], v[236:239], v[128:131], v[88:91]
  ds_read_b64_tr_b16 v[224:225], v6 offset:8192
  v_mfma_f32_16x16x32_bf16 v[92:95], v[236:239], v[132:135], v[92:95]
  s_waitcnt lgkmcnt(7)
  ds_read_b64_tr_b16 v[226:227], v6 offset:9216
  buffer_load_dwordx4 v17, s[8:11], s57 offen offset:2048 nt lds
  v_mfma_f32_16x16x32_bf16 v[96:99], v[240:243], v[128:131], v[96:99]
  ds_read_b64_tr_b16 v[228:229], v7 offset:8192
  v_add_u32 v6, s72, v6
  v_mfma_f32_16x16x32_bf16 v[100:103], v[240:243], v[132:135], v[100:103]
  s_waitcnt lgkmcnt(7)
  ds_read_b64_tr_b16 v[230:231], v7 offset:9216
  buffer_load_dwordx4 v17, s[8:11], s57 offen offset:3072 nt lds
  s_add_u32 s57, s57, 16384
  s_waitcnt vmcnt(8)
  s_barrier
  s_add_u32 s58, s41, 1
  s_and_b32 s58, s58, 3
  s_lshl_b32 s58, s58, 20
  s_add_u32 s58, s58, s42
  s_add_u32 s58, s58, 1024
  s_add_u32 m0, s60, 131072
  s_mov_b32 s68, s58
  buffer_load_dwordx4 v18, s[16:19], s68 offen offset:0 lds
  v_mfma_f32_16x16x32_bf16 v[104:107], v[244:247], v[128:131], v[104:107]
  ds_read_b64_tr_b16 v[232:233], v8 offset:8192
  v_add_u32 v7, s72, v7
  v_mfma_f32_16x16x32_bf16 v[108:111], v[244:247], v[132:135], v[108:111]
  s_waitcnt lgkmcnt(7)
  ds_read_b64_tr_b16 v[234:235], v8 offset:9216
  s_add_u32 m0, s60, 131072
  s_add_u32 s68, s58, 31744
  buffer_load_dwordx4 v18, s[16:19], s68 offen offset:1024 lds
  v_mfma_f32_16x16x32_bf16 v[112:115], v[248:251], v[128:131], v[112:115]
  ds_read_b64_tr_b16 v[236:237], v9 offset:8192
  v_add_u32 v8, s72, v8
  v_mfma_f32_16x16x32_bf16 v[116:119], v[248:251], v[132:135], v[116:119]
  s_waitcnt lgkmcnt(7)
  ds_read_b64_tr_b16 v[238:239], v9 offset:9216
  s_add_u32 m0, s60, 32768
  s_nop 0
  buffer_load_dwordx4 v14, s[4:7], s56 offen offset:0 nt lds
  v_mfma_f32_16x16x32_bf16 v[120:123], v[252:255], v[128:131], v[120:123]
  ds_read_b64_tr_b16 v[240:241], v10 offset:8192
  v_add_u32 v9, s72, v9
  v_mfma_f32_16x16x32_bf16 v[124:127], v[252:255], v[132:135], v[124:127]
  s_waitcnt lgkmcnt(7)
  ds_read_b64_tr_b16 v[242:243], v10 offset:9216
  buffer_load_dwordx4 v14, s[4:7], s56 offen offset:1024 nt lds
  v_mfma_f32_16x16x32_bf16 v[64:67], v[224:227], v[136:139], v[64:67]
  ds_read_b64_tr_b16 v[244:245], v11 offset:8192
  v_add_u32 v10, s72, v10
  v_mfma_f32_16x16x32_bf16 v[68:71], v[224:227], v[140:143], v[68:71]
  s_waitcnt lgkmcnt(7)
  ds_read_b64_tr_b16 v[246:247], v11 offset:9216
  buffer_load_dwordx4 v15, s[4:7], s56 offen offset:2048 nt lds
  v_mfma_f32_16x16x32_bf16 v[72:75], v[228:231], v[136:139], v[72:75]
  ds_read_b64_tr_b16 v[248:249], v12 offset:8192
  v_add_u32 v11, s72, v11
  v_mfma_f32_16x16x32_bf16 v[76:79], v[228:231], v[140:143], v[76:79]
  s_waitcnt lgkmcnt(7)
  ds_read_b64_tr_b16 v[250:251], v12 offset:9216
  buffer_load_dwordx4 v15, s[4:7], s56 offen offset:3072 nt lds
  s_add_u32 s56, s56, 16384
  v_mfma_f32_16x16x32_bf16 v[80:83], v[232:235], v[136:139], v[80:83]
  ds_read_b64_tr_b16 v[252:253], v13 offset:8192
  v_add_u32 v12, s72, v12
  v_mfma_f32_16x16x32_bf16 v[84:87], v[232:235], v[140:143], v[84:87]
  s_waitcnt lgkmcnt(7)
  ds_read_b64_tr_b16 v[254:255], v13 offset:9216
  v_add_u32 v13, s72, v13
  s_add_u32 m0, s60, 81920
  s_nop 0
  buffer_load_dwordx4 v16, s[8:11], s57 offen offset:0 nt lds
  v_mfma_f32_16x16x32_bf16 v[88:91], v[236:239], v[136:139], v[88:91]
  ds_read_b64_tr_b16 v[224:225], v6 offset:0
  v_mfma_f32_16x16x32_bf16 v[92:95], v[236:239], v[140:143], v[92:95]
  s_waitcnt lgkmcnt(7)
  ds_read_b64_tr_b16 v[226:227], v6 offset:1024
  buffer_load_dwordx4 v16, s[8:11], s57 offen offset:1024 nt lds
  v_mfma_f32_16x16x32_bf16 v[96:99], v[240:243], v[136:139], v[96:99]
  ds_read_b64_tr_b16 v[228:229], v7 offset:0
  v_mfma_f32_16x16x32_bf16 v[100:103], v[240:243], v[140:143], v[100:103]
  s_waitcnt lgkmcnt(7)
  ds_read_b64_tr_b16 v[230:231], v7 offset:1024
  buffer_load_dwordx4 v17, s[8:11], s57 offen offset:2048 nt lds
  v_mfma_f32_16x16x32_bf16 v[104:107], v[244:247], v[136:139], v[104:107]
  ds_read_b64_tr_b16 v[232:233], v8 offset:0
  v_mfma_f32_16x16x32_bf16 v[108:111], v[244:247], v[140:143], v[108:111]
  s_waitcnt lgkmcnt(7)
  ds_read_b64_tr_b16 v[234:235], v8 offset:1024
  buffer_load_dwordx4 v17, s[8:11], s57 offen offset:3072 nt lds
  s_add_u32 s57, s57, 16384
  v_mfma_f32_16x16x32_bf16 v[112:115], v[248:251], v[136:139], v[112:115]
  ds_read_b64_tr_b16 v[236:237], v9 offset:0
  v_mfma_f32_16x16x32_bf16 v[116:119], v[248:251], v[140:143], v[116:119]
  s_waitcnt lgkmcnt(7)
  ds_read_b64_tr_b16 v[238:239], v9 offset:1024
  s_waitcnt vmcnt(10)
  s_barrier
  s_add_u32 m0, s60, 131072
  s_add_u32 s68, s58, 63488
  buffer_load_dwordx4 v19, s[16:19], s68 offen offset:2048 lds
  v_mfma_f32_16x16x32_bf16 v[120:123], v[252:255], v[136:139], v[120:123]
  ds_read_b64_tr_b16 v[240:241], v10 offset:0
  v_mfma_f32_16x16x32_bf16 v[124:127], v[252:255], v[140:143], v[124:127]
  s_waitcnt lgkmcnt(7)
  ds_read_b64_tr_b16 v[242:243], v10 offset:1024
  s_add_u32 m0, s60, 131072
  s_add_u32 s68, s58, 95232
  buffer_load_dwordx4 v19, s[16:19], s68 offen offset:3072 lds
  v_mfma_f32_16x16x32_bf16 v[64:67], v[224:227], v[144:147], v[64:67]
  ds_read_b64_tr_b16 v[244:245], v11 offset:0
  v_mfma_f32_16x16x32_bf16 v[68:71], v[224:227], v[148:151], v[68:71]
  s_waitcnt lgkmcnt(7)
  ds_read_b64_tr_b16 v[246:247], v11 offset:1024
  s_add_u32 m0, s60, 0
  s_nop 0
  buffer_load_dwordx4 v14, s[4:7], s56 offen offset:0 nt lds
  v_mfma_f32_16x16x32_bf16 v[72:75], v[228:231], v[144:147], v[72:75]
  ds_read_b64_tr_b16 v[248:249], v12 offset:0
  v_mfma_f32_16x16x32_bf16 v[76:79], v[228:231], v[148:151], v[76:79]
  s_waitcnt lgkmcnt(7)
  ds_read_b64_tr_b16 v[250:251], v12 offset:1024
  buffer_load_dwordx4 v14, s[4:7], s56 offen offset:1024 nt lds
  v_mfma_f32_16x16x32_bf16 v[80:83], v[232:235], v[144:147], v[80:83]
  ds_read_b64_tr_b16 v[252:253], v13 offset:0
  v_mfma_f32_16x16x32_bf16 v[84:87], v[232:235], v[148:151], v[84:87]
  s_waitcnt lgkmcnt(7)
  ds_read_b64_tr_b16 v[254:255], v13 offset:1024
  buffer_load_dwordx4 v15, s[4:7], s56 offen offset:2048 nt lds
  s_mov_b32 s72, 0x4000
  v_mfma_f32_16x16x32_bf16 v[88:91], v[236:239], v[144:147], v[88:91]
  ds_read_b64_tr_b16 v[224:225], v6 offset:8192
  v_mfma_f32_16x16x32_bf16 v[92:95], v[236:239], v[148:151], v[92:95]
  s_waitcnt lgkmcnt(7)
  ds_read_b64_tr_b16 v[226:227], v6 offset:9216
  buffer_load_dwordx4 v15, s[4:7], s56 offen offset:3072 nt lds
  s_add_u32 s56, s56, 16384
  v_mfma_f32_16x16x32_bf16 v[96:99], v[240:243], v[144:147], v[96:99]
  ds_read_b64_tr_b16 v[228:229], v7 offset:8192
  v_add_u32 v6, s72, v6
  v_mfma_f32_16x16x32_bf16 v[100:103], v[240:243], v[148:151], v[100:103]
  s_waitcnt lgkmcnt(7)
  ds_read_b64_tr_b16 v[230:231], v7 offset:9216
  s_add_u32 m0, s60, 98304
  s_nop 0
  buffer_load_dwordx4 v16, s[8:11], s57 offen offset:0 nt lds
  v_mfma_f32_16x16x32_bf16 v[104:107], v[244:247], v[144:147], v[104:107]
  ds_read_b64_tr_b16 v[232:233], v8 offset:8192
  v_add_u32 v7, s72, v7
  v_mfma_f32_16x16x32_bf16 v[108:111], v[244:247], v[148:151], v[108:111]
  s_waitcnt lgkmcnt(7)
  ds_read_b64_tr_b16 v[234:235], v8 offset:9216
  buffer_load_dwordx4 v16, s[8:11], s57 offen offset:1024 nt lds
  v_mfma_f32_16x16x32_bf16 v[112:115], v[248:251], v[144:147], v[112:115]
  ds_read_b64_tr_b16 v[236:237], v9 offset:8192
  v_add_u32 v8, s72, v8
  v_mfma_f32_16x16x32_bf16 v[116:119], v[248:251], v[148:151], v[116:119]
  s_waitcnt lgkmcnt(7)
  ds_read_b64_tr_b16 v[238:239], v9 offset:9216
  buffer_load_dwordx4 v17, s[8:11], s57 offen offset:2048 nt lds
  v_mfma_f32_16x16x32_bf16 v[120:123], v[252:255], v[144:147], v[120:123]
  ds_read_b64_tr_b16 v[240:241], v10 offset:8192
  v_add_u32 v9, s72, v9
  v_mfma_f32_16x16x32_bf16 v[124:127], v[252:255], v[148:151], v[124:127]
  s_waitcnt lgkmcnt(7)
  ds_read_b64_tr_b16 v[242:243], v10 offset:9216
  buffer_load_dwordx4 v17, s[8:11], s57 offen offset:3072 nt lds
  s_add_u32 s57, s57, 16384
  v_mfma_f32_16x16x32_bf16 v[64:67], v[224:227], v[152:155], v[64:67]
  ds_read_b64_tr_b16 v[244:245], v11 offset:8192
  v_add_u32 v10, s72, v10
  v_mfma_f32_16x16x32_bf16 v[68:71], v[224:227], v[156:159], v[68:71]
  s_waitcnt lgkmcnt(7)
  ds_read_b64_tr_b16 v[246:247], v11 offset:9216
  s_waitcnt vmcnt(8)
  s_barrier
  s_add_u32 s58, s41, 1
  s_and_b32 s58, s58, 3
  s_lshl_b32 s58, s58, 20
  s_add_u32 s58, s58, s42
  s_add_u32 s58, s58, 525312
  s_add_u32 m0, s60, 147456
  s_mov_b32 s68, s58
  buffer_load_dwordx4 v18, s[16:19], s68 offen offset:0 lds
  v_mfma_f32_16x16x32_bf16 v[72:75], v[228:231], v[152:155], v[72:75]
  ds_read_b64_tr_b16 v[248:249], v12 offset:8192
  v_add_u32 v11, s72, v11
  v_mfma_f32_16x16x32_bf16 v[76:79], v[228:231], v[156:159], v[76:79]
  s_waitcnt lgkmcnt(7)
  ds_read_b64_tr_b16 v[250:251], v12 offset:9216
  s_add_u32 m0, s60, 147456
  s_add_u32 s68, s58, 31744
  buffer_load_dwordx4 v18, s[16:19], s68 offen offset:1024 lds
  v_mfma_f32_16x16x32_bf16 v[80:83], v[232:235], v[152:155], v[80:83]
  ds_read_b64_tr_b16 v[252:253], v13 offset:8192
  v_add_u32 v12, s72, v12
  v_mfma_f32_16x16x32_bf16 v[84:87], v[232:235], v[156:159], v[84:87]
  s_waitcnt lgkmcnt(7)
  ds_read_b64_tr_b16 v[254:255], v13 offset:9216
  v_add_u32 v13, s72, v13
  s_add_u32 m0, s60, 147456
  s_add_u32 s68, s58, 63488
  buffer_load_dwordx4 v19, s[16:19], s68 offen offset:2048 lds
  v_mfma_f32_16x16x32_bf16 v[88:91], v[236:239], v[152:155], v[88:91]
  ds_read_b64_tr_b16 v[224:225], v6 offset:0
  v_mfma_f32_16x16x32_bf16 v[92:95], v[236:239], v[156:159], v[92:95]
  s_waitcnt lgkmcnt(7)
  ds_read_b64_tr_b16 v[226:227], v6 offset:1024
  s_add_u32 m0, s60, 147456
  s_add_u32 s68, s58, 95232
  buffer_load_dwordx4 v19, s[16:19], s68 offen offset:3072 lds
  v_mfma_f32_16x16x32_bf16 v[96:99], v[240:243], v[152:155], v[96:99]
  ds_read_b64_tr_b16 v[228:229], v7 offset:0
  v_mfma_f32_16x16x32_bf16 v[100:103], v[240:243], v[156:159], v[100:103]
  s_waitcnt lgkmcnt(7)
  ds_read_b64_tr_b16 v[230:231], v7 offset:1024
  s_add_u32 m0, s60, 16384
  s_nop 0
  buffer_load_dwordx4 v14, s[4:7], s56 offen offset:0 nt lds
  v_mfma_f32_16x16x32_bf16 v[104:107], v[244:247], v[152:155], v[104:107]
  ds_read_b64_tr_b16 v[232:233], v8 offset:0
  v_mfma_f32_16x16x32_bf16 v[108:111], v[244:247], v[156:159], v[108:111]
  s_waitcnt lgkmcnt(7)
  ds_read_b64_tr_b16 v[234:235], v8 offset:1024
  buffer_load_dwordx4 v14, s[4:7], s56 offen offset:1024 nt lds
  buffer_load_dwordx4 v15, s[4:7], s56 offen offset:2048 nt lds
  v_mfma_f32_16x16x32_bf16 v[112:115], v[248:251], v[152:155], v[112:115]
  ds_read_b64_tr_b16 v[236:237], v9 offset:0
  v_mfma_f32_16x16x32_bf16 v[116:119], v[248:251], v[156:159], v[116:119]
  s_waitcnt lgkmcnt(7)
  ds_read_b64_tr_b16 v[238:239], v9 offset:1024
  buffer_load_dwordx4 v15, s[4:7], s56 offen offset:3072 nt lds
  s_add_u32 s56, s56, 16384
  v_mfma_f32_16x16x32_bf16 v[120:123], v[252:255], v[152:155], v[120:123]
  ds_read_b64_tr_b16 v[240:241], v10 offset:0
  v_mfma_f32_16x16x32_bf16 v[124:127], v[252:255], v[156:159], v[124:127]
  s_waitcnt lgkmcnt(7)
  ds_read_b64_tr_b16 v[242:243], v10 offset:1024
  s_add_u32 m0, s60, 65536
  s_nop 0
  buffer_load_dwordx4 v16, s[8:11], s57 offen offset:0 nt lds
  v_mfma_f32_16x16x32_bf16 v[64:67], v[224:227], v[160:163], v[64:67]
  ds_read_b64_tr_b16 v[244:245], v11 offset:0
  v_mfma_f32_16x16x32_bf16 v[68:71], v[224:227], v[164:167], v[68:71]
  s_waitcnt lgkmcnt(7)
  ds_read_b64_tr_b16 v[246:247], v11 offset:1024
  buffer_load_dwordx4 v16, s[8:11], s57 offen offset:1024 nt lds
  v_mfma_f32_16x16x32_bf16 v[72:75], v[228:231], v[160:163], v[72:75]
  ds_read_b64_tr_b16 v[248:249], v12 offset:0
  v_mfma_f32_16x16x32_bf16 v[76:79], v[228:231], v[164:167], v[76:79]
  s_waitcnt lgkmcnt(7)
  ds_read_b64_tr_b16 v[250:251], v12 offset:1024
  buffer_load_dwordx4 v17, s[8:11], s57 offen offset:2048 nt lds
  v_mfma_f32_16x16x32_bf16 v[80:83], v[232:235], v[160:163], v[80:83]
  ds_read_b64_tr_b16 v[252:253], v13 offset:0
  v_mfma_f32_16x16x32_bf16 v[84:87], v[232:235], v[164:167], v[84:87]
  s_waitcnt lgkmcnt(7)
  ds_read_b64_tr_b16 v[254:255], v13 offset:1024
  buffer_load_dwordx4 v17, s[8:11], s57 offen offset:3072 nt lds
  s_add_u32 s57, s57, 16384
  s_waitcnt vmcnt(8)
  s_barrier
  s_add_u32 s58, s41, 2
  s_and_b32 s58, s58, 3
  s_lshl_b32 s58, s58, 20
  s_add_u32 s58, s58, s42
  s_add_u32 s58, s58, 1024
  s_add_u32 m0, s60, 49152
  s_mov_b32 s68, s58
  buffer_load_dwordx4 v18, s[16:19], s68 offen offset:0 lds
  s_mov_b32 s72, 0x4000
  v_mfma_f32_16x16x32_bf16 v[88:91], v[236:239], v[160:163], v[88:91]
  ds_read_b64_tr_b16 v[224:225], v6 offset:8192
  v_mfma_f32_16x16x32_bf16 v[92:95], v[236:239], v[164:167], v[92:95]
  s_waitcnt lgkmcnt(7)
  ds_read_b64_tr_b16 v[226:227], v6 offset:9216
  s_add_u32 m0, s60, 49152
  s_add_u32 s68, s58, 31744
  buffer_load_dwordx4 v18, s[16:19], s68 offen offset:1024 lds
  v_mfma_f32_16x16x32_bf16 v[96:99], v[240:243], v[160:163], v[96:99]
  ds_read_b64_tr_b16 v[228:229], v7 offset:8192
  v_add_u32 v6, s72, v6
  v_mfma_f32_16x16x32_bf16 v[100:103], v[240:243], v[164:167], v[100:103]
  s_waitcnt lgkmcnt(7)
  ds_read_b64_tr_b16 v[230:231], v7 offset:9216
  s_add_u32 m0, s60, 32768
  s_nop 0
  buffer_load_dwordx4 v14, s[4:7], s56 offen offset:0 nt lds
  v_mfma_f32_16x16x32_bf16 v[104:107], v[244:247], v[160:163], v[104:107]
  ds_read_b64_tr_b16 v[232:233], v8 offset:8192
  v_add_u32 v7, s72, v7
  v_mfma_f32_16x16x32_bf16 v[108:111], v[244:247], v[164:167], v[108:111]
  s_waitcnt lgkmcnt(7)
  ds_read_b64_tr_b16 v[234:235], v8 offset:9216
  buffer_load_dwordx4 v14, s[4:7], s56 offen offset:1024 nt lds
  v_mfma_f32_16x16x32_bf16 v[112:115], v[248:251], v[160:163], v[112:115]
  ds_read_b64_tr_b16 v[236:237], v9 offset:8192
  v_add_u32 v8, s72, v8
  v_mfma_f32_16x16x32_bf16 v[116:119], v[248:251], v[164:167], v[116:119]
  s_waitcnt lgkmcnt(7)
  ds_read_b64_tr_b16 v[238:239], v9 offset:9216
  buffer_load_dwordx4 v15, s[4:7], s56 offen offset:2048 nt lds
  v_mfma_f32_16x16x32_bf16 v[120:123], v[252:255], v[160:163], v[120:123]
  ds_read_b64_tr_b16 v[240:241], v10 offset:8192
  v_add_u32 v9, s72, v9
  v_mfma_f32_16x16x32_bf16 v[124:127], v[252:255], v[164:167], v[124:127]
  s_waitcnt lgkmcnt(7)
  ds_read_b64_tr_b16 v[242:243], v10 offset:9216
  buffer_load_dwordx4 v15, s[4:7], s56 offen offset:3072 nt lds
  s_add_u32 s56, s56, 16384
  v_mfma_f32_16x16x32_bf16 v[64:67], v[224:227], v[168:171], v[64:67]
  ds_read_b64_tr_b16 v[244:245], v11 offset:8192
  v_add_u32 v10, s72, v10
  v_mfma_f32_16x16x32_bf16 v[68:71], v[224:227], v[172:175], v[68:71]
  s_waitcnt lgkmcnt(7)
  ds_read_b64_tr_b16 v[246:247], v11 offset:9216
  s_add_u32 m0, s60, 81920
  s_nop 0
  buffer_load_dwordx4 v16, s[8:11], s57 offen offset:0 nt lds
  v_mfma_f32_16x16x32_bf16 v[72:75], v[228:231], v[168:171], v[72:75]
  ds_read_b64_tr_b16 v[248:249], v12 offset:8192
  v_add_u32 v11, s72, v11
  v_mfma_f32_16x16x32_bf16 v[76:79], v[228:231], v[172:175], v[76:79]
  s_waitcnt lgkmcnt(7)
  ds_read_b64_tr_b16 v[250:251], v12 offset:9216
  buffer_load_dwordx4 v16, s[8:11], s57 offen offset:1024 nt lds
  v_mfma_f32_16x16x32_bf16 v[80:83], v[232:235], v[168:171], v[80:83]
  ds_read_b64_tr_b16 v[252:253], v13 offset:8192
  v_add_u32 v12, s72, v12
  v_mfma_f32_16x16x32_bf16 v[84:87], v[232:235], v[172:175], v[84:87]
  s_waitcnt lgkmcnt(7)
  ds_read_b64_tr_b16 v[254:255], v13 offset:9216
  v_add_u32 v13, s72, v13
  buffer_load_dwordx4 v17, s[8:11], s57 offen offset:2048 nt lds
  v_mfma_f32_16x16x32_bf16 v[88:91], v[236:239], v[168:171], v[88:91]
  ds_read_b64_tr_b16 v[224:225], v6 offset:0
  v_mfma_f32_16x16x32_bf16 v[92:95], v[236:239], v[172:175], v[92:95]
  s_waitcnt lgkmcnt(7)
  ds_read_b64_tr_b16 v[226:227], v6 offset:1024
  buffer_load_dwordx4 v17, s[8:11], s57 offen offset:3072 nt lds
  s_add_u32 s57, s57, 16384
  v_mfma_f32_16x16x32_bf16 v[96:99], v[240:243], v[168:171], v[96:99]
  ds_read_b64_tr_b16 v[228:229], v7 offset:0
  v_mfma_f32_16x16x32_bf16 v[100:103], v[240:243], v[172:175], v[100:103]
  s_waitcnt lgkmcnt(7)
  ds_read_b64_tr_b16 v[230:231], v7 offset:1024
  s_waitcnt vmcnt(10)
  s_barrier
  s_add_u32 m0, s60, 49152
  s_add_u32 s68, s58, 63488
  buffer_load_dwordx4 v19, s[16:19], s68 offen offset:2048 lds
  v_mfma_f32_16x16x32_bf16 v[104:107], v[244:247], v[168:171], v[104:107]
  ds_read_b64_tr_b16 v[232:233], v8 offset:0
  v_mfma_f32_16x16x32_bf16 v[108:111], v[244:247], v[172:175], v[108:111]
  s_waitcnt lgkmcnt(7)
  ds_read_b64_tr_b16 v[234:235], v8 offset:1024
  s_add_u32 m0, s60, 49152
  s_add_u32 s68, s58, 95232
  buffer_load_dwordx4 v19, s[16:19], s68 offen offset:3072 lds
  v_mfma_f32_16x16x32_bf16 v[112:115], v[248:251], v[168:171], v[112:115]
  ds_read_b64_tr_b16 v[236:237], v9 offset:0
  v_mfma_f32_16x16x32_bf16 v[116:119], v[248:251], v[172:175], v[116:119]
  s_waitcnt lgkmcnt(7)
  ds_read_b64_tr_b16 v[238:239], v9 offset:1024
  s_add_u32 m0, s60, 0
  s_nop 0
  buffer_load_dwordx4 v14, s[4:7], s56 offen offset:0 nt lds
  v_mfma_f32_16x16x32_bf16 v[120:123], v[252:255], v[168:171], v[120:123]
  ds_read_b64_tr_b16 v[240:241], v10 offset:0
  v_mfma_f32_16x16x32_bf16 v[124:127], v[252:255], v[172:175], v[124:127]
  s_waitcnt lgkmcnt(7)
  ds_read_b64_tr_b16 v[242:243], v10 offset:1024
  buffer_load_dwordx4 v14, s[4:7], s56 offen offset:1024 nt lds
  v_mfma_f32_16x16x32_bf16 v[64:67], v[224:227], v[176:179], v[64:67]
  ds_read_b64_tr_b16 v[244:245], v11 offset:0
  v_mfma_f32_16x16x32_bf16 v[68:71], v[224:227], v[180:183], v[68:71]
  s_waitcnt lgkmcnt(7)
  ds_read_b64_tr_b16 v[246:247], v11 offset:1024
  buffer_load_dwordx4 v15, s[4:7], s56 offen offset:2048 nt lds
  v_mfma_f32_16x16x32_bf16 v[72:75], v[228:231], v[176:179], v[72:75]
  ds_read_b64_tr_b16 v[248:249], v12 offset:0
  v_mfma_f32_16x16x32_bf16 v[76:79], v[228:231], v[180:183], v[76:79]
  s_waitcnt lgkmcnt(7)
  ds_read_b64_tr_b16 v[250:251], v12 offset:1024
  buffer_load_dwordx4 v15, s[4:7], s56 offen offset:3072 nt lds
  s_add_u32 s56, s56, 16384
  v_mfma_f32_16x16x32_bf16 v[80:83], v[232:235], v[176:179], v[80:83]
  ds_read_b64_tr_b16 v[252:253], v13 offset:0
  v_mfma_f32_16x16x32_bf16 v[84:87], v[232:235], v[180:183], v[84:87]
  s_waitcnt lgkmcnt(7)
  ds_read_b64_tr_b16 v[254:255], v13 offset:1024
  s_add_u32 m0, s60, 98304
  s_nop 0
  buffer_load_dwordx4 v16, s[8:11], s57 offen offset:0 nt lds
  s_mov_b32 s72, 0xfffe8000
  v_mfma_f32_16x16x32_bf16 v[88:91], v[236:239], v[176:179], v[88:91]
  ds_read_b64_tr_b16 v[224:225], v6 offset:8192
  v_mfma_f32_16x16x32_bf16 v[92:95], v[236:239], v[180:183], v[92:95]
  s_waitcnt lgkmcnt(7)
  ds_read_b64_tr_b16 v[226:227], v6 offset:9216
  buffer_load_dwordx4 v16, s[8:11], s57 offen offset:1024 nt lds
  v_mfma_f32_16x16x32_bf16 v[96:99], v[240:243], v[176:179], v[96:99]
  ds_read_b64_tr_b16 v[228:229], v7 offset:8192
  v_add_u32 v6, s72, v6
  v_mfma_f32_16x16x32_bf16 v[100:103], v[240:243], v[180:183], v[100:103]
  s_waitcnt lgkmcnt(7)
  ds_read_b64_tr_b16 v[230:231], v7 offset:9216
  buffer_load_dwordx4 v17, s[8:11], s57 offen offset:2048 nt lds
  v_mfma_f32_16x16x32_bf16 v[104:107], v[244:247], v[176:179], v[104:107]
  ds_read_b64_tr_b16 v[232:233], v8 offset:8192
  v_add_u32 v7, s72, v7
  v_mfma_f32_16x16x32_bf16 v[108:111], v[244:247], v[180:183], v[108:111]
  s_waitcnt lgkmcnt(7)
  ds_read_b64_tr_b16 v[234:235], v8 offset:9216
  buffer_load_dwordx4 v17, s[8:11], s57 offen offset:3072 nt lds
  s_add_u32 s57, s57, 16384
  v_mfma_f32_16x16x32_bf16 v[112:115], v[248:251], v[176:179], v[112:115]
  ds_read_b64_tr_b16 v[236:237], v9 offset:8192
  v_add_u32 v8, s72, v8
  v_mfma_f32_16x16x32_bf16 v[116:119], v[248:251], v[180:183], v[116:119]
  s_waitcnt lgkmcnt(7)
  ds_read_b64_tr_b16 v[238:239], v9 offset:9216
  s_waitcnt vmcnt(8)
  s_barrier
  s_add_u32 s58, s41, 2
  s_and_b32 s58, s58, 3
  s_lshl_b32 s58, s58, 20
  s_add_u32 s58, s58, s42
  s_add_u32 s58, s58, 525312
  s_add_u32 m0, s60, 114688
  s_mov_b32 s68, s58
  buffer_load_dwordx4 v18, s[16:19], s68 offen offset:0 lds
  v_mfma_f32_16x16x32_bf16 v[120:123], v[252:255], v[176:179], v[120:123]
  ds_read_b64_tr_b16 v[240:241], v10 offset:8192
  v_add_u32 v9, s72, v9
  v_mfma_f32_16x16x32_bf16 v[124:127], v[252:255], v[180:183], v[124:127]
  s_waitcnt lgkmcnt(7)
  ds_read_b64_tr_b16 v[242:243], v10 offset:9216
  s_add_u32 m0, s60, 114688
  s_add_u32 s68, s58, 31744
  buffer_load_dwordx4 v18, s[16:19], s68 offen offset:1024 lds
  v_mfma_f32_16x16x32_bf16 v[64:67], v[224:227], v[184:187], v[64:67]
  ds_read_b64_tr_b16 v[244:245], v11 offset:8192
  v_add_u32 v10, s72, v10
  v_mfma_f32_16x16x32_bf16 v[68:71], v[224:227], v[188:191], v[68:71]
  s_waitcnt lgkmcnt(7)
  ds_read_b64_tr_b16 v[246:247], v11 offset:9216
  s_add_u32 m0, s60, 16384
  s_nop 0
  buffer_load_dwordx4 v14, s[4:7], s56 offen offset:0 nt lds
  v_mfma_f32_16x16x32_bf16 v[72:75], v[228:231], v[184:187], v[72:75]
  ds_read_b64_tr_b16 v[248:249], v12 offset:8192
  v_add_u32 v11, s72, v11
  v_mfma_f32_16x16x32_bf16 v[76:79], v[228:231], v[188:191], v[76:79]
  s_waitcnt lgkmcnt(7)
  ds_read_b64_tr_b16 v[250:251], v12 offset:9216
  buffer_load_dwordx4 v14, s[4:7], s56 offen offset:1024 nt lds
  v_mfma_f32_16x16x32_bf16 v[80:83], v[232:235], v[184:187], v[80:83]
  ds_read_b64_tr_b16 v[252:253], v13 offset:8192
  v_add_u32 v12, s72, v12
  v_mfma_f32_16x16x32_bf16 v[84:87], v[232:235], v[188:191], v[84:87]
  s_waitcnt lgkmcnt(7)
  ds_read_b64_tr_b16 v[254:255], v13 offset:9216
  v_add_u32 v13, s72, v13
  buffer_load_dwordx4 v15, s[4:7], s56 offen offset:2048 nt lds
  v_mfma_f32_16x16x32_bf16 v[88:91], v[236:239], v[184:187], v[88:91]
  ds_read_b64_tr_b16 v[224:225], v6 offset:0
  v_mfma_f32_16x16x32_bf16 v[92:95], v[236:239], v[188:191], v[92:95]
  s_waitcnt lgkmcnt(7)
  ds_read_b64_tr_b16 v[226:227], v6 offset:1024
  buffer_load_dwordx4 v15, s[4:7], s56 offen offset:3072 nt lds
  s_add_u32 s56, s56, 16384
  v_mfma_f32_16x16x32_bf16 v[96:99], v[240:243], v[184:187], v[96:99]
  ds_read_b64_tr_b16 v[228:229], v7 offset:0
  v_mfma_f32_16x16x32_bf16 v[100:103], v[240:243], v[188:191], v[100:103]
  s_waitcnt lgkmcnt(7)
  ds_read_b64_tr_b16 v[230:231], v7 offset:1024
  s_add_u32 m0, s60, 65536
  s_nop 0
  buffer_load_dwordx4 v16, s[8:11], s57 offen offset:0 nt lds
  v_mfma_f32_16x16x32_bf16 v[104:107], v[244:247], v[184:187], v[104:107]
  ds_read_b64_tr_b16 v[232:233], v8 offset:0
  v_mfma_f32_16x16x32_bf16 v[108:111], v[244:247], v[188:191], v[108:111]
  s_waitcnt lgkmcnt(7)
  ds_read_b64_tr_b16 v[234:235], v8 offset:1024
  buffer_load_dwordx4 v16, s[8:11], s57 offen offset:1024 nt lds
  v_mfma_f32_16x16x32_bf16 v[112:115], v[248:251], v[184:187], v[112:115]
  ds_read_b64_tr_b16 v[236:237], v9 offset:0
  v_mfma_f32_16x16x32_bf16 v[116:119], v[248:251], v[188:191], v[116:119]
  s_waitcnt lgkmcnt(7)
  ds_read_b64_tr_b16 v[238:239], v9 offset:1024
  buffer_load_dwordx4 v17, s[8:11], s57 offen offset:2048 nt lds
  v_mfma_f32_16x16x32_bf16 v[120:123], v[252:255], v[184:187], v[120:123]
  ds_read_b64_tr_b16 v[240:241], v10 offset:0
  v_mfma_f32_16x16x32_bf16 v[124:127], v[252:255], v[188:191], v[124:127]
  s_waitcnt lgkmcnt(7)
  ds_read_b64_tr_b16 v[242:243], v10 offset:1024
  buffer_load_dwordx4 v17, s[8:11], s57 offen offset:3072 nt lds
  s_add_u32 s57, s57, 16384
  v_mfma_f32_16x16x32_bf16 v[64:67], v[224:227], v[192:195], v[64:67]
  ds_read_b64_tr_b16 v[244:245], v11 offset:0
  v_mfma_f32_16x16x32_bf16 v[68:71], v[224:227], v[196:199], v[68:71]
  s_waitcnt lgkmcnt(7)
  ds_read_b64_tr_b16 v[246:247], v11 offset:1024
  s_waitcnt vmcnt(10)
  s_barrier
  s_add_u32 m0, s60, 114688
  s_add_u32 s68, s58, 63488
  buffer_load_dwordx4 v19, s[16:19], s68 offen offset:2048 lds
  v_mfma_f32_16x16x32_bf16 v[72:75], v[228:231], v[192:195], v[72:75]
  ds_read_b64_tr_b16 v[248:249], v12 offset:0
  v_mfma_f32_16x16x32_bf16 v[76:79], v[228:231], v[196:199], v[76:79]
  s_waitcnt lgkmcnt(7)
  ds_read_b64_tr_b16 v[250:251], v12 offset:1024
  s_add_u32 m0, s60, 114688
  s_add_u32 s68, s58, 95232
  buffer_load_dwordx4 v19, s[16:19], s68 offen offset:3072 lds
  v_mfma_f32_16x16x32_bf16 v[80:83], v[232:235], v[192:195], v[80:83]
  ds_read_b64_tr_b16 v[252:253], v13 offset:0
  v_mfma_f32_16x16x32_bf16 v[84:87], v[232:235], v[196:199], v[84:87]
  s_waitcnt lgkmcnt(7)
  ds_read_b64_tr_b16 v[254:255], v13 offset:1024
  s_add_u32 m0, s60, 32768
  s_nop 0
  buffer_load_dwordx4 v14, s[4:7], s56 offen offset:0 nt lds
  s_mov_b32 s72, 0x10000
  v_mfma_f32_16x16x32_bf16 v[88:91], v[236:239], v[192:195], v[88:91]
  ds_read_b64_tr_b16 v[224:225], v6 offset:8192
  v_mfma_f32_16x16x32_bf16 v[92:95], v[236:239], v[196:199], v[92:95]
  s_waitcnt lgkmcnt(7)
  ds_read_b64_tr_b16 v[226:227], v6 offset:9216
  buffer_load_dwordx4 v14, s[4:7], s56 offen offset:1024 nt lds
  v_mfma_f32_16x16x32_bf16 v[96:99], v[240:243], v[192:195], v[96:99]
  ds_read_b64_tr_b16 v[228:229], v7 offset:8192
  v_add_u32 v6, s72, v6
  v_mfma_f32_16x16x32_bf16 v[100:103], v[240:243], v[196:199], v[100:103]
  s_waitcnt lgkmcnt(7)
  ds_read_b64_tr_b16 v[230:231], v7 offset:9216
  buffer_load_dwordx4 v15, s[4:7], s56 offen offset:2048 nt lds
  v_mfma_f32_16x16x32_bf16 v[104:107], v[244:247], v[192:195], v[104:107]
  ds_read_b64_tr_b16 v[232:233], v8 offset:8192
  v_add_u32 v7, s72, v7
  v_mfma_f32_16x16x32_bf16 v[108:111], v[244:247], v[196:199], v[108:111]
  s_waitcnt lgkmcnt(7)
  ds_read_b64_tr_b16 v[234:235], v8 offset:9216
  buffer_load_dwordx4 v15, s[4:7], s56 offen offset:3072 nt lds
  s_add_u32 s56, s56, 16384
  v_mfma_f32_16x16x32_bf16 v[112:115], v[248:251], v[192:195], v[112:115]
  ds_read_b64_tr_b16 v[236:237], v9 offset:8192
  v_add_u32 v8, s72, v8
  v_mfma_f32_16x16x32_bf16 v[116:119], v[248:251], v[196:199], v[116:119]
  s_waitcnt lgkmcnt(7)
  ds_read_b64_tr_b16 v[238:239], v9 offset:9216
  s_add_u32 m0, s60, 81920
  s_nop 0
  buffer_load_dwordx4 v16, s[8:11], s57 offen offset:0 nt lds
  v_mfma_f32_16x16x32_bf16 v[120:123], v[252:255], v[192:195], v[120:123]
  ds_read_b64_tr_b16 v[240:241], v10 offset:8192
  v_add_u32 v9, s72, v9
  v_mfma_f32_16x16x32_bf16 v[124:127], v[252:255], v[196:199], v[124:127]
  s_waitcnt lgkmcnt(7)
  ds_read_b64_tr_b16 v[242:243], v10 offset:9216
  buffer_load_dwordx4 v16, s[8:11], s57 offen offset:1024 nt lds
  v_mfma_f32_16x16x32_bf16 v[64:67], v[224:227], v[200:203], v[64:67]
  ds_read_b64_tr_b16 v[244:245], v11 offset:8192
  v_add_u32 v10, s72, v10
  v_mfma_f32_16x16x32_bf16 v[68:71], v[224:227], v[204:207], v[68:71]
  s_waitcnt lgkmcnt(7)
  ds_read_b64_tr_b16 v[246:247], v11 offset:9216
  buffer_load_dwordx4 v17, s[8:11], s57 offen offset:2048 nt lds
  v_mfma_f32_16x16x32_bf16 v[72:75], v[228:231], v[200:203], v[72:75]
  ds_read_b64_tr_b16 v[248:249], v12 offset:8192
  v_add_u32 v11, s72, v11
  v_mfma_f32_16x16x32_bf16 v[76:79], v[228:231], v[204:207], v[76:79]
  s_waitcnt lgkmcnt(7)
  ds_read_b64_tr_b16 v[250:251], v12 offset:9216
  buffer_load_dwordx4 v17, s[8:11], s57 offen offset:3072 nt lds
  s_add_u32 s57, s57, 16384
  v_mfma_f32_16x16x32_bf16 v[80:83], v[232:235], v[200:203], v[80:83]
  ds_read_b64_tr_b16 v[252:253], v13 offset:8192
  v_add_u32 v12, s72, v12
  v_mfma_f32_16x16x32_bf16 v[84:87], v[232:235], v[204:207], v[84:87]
  s_waitcnt lgkmcnt(7)
  ds_read_b64_tr_b16 v[254:255], v13 offset:9216
  v_add_u32 v13, s72, v13
  s_waitcnt vmcnt(8)
  s_barrier
  s_add_u32 s58, s41, 3
  s_and_b32 s58, s58, 3
  s_lshl_b32 s58, s58, 20
  s_add_u32 s58, s58, s42
  s_add_u32 s58, s58, 1024
  s_add_u32 m0, s60, 131072
  s_mov_b32 s68, s58
  buffer_load_dwordx4 v18, s[16:19], s68 offen offset:0 lds
  v_mfma_f32_16x16x32_bf16 v[88:91], v[236:239], v[200:203], v[88:91]
  ds_read_b64_tr_b16 v[224:225], v6 offset:0
  v_mfma_f32_16x16x32_bf16 v[92:95], v[236:239], v[204:207], v[92:95]
  s_waitcnt lgkmcnt(7)
  ds_read_b64_tr_b16 v[226:227], v6 offset:1024
  s_add_u32 m0, s60, 131072
  s_add_u32 s68, s58, 31744
  buffer_load_dwordx4 v18, s[16:19], s68 offen offset:1024 lds
  v_mfma_f32_16x16x32_bf16 v[96:99], v[240:243], v[200:203], v[96:99]
  ds_read_b64_tr_b16 v[228:229], v7 offset:0
  v_mfma_f32_16x16x32_bf16 v[100:103], v[240:243], v[204:207], v[100:103]
  s_waitcnt lgkmcnt(7)
  ds_read_b64_tr_b16 v[230:231], v7 offset:1024
  s_add_u32 m0, s60, 131072
  s_add_u32 s68, s58, 63488
  buffer_load_dwordx4 v19, s[16:19], s68 offen offset:2048 lds
  v_mfma_f32_16x16x32_bf16 v[104:107], v[244:247], v[200:203], v[104:107]
  ds_read_b64_tr_b16 v[232:233], v8 offset:0
  v_mfma_f32_16x16x32_bf16 v[108:111], v[244:247], v[204:207], v[108:111]
  s_waitcnt lgkmcnt(7)
  ds_read_b64_tr_b16 v[234:235], v8 offset:1024
  s_add_u32 m0, s60, 131072
  s_add_u32 s68, s58, 95232
  buffer_load_dwordx4 v19, s[16:19], s68 offen offset:3072 lds
  v_mfma_f32_16x16x32_bf16 v[112:115], v[248:251], v[200:203], v[112:115]
  ds_read_b64_tr_b16 v[236:237], v9 offset:0
  v_mfma_f32_16x16x32_bf16 v[116:119], v[248:251], v[204:207], v[116:119]
  s_waitcnt lgkmcnt(7)
  ds_read_b64_tr_b16 v[238:239], v9 offset:1024
  s_add_u32 m0, s60, 0
  s_nop 0
  buffer_load_dwordx4 v14, s[4:7], s56 offen offset:0 nt lds
  v_mfma_f32_16x16x32_bf16 v[120:123], v[252:255], v[200:203], v[120:123]
  ds_read_b64_tr_b16 v[240:241], v10 offset:0
  v_mfma_f32_16x16x32_bf16 v[124:127], v[252:255], v[204:207], v[124:127]
  s_waitcnt lgkmcnt(7)
  ds_read_b64_tr_b16 v[242:243], v10 offset:1024
  buffer_load_dwordx4 v14, s[4:7], s56 offen offset:1024 nt lds
  buffer_load_dwordx4 v15, s[4:7], s56 offen offset:2048 nt lds
  v_mfma_f32_16x16x32_bf16 v[64:67], v[224:227], v[208:211], v[64:67]
  ds_read_b64_tr_b16 v[244:245], v11 offset:0
  v_mfma_f32_16x16x32_bf16 v[68:71], v[224:227], v[212:215], v[68:71]
  s_waitcnt lgkmcnt(7)
  ds_read_b64_tr_b16 v[246:247], v11 offset:1024
  buffer_load_dwordx4 v15, s[4:7], s56 offen offset:3072 nt lds
  s_add_u32 s56, s56, 16384
  v_mfma_f32_16x16x32_bf16 v[72:75], v[228:231], v[208:211], v[72:75]
  ds_read_b64_tr_b16 v[248:249], v12 offset:0
  v_mfma_f32_16x16x32_bf16 v[76:79], v[228:231], v[212:215], v[76:79]
  s_waitcnt lgkmcnt(7)
  ds_read_b64_tr_b16 v[250:251], v12 offset:1024
  s_add_u32 m0, s60, 98304
  s_nop 0
  buffer_load_dwordx4 v16, s[8:11], s57 offen offset:0 nt lds
  v_mfma_f32_16x16x32_bf16 v[80:83], v[232:235], v[208:211], v[80:83]
  ds_read_b64_tr_b16 v[252:253], v13 offset:0
  v_mfma_f32_16x16x32_bf16 v[84:87], v[232:235], v[212:215], v[84:87]
  s_waitcnt lgkmcnt(7)
  ds_read_b64_tr_b16 v[254:255], v13 offset:1024
  buffer_load_dwordx4 v16, s[8:11], s57 offen offset:1024 nt lds
  s_mov_b32 s72, 0x4000
  v_mfma_f32_16x16x32_bf16 v[88:91], v[236:239], v[208:211], v[88:91]
  ds_read_b64_tr_b16 v[224:225], v6 offset:8192
  v_mfma_f32_16x16x32_bf16 v[92:95], v[236:239], v[212:215], v[92:95]
  s_waitcnt lgkmcnt(7)
  ds_read_b64_tr_b16 v[226:227], v6 offset:9216
  buffer_load_dwordx4 v17, s[8:11], s57 offen offset:2048 nt lds
  v_mfma_f32_16x16x32_bf16 v[96:99], v[240:243], v[208:211], v[96:99]
  ds_read_b64_tr_b16 v[228:229], v7 offset:8192
  v_add_u32 v6, s72, v6
  v_mfma_f32_16x16x32_bf16 v[100:103], v[240:243], v[212:215], v[100:103]
  s_waitcnt lgkmcnt(7)
  ds_read_b64_tr_b16 v[230:231], v7 offset:9216
  buffer_load_dwordx4 v17, s[8:11], s57 offen offset:3072 nt lds
  s_add_u32 s57, s57, 16384
  s_waitcnt vmcnt(8)
  s_barrier
  s_add_u32 s58, s41, 3
  s_and_b32 s58, s58, 3
  s_lshl_b32 s58, s58, 20
  s_add_u32 s58, s58, s42
  s_add_u32 s58, s58, 525312
  s_add_u32 m0, s60, 147456
  s_mov_b32 s68, s58
  buffer_load_dwordx4 v18, s[16:19], s68 offen offset:0 lds
  v_mfma_f32_16x16x32_bf16 v[104:107], v[244:247], v[208:211], v[104:107]
  ds_read_b64_tr_b16 v[232:233], v8 offset:8192
  v_add_u32 v7, s72, v7
  v_mfma_f32_16x16x32_bf16 v[108:111], v[244:247], v[212:215], v[108:111]
  s_waitcnt lgkmcnt(7)
  ds_read_b64_tr_b16 v[234:235], v8 offset:9216
  s_add_u32 m0, s60, 147456
  s_add_u32 s68, s58, 31744
  buffer_load_dwordx4 v18, s[16:19], s68 offen offset:1024 lds
  v_mfma_f32_16x16x32_bf16 v[112:115], v[248:251], v[208:211], v[112:115]
  ds_read_b64_tr_b16 v[236:237], v9 offset:8192
  v_add_u32 v8, s72, v8
  v_mfma_f32_16x16x32_bf16 v[116:119], v[248:251], v[212:215], v[116:119]
  s_waitcnt lgkmcnt(7)
  ds_read_b64_tr_b16 v[238:239], v9 offset:9216
  s_add_u32 m0, s60, 16384
  s_nop 0
  buffer_load_dwordx4 v14, s[4:7], s56 offen offset:0 nt lds
  v_mfma_f32_16x16x32_bf16 v[120:123], v[252:255], v[208:211], v[120:123]
  ds_read_b64_tr_b16 v[240:241], v10 offset:8192
  v_add_u32 v9, s72, v9
  v_mfma_f32_16x16x32_bf16 v[124:127], v[252:255], v[212:215], v[124:127]
  s_waitcnt lgkmcnt(7)
  ds_read_b64_tr_b16 v[242:243], v10 offset:9216
  buffer_load_dwordx4 v14, s[4:7], s56 offen offset:1024 nt lds
  v_mfma_f32_16x16x32_bf16 v[64:67], v[224:227], v[216:219], v[64:67]
  ds_read_b64_tr_b16 v[244:245], v11 offset:8192
  v_add_u32 v10, s72, v10
  v_mfma_f32_16x16x32_bf16 v[68:71], v[224:227], v[220:223], v[68:71]
  s_waitcnt lgkmcnt(7)
  ds_read_b64_tr_b16 v[246:247], v11 offset:9216
  buffer_load_dwordx4 v15, s[4:7], s56 offen offset:2048 nt lds
  v_mfma_f32_16x16x32_bf16 v[72:75], v[228:231], v[216:219], v[72:75]
  ds_read_b64_tr_b16 v[248:249], v12 offset:8192
  v_add_u32 v11, s72, v11
  v_mfma_f32_16x16x32_bf16 v[76:79], v[228:231], v[220:223], v[76:79]
  s_waitcnt lgkmcnt(7)
  ds_read_b64_tr_b16 v[250:251], v12 offset:9216
  buffer_load_dwordx4 v15, s[4:7], s56 offen offset:3072 nt lds
  s_add_u32 s56, s56, 16384
  v_mfma_f32_16x16x32_bf16 v[80:83], v[232:235], v[216:219], v[80:83]
  ds_read_b64_tr_b16 v[252:253], v13 offset:8192
  v_add_u32 v12, s72, v12
  v_mfma_f32_16x16x32_bf16 v[84:87], v[232:235], v[220:223], v[84:87]
  s_waitcnt lgkmcnt(7)
  ds_read_b64_tr_b16 v[254:255], v13 offset:9216
  v_add_u32 v13, s72, v13
  s_add_u32 m0, s60, 65536
  s_nop 0
  buffer_load_dwordx4 v16, s[8:11], s57 offen offset:0 nt lds
  v_mfma_f32_16x16x32_bf16 v[88:91], v[236:239], v[216:219], v[88:91]
  ds_read_b64_tr_b16 v[224:225], v6 offset:0
  v_mfma_f32_16x16x32_bf16 v[92:95], v[236:239], v[220:223], v[92:95]
  s_waitcnt lgkmcnt(7)
  ds_read_b64_tr_b16 v[226:227], v6 offset:1024
  buffer_load_dwordx4 v16, s[8:11], s57 offen offset:1024 nt lds
  v_mfma_f32_16x16x32_bf16 v[96:99], v[240:243], v[216:219], v[96:99]
  ds_read_b64_tr_b16 v[228:229], v7 offset:0
  v_mfma_f32_16x16x32_bf16 v[100:103], v[240:243], v[220:223], v[100:103]
  s_waitcnt lgkmcnt(7)
  ds_read_b64_tr_b16 v[230:231], v7 offset:1024
  buffer_load_dwordx4 v17, s[8:11], s57 offen offset:2048 nt lds
  v_mfma_f32_16x16x32_bf16 v[104:107], v[244:247], v[216:219], v[104:107]
  ds_read_b64_tr_b16 v[232:233], v8 offset:0
  v_mfma_f32_16x16x32_bf16 v[108:111], v[244:247], v[220:223], v[108:111]
  s_waitcnt lgkmcnt(7)
  ds_read_b64_tr_b16 v[234:235], v8 offset:1024
  buffer_load_dwordx4 v17, s[8:11], s57 offen offset:3072 nt lds
  s_add_u32 s57, s57, 16384
  v_mfma_f32_16x16x32_bf16 v[112:115], v[248:251], v[216:219], v[112:115]
  ds_read_b64_tr_b16 v[236:237], v9 offset:0
  v_mfma_f32_16x16x32_bf16 v[116:119], v[248:251], v[220:223], v[116:119]
  s_waitcnt lgkmcnt(7)
  ds_read_b64_tr_b16 v[238:239], v9 offset:1024
  s_waitcnt vmcnt(10)
  s_barrier
  s_add_u32 m0, s60, 147456
  s_add_u32 s68, s58, 63488
  buffer_load_dwordx4 v19, s[16:19], s68 offen offset:2048 lds
  v_mfma_f32_16x16x32_bf16 v[120:123], v[252:255], v[216:219], v[120:123]
  ds_read_b64_tr_b16 v[240:241], v10 offset:0
  v_mfma_f32_16x16x32_bf16 v[124:127], v[252:255], v[220:223], v[124:127]
  s_waitcnt lgkmcnt(7)
  ds_read_b64_tr_b16 v[242:243], v10 offset:1024
  s_add_u32 m0, s60, 147456
  s_add_u32 s68, s58, 95232
  buffer_load_dwordx4 v19, s[16:19], s68 offen offset:3072 lds
  v_mfma_f32_16x16x32_bf16 v[64:67], v[224:227], v[32:35], v[64:67]
  ds_read_b64_tr_b16 v[244:245], v11 offset:0
  v_mfma_f32_16x16x32_bf16 v[68:71], v[224:227], v[36:39], v[68:71]
  s_waitcnt lgkmcnt(7)
  ds_read_b64_tr_b16 v[246:247], v11 offset:1024
  s_add_u32 m0, s60, 32768
  s_nop 0
  buffer_load_dwordx4 v14, s[4:7], s56 offen offset:0 nt lds
  v_mfma_f32_16x16x32_bf16 v[72:75], v[228:231], v[32:35], v[72:75]
  ds_read_b64_tr_b16 v[248:249], v12 offset:0
  v_mfma_f32_16x16x32_bf16 v[76:79], v[228:231], v[36:39], v[76:79]
  s_waitcnt lgkmcnt(7)
  ds_read_b64_tr_b16 v[250:251], v12 offset:1024
  buffer_load_dwordx4 v14, s[4:7], s56 offen offset:1024 nt lds
  v_mfma_f32_16x16x32_bf16 v[80:83], v[232:235], v[32:35], v[80:83]
  ds_read_b64_tr_b16 v[252:253], v13 offset:0
  v_mfma_f32_16x16x32_bf16 v[84:87], v[232:235], v[36:39], v[84:87]
  s_waitcnt lgkmcnt(7)
  ds_read_b64_tr_b16 v[254:255], v13 offset:1024
  buffer_load_dwordx4 v15, s[4:7], s56 offen offset:2048 nt lds
  s_mov_b32 s72, 0x4000
  v_mfma_f32_16x16x32_bf16 v[88:91], v[236:239], v[32:35], v[88:91]
  ds_read_b64_tr_b16 v[224:225], v6 offset:8192
  v_mfma_f32_16x16x32_bf16 v[92:95], v[236:239], v[36:39], v[92:95]
  s_waitcnt lgkmcnt(7)
  ds_read_b64_tr_b16 v[226:227], v6 offset:9216
  buffer_load_dwordx4 v15, s[4:7], s56 offen offset:3072 nt lds
  s_add_u32 s56, s56, 16384
  v_mfma_f32_16x16x32_bf16 v[96:99], v[240:243], v[32:35], v[96:99]
  ds_read_b64_tr_b16 v[228:229], v7 offset:8192
  v_add_u32 v6, s72, v6
  v_mfma_f32_16x16x32_bf16 v[100:103], v[240:243], v[36:39], v[100:103]
  s_waitcnt lgkmcnt(7)
  ds_read_b64_tr_b16 v[230:231], v7 offset:9216
  s_add_u32 m0, s60, 81920
  s_nop 0
  buffer_load_dwordx4 v16, s[8:11], s57 offen offset:0 nt lds
  v_mfma_f32_16x16x32_bf16 v[104:107], v[244:247], v[32:35], v[104:107]
  ds_read_b64_tr_b16 v[232:233], v8 offset:8192
  v_add_u32 v7, s72, v7
  v_mfma_f32_16x16x32_bf16 v[108:111], v[244:247], v[36:39], v[108:111]
  s_waitcnt lgkmcnt(7)
  ds_read_b64_tr_b16 v[234:235], v8 offset:9216
  buffer_load_dwordx4 v16, s[8:11], s57 offen offset:1024 nt lds
  v_mfma_f32_16x16x32_bf16 v[112:115], v[248:251], v[32:35], v[112:115]
  ds_read_b64_tr_b16 v[236:237], v9 offset:8192
  v_add_u32 v8, s72, v8
  v_mfma_f32_16x16x32_bf16 v[116:119], v[248:251], v[36:39], v[116:119]
  s_waitcnt lgkmcnt(7)
  ds_read_b64_tr_b16 v[238:239], v9 offset:9216
  buffer_load_dwordx4 v17, s[8:11], s57 offen offset:2048 nt lds
  v_mfma_f32_16x16x32_bf16 v[120:123], v[252:255], v[32:35], v[120:123]
  ds_read_b64_tr_b16 v[240:241], v10 offset:8192
  v_add_u32 v9, s72, v9
  v_mfma_f32_16x16x32_bf16 v[124:127], v[252:255], v[36:39], v[124:127]
  s_waitcnt lgkmcnt(7)
  ds_read_b64_tr_b16 v[242:243], v10 offset:9216
  buffer_load_dwordx4 v17, s[8:11], s57 offen offset:3072 nt lds
  s_add_u32 s57, s57, 16384
  v_mfma_f32_16x16x32_bf16 v[64:67], v[224:227], v[40:43], v[64:67]
  ds_read_b64_tr_b16 v[244:245], v11 offset:8192
  v_add_u32 v10, s72, v10
  v_mfma_f32_16x16x32_bf16 v[68:71], v[224:227], v[44:47], v[68:71]
  s_waitcnt lgkmcnt(7)
  ds_read_b64_tr_b16 v[246:247], v11 offset:9216
  s_waitcnt vmcnt(8)
  s_barrier
  s_add_u32 m0, s60, 0
  s_nop 0
  buffer_load_dwordx4 v14, s[4:7], s56 offen offset:0 nt lds
  v_mfma_f32_16x16x32_bf16 v[72:75], v[228:231], v[40:43], v[72:75]
  ds_read_b64_tr_b16 v[248:249], v12 offset:8192
  v_add_u32 v11, s72, v11
  v_mfma_f32_16x16x32_bf16 v[76:79], v[228:231], v[44:47], v[76:79]
  s_waitcnt lgkmcnt(7)
  ds_read_b64_tr_b16 v[250:251], v12 offset:9216
  v_mfma_f32_16x16x32_bf16 v[80:83], v[232:235], v[40:43], v[80:83]
  ds_read_b64_tr_b16 v[252:253], v13 offset:8192
  v_add_u32 v12, s72, v12
  v_mfma_f32_16x16x32_bf16 v[84:87], v[232:235], v[44:47], v[84:87]
  s_waitcnt lgkmcnt(7)
  ds_read_b64_tr_b16 v[254:255], v13 offset:9216
  v_add_u32 v13, s72, v13
  buffer_load_dwordx4 v14, s[4:7], s56 offen offset:1024 nt lds
  v_mfma_f32_16x16x32_bf16 v[88:91], v[236:239], v[40:43], v[88:91]
  ds_read_b64_tr_b16 v[224:225], v6 offset:0
  v_mfma_f32_16x16x32_bf16 v[92:95], v[236:239], v[44:47], v[92:95]
  s_waitcnt lgkmcnt(7)
  ds_read_b64_tr_b16 v[226:227], v6 offset:1024
  buffer_load_dwordx4 v15, s[4:7], s56 offen offset:2048 nt lds
  v_mfma_f32_16x16x32_bf16 v[96:99], v[240:243], v[40:43], v[96:99]
  ds_read_b64_tr_b16 v[228:229], v7 offset:0
  v_mfma_f32_16x16x32_bf16 v[100:103], v[240:243], v[44:47], v[100:103]
  s_waitcnt lgkmcnt(7)
  ds_read_b64_tr_b16 v[230:231], v7 offset:1024
  buffer_load_dwordx4 v15, s[4:7], s56 offen offset:3072 nt lds
  s_add_u32 s56, s56, 16384
  v_mfma_f32_16x16x32_bf16 v[104:107], v[244:247], v[40:43], v[104:107]
  ds_read_b64_tr_b16 v[232:233], v8 offset:0
  v_mfma_f32_16x16x32_bf16 v[108:111], v[244:247], v[44:47], v[108:111]
  s_waitcnt lgkmcnt(7)
  ds_read_b64_tr_b16 v[234:235], v8 offset:1024
  s_add_u32 m0, s60, 98304
  s_nop 0
  buffer_load_dwordx4 v16, s[8:11], s57 offen offset:0 nt lds
  v_mfma_f32_16x16x32_bf16 v[112:115], v[248:251], v[40:43], v[112:115]
  ds_read_b64_tr_b16 v[236:237], v9 offset:0
  v_mfma_f32_16x16x32_bf16 v[116:119], v[248:251], v[44:47], v[116:119]
  s_waitcnt lgkmcnt(7)
  ds_read_b64_tr_b16 v[238:239], v9 offset:1024
  v_mfma_f32_16x16x32_bf16 v[120:123], v[252:255], v[40:43], v[120:123]
  ds_read_b64_tr_b16 v[240:241], v10 offset:0
  v_mfma_f32_16x16x32_bf16 v[124:127], v[252:255], v[44:47], v[124:127]
  s_waitcnt lgkmcnt(7)
  ds_read_b64_tr_b16 v[242:243], v10 offset:1024
  buffer_load_dwordx4 v16, s[8:11], s57 offen offset:1024 nt lds
  v_mfma_f32_16x16x32_bf16 v[64:67], v[224:227], v[48:51], v[64:67]
  ds_read_b64_tr_b16 v[244:245], v11 offset:0
  v_mfma_f32_16x16x32_bf16 v[68:71], v[224:227], v[52:55], v[68:71]
  s_waitcnt lgkmcnt(7)
  ds_read_b64_tr_b16 v[246:247], v11 offset:1024
  buffer_load_dwordx4 v17, s[8:11], s57 offen offset:2048 nt lds
  v_mfma_f32_16x16x32_bf16 v[72:75], v[228:231], v[48:51], v[72:75]
  ds_read_b64_tr_b16 v[248:249], v12 offset:0
  v_mfma_f32_16x16x32_bf16 v[76:79], v[228:231], v[52:55], v[76:79]
  s_waitcnt lgkmcnt(7)
  ds_read_b64_tr_b16 v[250:251], v12 offset:1024
  buffer_load_dwordx4 v17, s[8:11], s57 offen offset:3072 nt lds
  s_add_u32 s57, s57, 16384
  v_mfma_f32_16x16x32_bf16 v[80:83], v[232:235], v[48:51], v[80:83]
  ds_read_b64_tr_b16 v[252:253], v13 offset:0
  v_mfma_f32_16x16x32_bf16 v[84:87], v[232:235], v[52:55], v[84:87]
  s_waitcnt lgkmcnt(7)
  ds_read_b64_tr_b16 v[254:255], v13 offset:1024
  s_waitcnt vmcnt(8)
  s_barrier
  s_mov_b32 s56, s61
  s_add_u32 m0, s60, 16384
  s_nop 0
  buffer_load_dwordx4 v14, s[4:7], s56 offen offset:0 nt lds
  s_mov_b32 s72, 0xffff0000
  v_mfma_f32_16x16x32_bf16 v[88:91], v[236:239], v[48:51], v[88:91]
  ds_read_b64_tr_b16 v[224:225], v6 offset:8192
  v_mfma_f32_16x16x32_bf16 v[92:95], v[236:239], v[52:55], v[92:95]
  s_waitcnt lgkmcnt(7)
  ds_read_b64_tr_b16 v[226:227], v6 offset:9216
  v_mfma_f32_16x16x32_bf16 v[96:99], v[240:243], v[48:51], v[96:99]
  ds_read_b64_tr_b16 v[228:229], v7 offset:8192
  v_add_u32 v6, s72, v6
  v_mfma_f32_16x16x32_bf16 v[100:103], v[240:243], v[52:55], v[100:103]
  s_waitcnt lgkmcnt(7)
  ds_read_b64_tr_b16 v[230:231], v7 offset:9216
  buffer_load_dwordx4 v14, s[4:7], s56 offen offset:1024 nt lds
  v_mfma_f32_16x16x32_bf16 v[104:107], v[244:247], v[48:51], v[104:107]
  ds_read_b64_tr_b16 v[232:233], v8 offset:8192
  v_add_u32 v7, s72, v7
  v_mfma_f32_16x16x32_bf16 v[108:111], v[244:247], v[52:55], v[108:111]
  s_waitcnt lgkmcnt(7)
  ds_read_b64_tr_b16 v[234:235], v8 offset:9216
  buffer_load_dwordx4 v15, s[4:7], s56 offen offset:2048 nt lds
  v_mfma_f32_16x16x32_bf16 v[112:115], v[248:251], v[48:51], v[112:115]
  ds_read_b64_tr_b16 v[236:237], v9 offset:8192
  v_add_u32 v8, s72, v8
  v_mfma_f32_16x16x32_bf16 v[116:119], v[248:251], v[52:55], v[116:119]
  s_waitcnt lgkmcnt(7)
  ds_read_b64_tr_b16 v[238:239], v9 offset:9216
  buffer_load_dwordx4 v15, s[4:7], s56 offen offset:3072 nt lds
  s_add_u32 s56, s56, 16384
  v_mfma_f32_16x16x32_bf16 v[120:123], v[252:255], v[48:51], v[120:123]
  ds_read_b64_tr_b16 v[240:241], v10 offset:8192
  v_add_u32 v9, s72, v9
  v_mfma_f32_16x16x32_bf16 v[124:127], v[252:255], v[52:55], v[124:127]
  s_waitcnt lgkmcnt(7)
  ds_read_b64_tr_b16 v[242:243], v10 offset:9216
  s_add_u32 m0, s60, 65536
  s_nop 0
  buffer_load_dwordx4 v16, s[8:11], s57 offen offset:0 nt lds
  v_mfma_f32_16x16x32_bf16 v[64:67], v[224:227], v[56:59], v[64:67]
  ds_read_b64_tr_b16 v[244:245], v11 offset:8192
  v_add_u32 v10, s72, v10
  v_mfma_f32_16x16x32_bf16 v[68:71], v[224:227], v[60:63], v[68:71]
  s_waitcnt lgkmcnt(7)
  ds_read_b64_tr_b16 v[246:247], v11 offset:9216
  v_mfma_f32_16x16x32_bf16 v[72:75], v[228:231], v[56:59], v[72:75]
  ds_read_b64_tr_b16 v[248:249], v12 offset:8192
  v_add_u32 v11, s72, v11
  v_mfma_f32_16x16x32_bf16 v[76:79], v[228:231], v[60:63], v[76:79]
  s_waitcnt lgkmcnt(7)
  ds_read_b64_tr_b16 v[250:251], v12 offset:9216
  buffer_load_dwordx4 v16, s[8:11], s57 offen offset:1024 nt lds
  v_mfma_f32_16x16x32_bf16 v[80:83], v[232:235], v[56:59], v[80:83]
  ds_read_b64_tr_b16 v[252:253], v13 offset:8192
  v_add_u32 v12, s72, v12
  v_mfma_f32_16x16x32_bf16 v[84:87], v[232:235], v[60:63], v[84:87]
  s_waitcnt lgkmcnt(7)
  ds_read_b64_tr_b16 v[254:255], v13 offset:9216
  v_add_u32 v13, s72, v13
  buffer_load_dwordx4 v17, s[8:11], s57 offen offset:2048 nt lds
  v_mfma_f32_16x16x32_bf16 v[88:91], v[236:239], v[56:59], v[88:91]
  v_mfma_f32_16x16x32_bf16 v[92:95], v[236:239], v[60:63], v[92:95]
  s_waitcnt lgkmcnt(6)
  buffer_load_dwordx4 v17, s[8:11], s57 offen offset:3072 nt lds
  s_add_u32 s57, s57, 16384
  v_mfma_f32_16x16x32_bf16 v[96:99], v[240:243], v[56:59], v[96:99]
  v_mfma_f32_16x16x32_bf16 v[100:103], v[240:243], v[60:63], v[100:103]
  s_waitcnt lgkmcnt(4)
  s_waitcnt vmcnt(8)
  s_barrier
  s_add_u32 m0, s60, 32768
  s_nop 0
  buffer_load_dwordx4 v14, s[4:7], s56 offen offset:0 nt lds
  buffer_load_dwordx4 v14, s[4:7], s56 offen offset:1024 nt lds
  buffer_load_dwordx4 v15, s[4:7], s56 offen offset:2048 nt lds
  buffer_load_dwordx4 v15, s[4:7], s56 offen offset:3072 nt lds
  s_add_u32 s56, s56, 16384
  s_mov_b32 s57, s61
  s_add_u32 m0, s60, 81920
  s_nop 0
  buffer_load_dwordx4 v16, s[8:11], s57 offen offset:0 nt lds
  buffer_load_dwordx4 v16, s[8:11], s57 offen offset:1024 nt lds
  buffer_load_dwordx4 v17, s[8:11], s57 offen offset:2048 nt lds
  buffer_load_dwordx4 v17, s[8:11], s57 offen offset:3072 nt lds
  s_add_u32 s57, s57, 16384
  v_mfma_f32_16x16x32_bf16 v[104:107], v[244:247], v[56:59], v[104:107]
  v_mfma_f32_16x16x32_bf16 v[108:111], v[244:247], v[60:63], v[108:111]
  s_waitcnt lgkmcnt(2)
  v_mfma_f32_16x16x32_bf16 v[112:115], v[248:251], v[56:59], v[112:115]
  v_mfma_f32_16x16x32_bf16 v[116:119], v[248:251], v[60:63], v[116:119]
  s_waitcnt lgkmcnt(0)
  v_mfma_f32_16x16x32_bf16 v[120:123], v[252:255], v[56:59], v[120:123]
  v_mfma_f32_16x16x32_bf16 v[124:127], v[252:255], v[60:63], v[124:127]
  s_mov_b32 s90, 0x3e0293ee
  s_mov_b32 s91, 0x3e0293ee
  s_nop 3
  v_mul_f32 v64, s90, v64
  v_mul_f32 v65, s90, v65
  v_mul_f32 v66, s90, v66
  v_mul_f32 v67, s90, v67
  v_cvt_pk_bf16_f32 v32, v64, v65
  v_cvt_pk_bf16_f32 v33, v66, v67
  v_mul_f32 v72, s90, v72
  v_mul_f32 v73, s90, v73
  v_mul_f32 v74, s90, v74
  v_mul_f32 v75, s90, v75
  v_cvt_pk_bf16_f32 v34, v72, v73
  v_cvt_pk_bf16_f32 v35, v74, v75
  v_mul_f32 v68, s90, v68
  v_mul_f32 v69, s90, v69
  v_mul_f32 v70, s90, v70
  v_mul_f32 v71, s90, v71
  v_cvt_pk_bf16_f32 v36, v68, v69
  v_cvt_pk_bf16_f32 v37, v70, v71
  v_mul_f32 v76, s90, v76
  v_mul_f32 v77, s90, v77
  v_mul_f32 v78, s90, v78
  v_mul_f32 v79, s90, v79
  v_cvt_pk_bf16_f32 v38, v76, v77
  v_cvt_pk_bf16_f32 v39, v78, v79
  v_mul_f32 v80, s90, v80
  v_mul_f32 v81, s90, v81
  v_mul_f32 v82, s90, v82
  v_mul_f32 v83, s90, v83
  v_cvt_pk_bf16_f32 v40, v80, v81
  v_cvt_pk_bf16_f32 v41, v82, v83
  v_mul_f32 v88, s90, v88
  v_mul_f32 v89, s90, v89
  v_mul_f32 v90, s90, v90
  v_mul_f32 v91, s90, v91
  v_cvt_pk_bf16_f32 v42, v88, v89
  v_cvt_pk_bf16_f32 v43, v90, v91
  v_mul_f32 v84, s90, v84
  v_mul_f32 v85, s90, v85
  v_mul_f32 v86, s90, v86
  v_mul_f32 v87, s90, v87
  v_cvt_pk_bf16_f32 v44, v84, v85
  v_cvt_pk_bf16_f32 v45, v86, v87
  v_mul_f32 v92, s90, v92
  v_mul_f32 v93, s90, v93
  v_mul_f32 v94, s90, v94
  v_mul_f32 v95, s90, v95
  v_cvt_pk_bf16_f32 v46, v92, v93
  v_cvt_pk_bf16_f32 v47, v94, v95
  v_mul_f32 v96, s90, v96
  v_mul_f32 v97, s90, v97
  v_mul_f32 v98, s90, v98
  v_mul_f32 v99, s90, v99
  v_cvt_pk_bf16_f32 v48, v96, v97
  v_cvt_pk_bf16_f32 v49, v98, v99
  v_mul_f32 v104, s90, v104
  v_mul_f32 v105, s90, v105
  v_mul_f32 v106, s90, v106
  v_mul_f32 v107, s90, v107
  v_cvt_pk_bf16_f32 v50, v104, v105
  v_cvt_pk_bf16_f32 v51, v106, v107
  v_mul_f32 v100, s90, v100
  v_mul_f32 v101, s90, v101
  v_mul_f32 v102, s90, v102
  v_mul_f32 v103, s90, v103
  v_cvt_pk_bf16_f32 v52, v100, v101
  v_cvt_pk_bf16_f32 v53, v102, v103
  v_mul_f32 v108, s90, v108
  v_mul_f32 v109, s90, v109
  v_mul_f32 v110, s90, v110
  v_mul_f32 v111, s90, v111
  v_cvt_pk_bf16_f32 v54, v108, v109
  v_cvt_pk_bf16_f32 v55, v110, v111
  v_mul_f32 v112, s90, v112
  v_mul_f32 v113, s90, v113
  v_mul_f32 v114, s90, v114
  v_mul_f32 v115, s90, v115
  v_cvt_pk_bf16_f32 v56, v112, v113
  v_cvt_pk_bf16_f32 v57, v114, v115
  v_mul_f32 v120, s90, v120
  v_mul_f32 v121, s90, v121
  v_mul_f32 v122, s90, v122
  v_mul_f32 v123, s90, v123
  v_cvt_pk_bf16_f32 v58, v120, v121
  v_cvt_pk_bf16_f32 v59, v122, v123
  v_mul_f32 v116, s90, v116
  v_mul_f32 v117, s90, v117
  v_mul_f32 v118, s90, v118
  v_mul_f32 v119, s90, v119
  v_cvt_pk_bf16_f32 v60, v116, v117
  v_cvt_pk_bf16_f32 v61, v118, v119
  v_mul_f32 v124, s90, v124
  v_mul_f32 v125, s90, v125
  v_mul_f32 v126, s90, v126
  v_mul_f32 v127, s90, v127
  v_cvt_pk_bf16_f32 v62, v124, v125
  v_cvt_pk_bf16_f32 v63, v126, v127
  v_permlane32_swap_b32 v32, v34
  v_permlane32_swap_b32 v33, v35
  v_permlane32_swap_b32 v36, v38
  v_permlane32_swap_b32 v37, v39
  v_permlane32_swap_b32 v40, v42
  v_permlane32_swap_b32 v41, v43
  v_permlane32_swap_b32 v44, v46
  v_permlane32_swap_b32 v45, v47
  v_permlane32_swap_b32 v48, v50
  v_permlane32_swap_b32 v49, v51
  v_permlane32_swap_b32 v52, v54
  v_permlane32_swap_b32 v53, v55
  v_permlane32_swap_b32 v56, v58
  v_permlane32_swap_b32 v57, v59
  v_permlane32_swap_b32 v60, v62
  v_permlane32_swap_b32 v61, v63
  v_permlane16_swap_b32 v32, v34
  v_permlane16_swap_b32 v33, v35
  v_permlane16_swap_b32 v36, v38
  v_permlane16_swap_b32 v37, v39
  v_permlane16_swap_b32 v40, v42
  v_permlane16_swap_b32 v41, v43
  v_permlane16_swap_b32 v44, v46
  v_permlane16_swap_b32 v45, v47
  v_permlane16_swap_b32 v48, v50
  v_permlane16_swap_b32 v49, v51
  v_permlane16_swap_b32 v52, v54
  v_permlane16_swap_b32 v53, v55
  v_permlane16_swap_b32 v56, v58
  v_permlane16_swap_b32 v57, v59
  v_permlane16_swap_b32 v60, v62
  v_permlane16_swap_b32 v61, v63
  s_waitcnt vmcnt(8)
  s_barrier
  s_add_u32 m0, s60, 49152
  s_nop 0
  buffer_load_dwordx4 v14, s[4:7], s56 offen offset:0 nt lds
  buffer_load_dwordx4 v14, s[4:7], s56 offen offset:1024 nt lds
  buffer_load_dwordx4 v15, s[4:7], s56 offen offset:2048 nt lds
  buffer_load_dwordx4 v15, s[4:7], s56 offen offset:3072 nt lds
  s_add_u32 s56, s56, 16384
  s_add_u32 m0, s60, 98304
  s_nop 0
  buffer_load_dwordx4 v16, s[8:11], s57 offen offset:0 nt lds
  buffer_load_dwordx4 v16, s[8:11], s57 offen offset:1024 nt lds
  buffer_load_dwordx4 v17, s[8:11], s57 offen offset:2048 nt lds
  buffer_load_dwordx4 v17, s[8:11], s57 offen offset:3072 nt lds
  s_add_u32 s57, s57, 16384
  s_branch L_att_entry
L_end:
  s_endpgm
L_sta0:
  s_call_b64 s[32:33], L_rare0
  s_branch L_oka0
L_stb0:
  s_call_b64 s[32:33], L_rare1
  s_branch L_okb0
L_sta1:
  s_call_b64 s[32:33], L_rare0
  s_branch L_oka1
L_stb1:
  s_call_b64 s[32:33], L_rare1
  s_branch L_okb1
L_sta2:
  s_call_b64 s[32:33], L_rare0
  s_branch L_oka2
L_stb2:
  s_call_b64 s[32:33], L_rare1
  s_branch L_okb2
L_ste0:
  s_call_b64 s[32:33], L_rare0
  s_branch L_oke0
L_ste1:
  s_call_b64 s[32:33], L_rare1
  s_branch L_oke1
L_rare0:
  s_nop 15
  v_max3_f32 v24, v144, v145, v146
  v_max3_f32 v24, v24, v147, v152
  v_max3_f32 v24, v24, v153, v154
  v_max_f32 v24, v24, v155
  v_max3_f32 v25, v148, v149, v150
  v_max3_f32 v25, v25, v151, v156
  v_max3_f32 v25, v25, v157, v158
  v_max_f32 v25, v25, v159
  v_mov_b32 v26, v24
  v_mov_b32 v27, v25
  s_nop 1
  v_permlane32_swap_b32 v24, v26
  v_permlane32_swap_b32 v25, v27
  v_max_f32 v24, v24, v26
  v_max_f32 v25, v25, v27
  v_mov_b32 v26, v24
  v_mov_b32 v27, v25
  s_nop 1
  v_permlane16_swap_b32 v24, v26
  v_permlane16_swap_b32 v25, v27
  v_max_f32 v24, v24, v26
  v_max_f32 v25, v25, v27
  v_add_f32 v24, s67, v24
  v_add_f32 v25, s67, v25
  v_max_f32 v24, 0, v24
  v_max_f32 v25, 0, v25
  v_exp_f32 v26, -v24
  v_exp_f32 v27, -v25
  v_sub_f32 v128, v128, v24
  v_sub_f32 v129, v129, v24
  v_sub_f32 v130, v130, v24
  v_sub_f32 v131, v131, v24
  v_sub_f32 v132, v132, v25
  v_sub_f32 v133, v133, v25
  v_sub_f32 v134, v134, v25
  v_sub_f32 v135, v135, v25
  v_sub_f32 v144, v144, v24
  v_sub_f32 v145, v145, v24
  v_sub_f32 v146, v146, v24
  v_sub_f32 v147, v147, v24
  v_sub_f32 v148, v148, v25
  v_sub_f32 v149, v149, v25
  v_sub_f32 v150, v150, v25
  v_sub_f32 v151, v151, v25
  v_sub_f32 v152, v152, v24
  v_sub_f32 v153, v153, v24
  v_sub_f32 v154, v154, v24
  v_sub_f32 v155, v155, v24
  v_sub_f32 v156, v156, v25
  v_sub_f32 v157, v157, v25
  v_sub_f32 v158, v158, v25
  v_sub_f32 v159, v159, v25
  v_sub_f32 v160, v160, v24
  v_sub_f32 v161, v161, v24
  v_sub_f32 v162, v162, v24
  v_sub_f32 v163, v163, v24
  v_sub_f32 v164, v164, v25
  v_sub_f32 v165, v165, v25
  v_sub_f32 v166, v166, v25
  v_sub_f32 v167, v167, v25
  v_sub_f32 v168, v168, v24
  v_sub_f32 v169, v169, v24
  v_sub_f32 v170, v170, v24
  v_sub_f32 v171, v171, v24
  v_sub_f32 v172, v172, v25
  v_sub_f32 v173, v173, v25
  v_sub_f32 v174, v174, v25
  v_sub_f32 v175, v175, v25
  v_mul_f32 v64, v64, v26
  v_mul_f32 v65, v65, v26
  v_mul_f32 v66, v66, v26
  v_mul_f32 v67, v67, v26
  v_mul_f32 v68, v68, v27
  v_mul_f32 v69, v69, v27
  v_mul_f32 v70, v70, v27
  v_mul_f32 v71, v71, v27
  v_mul_f32 v72, v72, v26
  v_mul_f32 v73, v73, v26
  v_mul_f32 v74, v74, v26
  v_mul_f32 v75, v75, v26
  v_mul_f32 v76, v76, v27
  v_mul_f32 v77, v77, v27
  v_mul_f32 v78, v78, v27
  v_mul_f32 v79, v79, v27
  v_mul_f32 v80, v80, v26
  v_mul_f32 v81, v81, v26
  v_mul_f32 v82, v82, v26
  v_mul_f32 v83, v83, v26
  v_mul_f32 v84, v84, v27
  v_mul_f32 v85, v85, v27
  v_mul_f32 v86, v86, v27
  v_mul_f32 v87, v87, v27
  v_mul_f32 v88, v88, v26
  v_mul_f32 v89, v89, v26
  v_mul_f32 v90, v90, v26
  v_mul_f32 v91, v91, v26
  v_mul_f32 v92, v92, v27
  v_mul_f32 v93, v93, v27
  v_mul_f32 v94, v94, v27
  v_mul_f32 v95, v95, v27
  v_mul_f32 v96, v96, v26
  v_mul_f32 v97, v97, v26
  v_mul_f32 v98, v98, v26
  v_mul_f32 v99, v99, v26
  v_mul_f32 v100, v100, v27
  v_mul_f32 v101, v101, v27
  v_mul_f32 v102, v102, v27
  v_mul_f32 v103, v103, v27
  v_mul_f32 v104, v104, v26
  v_mul_f32 v105, v105, v26
  v_mul_f32 v106, v106, v26
  v_mul_f32 v107, v107, v26
  v_mul_f32 v108, v108, v27
  v_mul_f32 v109, v109, v27
  v_mul_f32 v110, v110, v27
  v_mul_f32 v111, v111, v27
  v_mul_f32 v112, v112, v26
  v_mul_f32 v113, v113, v26
  v_mul_f32 v114, v114, v26
  v_mul_f32 v115, v115, v26
  v_mul_f32 v116, v116, v27
  v_mul_f32 v117, v117, v27
  v_mul_f32 v118, v118, v27
  v_mul_f32 v119, v119, v27
  v_mul_f32 v120, v120, v26
  v_mul_f32 v121, v121, v26
  v_mul_f32 v122, v122, v26
  v_mul_f32 v123, v123, v26
  v_mul_f32 v124, v124, v27
  v_mul_f32 v125, v125, v27
  v_mul_f32 v126, v126, v27
  v_mul_f32 v127, v127, v27
  v_mul_f32 v136, v136, v26
  v_mul_f32 v137, v137, v26
  v_mul_f32 v138, v138, v26
  v_mul_f32 v139, v139, v26
  v_mul_f32 v140, v140, v27
  v_mul_f32 v141, v141, v27
  v_mul_f32 v142, v142, v27
  v_mul_f32 v143, v143, v27
  v_exp_f32 v144, v144
  v_exp_f32 v145, v145
  v_exp_f32 v146, v146
  v_exp_f32 v147, v147
  v_exp_f32 v148, v148
  v_exp_f32 v149, v149
  v_exp_f32 v150, v150
  v_exp_f32 v151, v151
  v_exp_f32 v152, v152
  v_exp_f32 v153, v153
  v_exp_f32 v154, v154
  v_exp_f32 v155, v155
  v_exp_f32 v156, v156
  v_exp_f32 v157, v157
  v_exp_f32 v158, v158
  v_exp_f32 v159, v159
  s_nop 0
  v_cvt_pk_bf16_f32 v176, v144, v145
  v_cvt_pk_bf16_f32 v177, v146, v147
  v_cvt_pk_bf16_f32 v180, v148, v149
  v_cvt_pk_bf16_f32 v181, v150, v151
  v_cvt_pk_bf16_f32 v178, v152, v153
  v_cvt_pk_bf16_f32 v179, v154, v155
  v_cvt_pk_bf16_f32 v182, v156, v157
  v_cvt_pk_bf16_f32 v183, v158, v159
  s_nop 1
  s_setpc_b64 s[32:33]
L_rare1:
  s_nop 15
  v_max3_f32 v24, v160, v161, v162
  v_max3_f32 v24, v24, v163, v168
  v_max3_f32 v24, v24, v169, v170
  v_max_f32 v24, v24, v171
  v_max3_f32 v25, v164, v165, v166
  v_max3_f32 v25, v25, v167, v172
  v_max3_f32 v25, v25, v173, v174
  v_max_f32 v25, v25, v175
  v_mov_b32 v26, v24
  v_mov_b32 v27, v25
  s_nop 1
  v_permlane32_swap_b32 v24, v26
  v_permlane32_swap_b32 v25, v27
  v_max_f32 v24, v24, v26
  v_max_f32 v25, v25, v27
  v_mov_b32 v26, v24
  v_mov_b32 v27, v25
  s_nop 1
  v_permlane16_swap_b32 v24, v26
  v_permlane16_swap_b32 v25, v27
  v_max_f32 v24, v24, v26
  v_max_f32 v25, v25, v27
  v_add_f32 v24, s67, v24
  v_add_f32 v25, s67, v25
  v_max_f32 v24, 0, v24
  v_max_f32 v25, 0, v25
  v_exp_f32 v26, -v24
  v_exp_f32 v27, -v25
  v_sub_f32 v128, v128, v24
  v_sub_f32 v129, v129, v24
  v_sub_f32 v130, v130, v24
  v_sub_f32 v131, v131, v24
  v_sub_f32 v132, v132, v25
  v_sub_f32 v133, v133, v25
  v_sub_f32 v134, v134, v25
  v_sub_f32 v135, v135, v25
  v_sub_f32 v160, v160, v24
  v_sub_f32 v161, v161, v24
  v_sub_f32 v162, v162, v24
  v_sub_f32 v163, v163, v24
  v_sub_f32 v164, v164, v25
  v_sub_f32 v165, v165, v25
  v_sub_f32 v166, v166, v25
  v_sub_f32 v167, v167, v25
  v_sub_f32 v168, v168, v24
  v_sub_f32 v169, v169, v24
  v_sub_f32 v170, v170, v24
  v_sub_f32 v171, v171, v24
  v_sub_f32 v172, v172, v25
  v_sub_f32 v173, v173, v25
  v_sub_f32 v174, v174, v25
  v_sub_f32 v175, v175, v25
  v_sub_f32 v144, v144, v24
  v_sub_f32 v145, v145, v24
  v_sub_f32 v146, v146, v24
  v_sub_f32 v147, v147, v24
  v_sub_f32 v148, v148, v25
  v_sub_f32 v149, v149, v25
  v_sub_f32 v150, v150, v25
  v_sub_f32 v151, v151, v25
  v_sub_f32 v152, v152, v24
  v_sub_f32 v153, v153, v24
  v_sub_f32 v154, v154, v24
  v_sub_f32 v155, v155, v24
  v_sub_f32 v156, v156, v25
  v_sub_f32 v157, v157, v25
  v_sub_f32 v158, v158, v25
  v_sub_f32 v159, v159, v25
  v_mul_f32 v64, v64, v26
  v_mul_f32 v65, v65, v26
  v_mul_f32 v66, v66, v26
  v_mul_f32 v67, v67, v26
  v_mul_f32 v68, v68, v27
  v_mul_f32 v69, v69, v27
  v_mul_f32 v70, v70, v27
  v_mul_f32 v71, v71, v27
  v_mul_f32 v72, v72, v26
  v_mul_f32 v73, v73, v26
  v_mul_f32 v74, v74, v26
  v_mul_f32 v75, v75, v26
  v_mul_f32 v76, v76, v27
  v_mul_f32 v77, v77, v27
  v_mul_f32 v78, v78, v27
  v_mul_f32 v79, v79, v27
  v_mul_f32 v80, v80, v26
  v_mul_f32 v81, v81, v26
  v_mul_f32 v82, v82, v26
  v_mul_f32 v83, v83, v26
  v_mul_f32 v84, v84, v27
  v_mul_f32 v85, v85, v27
  v_mul_f32 v86, v86, v27
  v_mul_f32 v87, v87, v27
  v_mul_f32 v88, v88, v26
  v_mul_f32 v89, v89, v26
  v_mul_f32 v90, v90, v26
  v_mul_f32 v91, v91, v26
  v_mul_f32 v92, v92, v27
  v_mul_f32 v93, v93, v27
  v_mul_f32 v94, v94, v27
  v_mul_f32 v95, v95, v27
  v_mul_f32 v96, v96, v26
  v_mul_f32 v97, v97, v26
  v_mul_f32 v98, v98, v26
  v_mul_f32 v99, v99, v26
  v_mul_f32 v100, v100, v27
  v_mul_f32 v101, v101, v27
  v_mul_f32 v102, v102, v27
  v_mul_f32 v103, v103, v27
  v_mul_f32 v104, v104, v26
  v_mul_f32 v105, v105, v26
  v_mul_f32 v106, v106, v26
  v_mul_f32 v107, v107, v26
  v_mul_f32 v108, v108, v27
  v_mul_f32 v109, v109, v27
  v_mul_f32 v110, v110, v27
  v_mul_f32 v111, v111, v27
  v_mul_f32 v112, v112, v26
  v_mul_f32 v113, v113, v26
  v_mul_f32 v114, v114, v26
  v_mul_f32 v115, v115, v26
  v_mul_f32 v116, v116, v27
  v_mul_f32 v117, v117, v27
  v_mul_f32 v118, v118, v27
  v_mul_f32 v119, v119, v27
  v_mul_f32 v120, v120, v26
  v_mul_f32 v121, v121, v26
  v_mul_f32 v122, v122, v26
  v_mul_f32 v123, v123, v26
  v_mul_f32 v124, v124, v27
  v_mul_f32 v125, v125, v27
  v_mul_f32 v126, v126, v27
  v_mul_f32 v127, v127, v27
  v_mul_f32 v136, v136, v26
  v_mul_f32 v137, v137, v26
  v_mul_f32 v138, v138, v26
  v_mul_f32 v139, v139, v26
  v_mul_f32 v140, v140, v27
  v_mul_f32 v141, v141, v27
  v_mul_f32 v142, v142, v27
  v_mul_f32 v143, v143, v27
  v_exp_f32 v160, v160
  v_exp_f32 v161, v161
  v_exp_f32 v162, v162
  v_exp_f32 v163, v163
  v_exp_f32 v164, v164
  v_exp_f32 v165, v165
  v_exp_f32 v166, v166
  v_exp_f32 v167, v167
  v_exp_f32 v168, v168
  v_exp_f32 v169, v169
  v_exp_f32 v170, v170
  v_exp_f32 v171, v171
  v_exp_f32 v172, v172
  v_exp_f32 v173, v173
  v_exp_f32 v174, v174
  v_exp_f32 v175, v175
  s_nop 0
  v_cvt_pk_bf16_f32 v184, v160, v161
  v_cvt_pk_bf16_f32 v185, v162, v163
  v_cvt_pk_bf16_f32 v188, v164, v165
  v_cvt_pk_bf16_f32 v189, v166, v167
  v_cvt_pk_bf16_f32 v186, v168, v169
  v_cvt_pk_bf16_f32 v187, v170, v171
  v_cvt_pk_bf16_f32 v190, v172, v173
  v_cvt_pk_bf16_f32 v191, v174, v175
  s_nop 1
  s_setpc_b64 s[32:33]
L_code_end:
.section .rodata,"a"
.p2align 6
.amdhsa_kernel concat_heads__mha_block_cached__gqa_block_cached__near_ridge_kernel
  .amdhsa_next_free_vgpr 256
  .amdhsa_next_free_sgpr 96
  .amdhsa_accum_offset 256
  .amdhsa_group_segment_fixed_size 0
  .amdhsa_kernarg_size 104
  .amdhsa_user_sgpr_count 2
  .amdhsa_user_sgpr_kernarg_segment_ptr 1
  .amdhsa_system_sgpr_workgroup_id_x 1
.end_amdhsa_kernel
```
